```python
import torch

def _softmax(x, axis=-1):
    return torch.softmax(x, dim=axis)
def _gelu(x):
    return torch.nn.functional.gelu(x, approximate="tanh")
def _silu(x):
    return torch.nn.functional.silu(x)
def _sigmoid(x):
    return torch.sigmoid(x)
def _layernorm(x, axis=-1, eps=1e-5):
    m = x.mean(dim=axis, keepdim=True)
    v = x.var(dim=axis, keepdim=True, unbiased=False)
    return (x - m) / torch.sqrt(v + eps)
def _scatter_add(tgt, idx, src, axis=0):
    return tgt.clone().index_add_(axis, idx, src)
def _segment_sum(src, seg, n):
    out = torch.zeros((n,) + src.shape[1:], dtype=src.dtype)
    return out.index_add_(0, seg, src)
def _pad(x, pw):
    flat = tuple(v for pair in reversed(pw) for v in pair)
    return torch.nn.functional.pad(x, flat)

kernel_name = 'gated_mix__linear_attn_block__mixer_channel_mlp__prompt'

def setup_inputs():

    _w = (lambda a: (lambda t: t.to(torch.bfloat16) if t.is_floating_point() else t)(torch.as_tensor(a)))
    def _A_setup():
        B, S, D = 1, 2048, 640
        return {
            "x": _w((lambda *s: torch.randn(*s, dtype=torch.bfloat16) * 0.05)(B, S, D)),
            "wqkv": _w((lambda *s: torch.randn(*s, dtype=torch.bfloat16) * 0.8)(D, 3 * D)),
            "wo": _w((lambda *s: torch.randn(*s, dtype=torch.bfloat16) * 0.2)(D, D)),
        }
    _A_in = _A_setup()

    def _B_setup():
        B, S, D, F = 1, 2048, 640, 1728
        return {
            "x": _w((lambda *s: torch.randn(*s, dtype=torch.bfloat16) * 0.05)(B, S, D)),
            "w1": _w((lambda *s: torch.randn(*s, dtype=torch.bfloat16) * 1.6)(D, F) * (D ** -0.5)),
            "b1": _w((lambda *s: torch.randn(*s, dtype=torch.bfloat16) * 0.8)(F)),
            "w2": _w((lambda *s: torch.randn(*s, dtype=torch.bfloat16) * 0.05)(F, D) * (F ** -0.5)),
            "b2": _w((lambda *s: torch.randn(*s, dtype=torch.bfloat16) * 0.05)(D)),
        }
    _B_in = _B_setup()

    return {
        "A_x": _A_in["x"],
        "A_wqkv": _A_in["wqkv"],
        "A_wo": _A_in["wo"],
        "B_x": _B_in["x"],
        "B_w1": _B_in["w1"],
        "B_b1": _B_in["b1"],
        "B_w2": _B_in["w2"],
        "B_b2": _B_in["b2"],
        "gate_w": _w((lambda *s: torch.randn(*s, dtype=torch.bfloat16) * 0.05)(640) * 16.0),
    }

def reference(A_x, A_wqkv, A_wo, B_x, B_w1, B_b1, B_w2, B_b2, gate_w):
    def _A_ref(x, wqkv, wo):
        B, S, D = x.shape
        H = 32; Dh = D // H
        qkv = (lambda x, *d: x.permute(*d))((x @ wqkv).reshape(B, S, 3, H, Dh), 2, 0, 3, 1, 4)
        q, k, v = qkv[0], qkv[1], qkv[2]
        phi = lambda t: torch.where(t > 0, t + 1, torch.exp(t)) + 1e-6
        pq, pk = phi(q), phi(k)
        kv = torch.einsum("bhsd,bhse->bhde", pk, v)
        z = torch.einsum("bhsd->bhd", pk)
        num = torch.einsum("bhqd,bhde->bhqe", pq, kv)
        den = torch.einsum("bhqd,bhd->bhq", pq, z)[..., None] + 1e-6
        o = num / den
        return (lambda x, *d: x.permute(*d))(o, 0, 2, 1, 3).reshape(B, S, D) @ wo

    def _B_ref(x, w1, b1, w2, b2):
        y = _layernorm(x, axis=-1)
        h = _gelu(torch.einsum("bsd,df->bsf", y, w1) + b1)
        return torch.einsum("bsf,fd->bsd", h, w2) + b2

    x = A_x
    g = _sigmoid((x * gate_w).sum(-1, keepdims=True))
    a = _A_ref(x, A_wqkv, A_wo)
    b = _B_ref(x, B_w1, B_b1, B_w2, B_b2)
    return g * a + (1 - g) * b
```

```asm
; @launch grid=(256,1,1) block=(256,1,1) lds=163840
.amdgcn_target "amdgcn-amd-amdhsa--gfx950"
.text
.globl gated_mix__linear_attn_block__mixer_channel_mlp__prompt_kernel
.p2align 8
.type gated_mix__linear_attn_block__mixer_channel_mlp__prompt_kernel,@function
gated_mix__linear_attn_block__mixer_channel_mlp__prompt_kernel:
    s_cmp_ge_u32 s2, 256
    s_cbranch_scc1 K1_end0
    s_load_dwordx4 s[76:79], s[0:1], 0
    s_load_dwordx2 s[80:81], s[0:1], 16
    s_load_dwordx8 s[84:91], s[0:1], 32
    s_load_dwordx2 s[82:83], s[0:1], 64
    s_load_dwordx4 s[92:95], s[0:1], 80
    s_getpc_b64 s[70:71]
    v_lshlrev_b32 v4, 7, v0
    v_lshrrev_b32 v5, 6, v0
    s_lshr_b32 s72, s2, 3
    v_lshl_add_u32 v5, v5, 3, s72
    v_and_b32 v5, 31, v5
    v_mul_u32_u24 v5, 2304, v5
    v_and_b32 v4, 63, v0
    v_min_u32 v4, 17, v4
    v_lshl_add_u32 v5, v4, 7, v5
    global_load_dword a255, v5, s[70:71]
    v_lshrrev_b32 v1, 6, v0
    v_and_b32 v3, 63, v0
    v_readfirstlane_b32 s24, v1
    s_and_b32 s70, s2, 1
    s_lshl_b32 s70, s70, 3
    s_bfe_u32 s71, s2, 0x30003
    s_add_u32 s25, s70, s71
    s_and_b32 s70, s2, 6
    s_bfe_u32 s71, s2, 0x10006
    s_add_u32 s26, s70, s71
    s_lshr_b32 s72, s2, 6
    s_add_u32 s70, s25, s72
    s_and_b32 s71, s2, 6
    s_lshl_b32 s71, s71, 1
    s_add_u32 s70, s70, s71
    s_mul_i32 s71, s70, 52
    s_lshr_b32 s71, s71, 8
    s_mul_i32 s71, s71, 5
    s_sub_u32 s70, s70, s71
    s_lshl_b32 s70, s70, 8
    s_lshl_b32 s27, s24, 12
    s_mul_i32 s68, s24, 5120
    s_lshl_b32 s28, s25, 2
    s_add_u32 s28, s28, s24
    s_lshl_b32 s69, s28, 7
    s_add_u32 s69, s69, 19922944
    s_mul_i32 s28, s28, 40960
    s_lshl_b32 s3, s25, 7
    s_add_u32 s3, s3, 20447232
    s_lshl_b32 s31, s26, 7
    s_add_u32 s31, s31, 20451328
    s_cmp_eq_u32 s24, 0
    s_cselect_b32 s3, s3, 2130706432
    s_cselect_b32 s31, s31, 2130706432
    s_mov_b32 s66, 0x3fb8aa3b
    s_mov_b32 s67, 0x358637bd
    s_add_u32 s71, s70, 0
    s_cmp_ge_u32 s71, 1280
    s_cselect_b32 s29, 1280, 0
    s_sub_u32 s71, s71, s29
    s_add_u32 s40, s71, s28
    s_mul_i32 s50, s71, 1920
    s_mul_i32 s60, s71, 1728
    s_add_u32 s71, s70, 128
    s_cmp_ge_u32 s71, 1280
    s_cselect_b32 s29, 1280, 0
    s_sub_u32 s71, s71, s29
    s_add_u32 s41, s71, s28
    s_mul_i32 s51, s71, 1920
    s_add_u32 s71, s70, 256
    s_cmp_ge_u32 s71, 1280
    s_cselect_b32 s29, 1280, 0
    s_sub_u32 s71, s71, s29
    s_add_u32 s42, s71, s28
    s_mul_i32 s52, s71, 1920
    s_mul_i32 s61, s71, 1728
    s_add_u32 s71, s70, 384
    s_cmp_ge_u32 s71, 1280
    s_cselect_b32 s29, 1280, 0
    s_sub_u32 s71, s71, s29
    s_add_u32 s43, s71, s28
    s_mul_i32 s53, s71, 1920
    s_add_u32 s71, s70, 512
    s_cmp_ge_u32 s71, 1280
    s_cselect_b32 s29, 1280, 0
    s_sub_u32 s71, s71, s29
    s_add_u32 s44, s71, s28
    s_mul_i32 s54, s71, 1920
    s_mul_i32 s62, s71, 1728
    s_add_u32 s71, s70, 640
    s_cmp_ge_u32 s71, 1280
    s_cselect_b32 s29, 1280, 0
    s_sub_u32 s71, s71, s29
    s_add_u32 s45, s71, s28
    s_mul_i32 s55, s71, 1920
    s_add_u32 s71, s70, 768
    s_cmp_ge_u32 s71, 1280
    s_cselect_b32 s29, 1280, 0
    s_sub_u32 s71, s71, s29
    s_add_u32 s46, s71, s28
    s_mul_i32 s56, s71, 1920
    s_mul_i32 s63, s71, 1728
    s_add_u32 s71, s70, 896
    s_cmp_ge_u32 s71, 1280
    s_cselect_b32 s29, 1280, 0
    s_sub_u32 s71, s71, s29
    s_add_u32 s47, s71, s28
    s_mul_i32 s57, s71, 1920
    s_add_u32 s71, s70, 1024
    s_cmp_ge_u32 s71, 1280
    s_cselect_b32 s29, 1280, 0
    s_sub_u32 s71, s71, s29
    s_add_u32 s48, s71, s28
    s_mul_i32 s58, s71, 1920
    s_mul_i32 s64, s71, 1728
    s_add_u32 s71, s70, 1152
    s_cmp_ge_u32 s71, 1280
    s_cselect_b32 s29, 1280, 0
    s_sub_u32 s71, s71, s29
    s_add_u32 s49, s71, s28
    s_mul_i32 s59, s71, 1920
    v_mov_b32 v15, v0
    v_lshrrev_b32 v4, 3, v3
    v_mul_u32_u24 v5, 1280, v4
    v_lshrrev_b32 v6, 4, v3
    v_and_b32 v7, 7, v3
    v_xor_b32 v8, v6, v7
    v_lshl_add_u32 v0, v8, 4, v5
    v_xor_b32 v1, 64, v0
    v_and_b32 v6, 1, v6
    v_lshlrev_b32 v6, 2, v6
    v_xor_b32 v12, v6, v7
    v_lshlrev_b32 v12, 4, v12
    s_lshl_b32 s71, s24, 5
    v_add_u32 v13, s71, v4
    v_mul_u32_u24 v9, 205, v15
    v_lshrrev_b32 v9, 14, v9
    v_mul_u32_u24 v9, 80, v9
    v_sub_u32 v9, v15, v9
    v_lshlrev_b32 v9, 4, v9
    s_waitcnt lgkmcnt(0)
    s_mov_b32 s4, s76
    s_and_b32 s5, s77, 0xffff
    s_mov_b32 s6, 2621440
    s_mov_b32 s7, 0x20000
    s_mov_b32 s8, s78
    s_and_b32 s9, s79, 0xffff
    s_mov_b32 s10, 2457600
    s_mov_b32 s11, 0x20000
    s_mov_b32 s12, s84
    s_and_b32 s13, s85, 0xffff
    s_mov_b32 s14, 2211840
    s_mov_b32 s15, 0x20000
    s_mov_b32 s96, s92
    s_and_b32 s97, s93, 0xffff
    s_mov_b32 s98, 256
    s_mov_b32 s99, 0x20000
    s_mov_b32 s16, s94
    s_and_b32 s17, s95, 0xffff
    s_mov_b32 s18, 20971520
    s_mov_b32 s19, 0x20000
    s_mov_b32 s20, s82
    s_and_b32 s21, s83, 0xffff
    s_mov_b32 s22, 1280
    s_mov_b32 s23, 0x20000
    s_lshl_b32 m0, s24, 10
    s_nop 0
    buffer_load_dwordx4 v9, s[20:23], 0 offen lds
    s_mov_b32 s20, s86
    s_and_b32 s21, s87, 0xffff
    s_mov_b32 s22, 3456
    s_mov_b32 s23, 0x20000
    s_cmp_lt_u32 s72, 2
    s_cbranch_scc1 K1_kv
    s_branch K1_A
K1_end0:
    s_endpgm
K1_A:
    v_mul_u32_u24 v9, 3840, v13
    v_add_u32 v9, v9, v12
    v_add_u32 v4, 0, v9
    v_add_u32 v5, 29696, v9
    v_add_u32 v6, 59392, v9
    v_add_u32 v7, 89088, v9
    s_lshl_b32 s32, s26, 7
    s_add_u32 m0, s27, 16384
    s_add_u32 s29, s40, 0
    buffer_load_dwordx4 v0, s[4:7], s29 offen lds
    s_add_u32 m0, s27, 17408
    s_add_u32 s29, s40, 10240
    buffer_load_dwordx4 v1, s[4:7], s29 offen lds
    s_add_u32 m0, s27, 18432
    s_add_u32 s29, s40, 20480
    buffer_load_dwordx4 v0, s[4:7], s29 offen lds
    s_add_u32 m0, s27, 19456
    s_add_u32 s29, s40, 30720
    buffer_load_dwordx4 v1, s[4:7], s29 offen lds
    s_add_u32 m0, s27, 32768
    s_add_u32 s29, s41, 0
    buffer_load_dwordx4 v0, s[4:7], s29 offen lds
    s_add_u32 m0, s27, 33792
    s_add_u32 s29, s41, 10240
    buffer_load_dwordx4 v1, s[4:7], s29 offen lds
    s_add_u32 m0, s27, 34816
    s_add_u32 s29, s41, 20480
    buffer_load_dwordx4 v0, s[4:7], s29 offen lds
    s_add_u32 m0, s27, 35840
    s_add_u32 s29, s41, 30720
    buffer_load_dwordx4 v1, s[4:7], s29 offen lds
    s_add_u32 m0, s27, 49152
    s_add_u32 s30, s50, s32
    buffer_load_dwordx4 v4, s[8:11], s30 offen offset:0 lds
    buffer_load_dwordx4 v5, s[8:11], s30 offen offset:1024 lds
    buffer_load_dwordx4 v6, s[8:11], s30 offen offset:2048 lds
    buffer_load_dwordx4 v7, s[8:11], s30 offen offset:3072 lds
    v_mul_u32_u24 v9, 3456, v13
    v_add_u32 v9, v9, v12
    v_add_u32 v10, 0, v9
    v_accvgpr_write_b32 a112, v10
    v_add_u32 v10, 26624, v9
    v_accvgpr_write_b32 a113, v10
    v_add_u32 v10, 53248, v9
    v_accvgpr_write_b32 a114, v10
    v_add_u32 v10, 79872, v9
    v_accvgpr_write_b32 a115, v10
    v_mov_b32 v16, 0x3f803f80
    v_mov_b32 v17, v16
    v_mov_b32 v18, v16
    v_mov_b32 v19, v16
    v_lshlrev_b32 v20, 4, v15
    ds_write_b128 v20, v[16:19] offset:4096
    v_mov_b32 v28, 0
    v_mov_b32 v29, 0
    v_mov_b32 v30, 0
    v_mov_b32 v31, 0
    ds_write_b128 v20, v[28:31] offset:8192
    v_and_b32 v21, 31, v3
    v_lshrrev_b32 v22, 5, v3
    v_bfe_u32 v23, v21, 1, 3
    v_xor_b32 v23, v23, v22
    v_lshlrev_b32 v23, 4, v23
    v_lshl_add_u32 v11, v21, 7, v23
    v_add_u32 v11, s27, v11
    v_lshrrev_b32 v23, 4, v3
    v_xor_b32 v23, v23, v3
    v_and_b32 v23, 1, v23
    v_cmp_eq_u32 vcc, 0, v23
    v_bfe_u32 v24, v3, 1, 1
    v_lshlrev_b32 v24, 12, v24
    v_mov_b32 v23, 0x2000
    v_cndmask_b32 v23, v23, v24, vcc
    v_lshl_add_u32 v14, v22, 4, v23
    v_add_u32 v14, s70, v14
    v_lshrrev_b32 v23, 4, v21
    v_lshlrev_b32 v23, 10, v23
    v_lshl_add_u32 v23, v22, 8, v23
    v_and_b32 v24, 15, v21
    v_lshl_add_u32 v23, v24, 4, v23
    s_and_b32 s71, s24, 1
    s_lshl_b32 s71, s71, 11
    v_add_u32 v23, s71, v23
    v_accvgpr_write_b32 a116, v23
    v_bfe_u32 v23, v21, 2, 1
    v_cmp_eq_u32 vcc, v23, v22
    v_and_b32 v24, 1, v21
    v_lshlrev_b32 v24, 4, v24
    v_mov_b32 v25, 0x3f80
    v_lshlrev_b32 v25, v24, v25
    v_cndmask_b32 v25, 0, v25, vcc
    v_lshrrev_b32 v24, 3, v21
    v_bfe_u32 v26, v21, 1, 1
    v_lshl_add_u32 v24, v24, 1, v26
    v_cmp_eq_u32 vcc, 0, v24
    s_nop 1
    v_cndmask_b32 v26, 0, v25, vcc
    v_accvgpr_write_b32 a84, v26
    v_cmp_eq_u32 vcc, 1, v24
    s_nop 1
    v_cndmask_b32 v26, 0, v25, vcc
    v_accvgpr_write_b32 a85, v26
    v_cmp_eq_u32 vcc, 2, v24
    s_nop 1
    v_cndmask_b32 v26, 0, v25, vcc
    v_accvgpr_write_b32 a86, v26
    v_cmp_eq_u32 vcc, 3, v24
    s_nop 1
    v_cndmask_b32 v26, 0, v25, vcc
    v_accvgpr_write_b32 a87, v26
    v_cmp_eq_u32 vcc, 4, v24
    s_nop 1
    v_cndmask_b32 v26, 0, v25, vcc
    v_accvgpr_write_b32 a88, v26
    v_cmp_eq_u32 vcc, 5, v24
    s_nop 1
    v_cndmask_b32 v26, 0, v25, vcc
    v_accvgpr_write_b32 a89, v26
    v_cmp_eq_u32 vcc, 6, v24
    s_nop 1
    v_cndmask_b32 v26, 0, v25, vcc
    v_accvgpr_write_b32 a90, v26
    v_cmp_eq_u32 vcc, 7, v24
    s_nop 1
    v_cndmask_b32 v26, 0, v25, vcc
    v_accvgpr_write_b32 a91, v26
    v_accvgpr_write_b32 a65, 0
    v_accvgpr_write_b32 a67, 0
    v_accvgpr_write_b32 a69, 0
    v_accvgpr_write_b32 a71, 0
    v_accvgpr_write_b32 a73, 0
    v_accvgpr_write_b32 a75, 0
    v_accvgpr_write_b32 a76, 0
    v_accvgpr_write_b32 a77, 0
    v_accvgpr_write_b32 a81, 0
    v_accvgpr_write_b32 a82, 0
    v_accvgpr_write_b32 a83, 0
    v_lshlrev_b32 v20, 1, v21
    v_accvgpr_write_b32 a117, v15
    s_lshr_b32 s74, s25, 1
    s_mul_i32 s71, s74, 86
    s_lshr_b32 s71, s71, 8
    s_mul_i32 s71, s71, 3
    s_sub_u32 s74, s74, s71
    s_mul_i32 s75, s26, 3
    s_add_u32 s71, s74, 0
    s_cmp_ge_u32 s71, 3
    s_cselect_b32 s29, 3, 0
    s_sub_u32 s71, s71, s29
    s_add_u32 s71, s71, s75
    s_lshl_b32 s33, s71, 7
    buffer_load_ushort a64, v20, s[20:23], s33 offen offset:0
    buffer_load_ushort a66, v20, s[20:23], s33 offen offset:64
    s_lshl_b32 s37, s33, 6
    s_lshl_b32 s71, s25, 1
    s_lshr_b32 s29, s24, 1
    s_add_u32 s71, s71, s29
    s_mul_i32 s71, s71, 303104
    s_add_u32 s37, s37, s71
    s_add_u32 s37, s37, 0
    s_add_u32 s71, s74, 1
    s_cmp_ge_u32 s71, 3
    s_cselect_b32 s29, 3, 0
    s_sub_u32 s71, s71, s29
    s_add_u32 s71, s71, s75
    s_lshl_b32 s34, s71, 7
    buffer_load_ushort a68, v20, s[20:23], s34 offen offset:0
    buffer_load_ushort a70, v20, s[20:23], s34 offen offset:64
    s_lshl_b32 s38, s34, 6
    s_lshl_b32 s71, s25, 1
    s_lshr_b32 s29, s24, 1
    s_add_u32 s71, s71, s29
    s_mul_i32 s71, s71, 303104
    s_add_u32 s38, s38, s71
    s_add_u32 s38, s38, 0
    s_add_u32 s71, s74, 2
    s_cmp_ge_u32 s71, 3
    s_cselect_b32 s29, 3, 0
    s_sub_u32 s71, s71, s29
    s_add_u32 s71, s71, s75
    s_lshl_b32 s35, s71, 7
    buffer_load_ushort a72, v20, s[20:23], s35 offen offset:0
    buffer_load_ushort a74, v20, s[20:23], s35 offen offset:64
    s_lshl_b32 s39, s35, 6
    s_lshl_b32 s71, s25, 1
    s_lshr_b32 s29, s24, 1
    s_add_u32 s71, s71, s29
    s_mul_i32 s71, s71, 303104
    s_add_u32 s39, s39, s71
    s_add_u32 s39, s39, 0
    s_lshl_b32 s36, s32, 6
    s_lshl_b32 s71, s25, 1
    s_lshr_b32 s29, s24, 1
    s_add_u32 s71, s71, s29
    s_mul_i32 s71, s71, 81920
    s_add_u32 s36, s36, s71
    s_add_u32 s36, s36, 14680064
    v_mbcnt_lo_u32_b32 v12, -1, 0
    v_mbcnt_hi_u32_b32 v12, -1, v12
    v_bfe_u32 v13, v12, 2, 2
    v_lshrrev_b32 v9, 5, v12
    v_lshl_add_u32 v9, v9, 3, v13
    v_lshlrev_b32 v9, 7, v9
    v_bfe_u32 v13, v12, 3, 1
    v_lshl_add_u32 v9, v13, 6, v9
    v_bfe_u32 v13, v12, 4, 1
    v_lshl_add_u32 v9, v13, 5, v9
    v_and_b32 v13, 3, v12
    v_lshl_add_u32 v9, v13, 3, v9
    v_xor_b32 v10, 64, v9
    s_cmp_eq_u32 s26, 0
    s_cselect_b32 s69, s69, 2130706432
    s_lshr_b32 s31, s25, 1
    s_lshl_b32 s31, s31, 7
    s_add_u32 s31, s31, 20449280
    s_cmp_eq_u32 s24, 0
    s_cselect_b32 s31, s31, 2130706432
    s_add_u32 m0, s27, 65536
    s_add_u32 s29, s42, 0
    buffer_load_dwordx4 v0, s[4:7], s29 offen lds
    s_add_u32 m0, s27, 66560
    s_add_u32 s29, s42, 10240
    buffer_load_dwordx4 v1, s[4:7], s29 offen lds
    s_add_u32 m0, s27, 67584
    s_add_u32 s29, s42, 20480
    buffer_load_dwordx4 v0, s[4:7], s29 offen lds
    s_add_u32 m0, s27, 68608
    s_add_u32 s29, s42, 30720
    buffer_load_dwordx4 v1, s[4:7], s29 offen lds
    s_add_u32 m0, s27, 81920
    s_add_u32 s29, s43, 0
    buffer_load_dwordx4 v0, s[4:7], s29 offen lds
    s_add_u32 m0, s27, 82944
    s_add_u32 s29, s43, 10240
    buffer_load_dwordx4 v1, s[4:7], s29 offen lds
    s_add_u32 m0, s27, 83968
    s_add_u32 s29, s43, 20480
    buffer_load_dwordx4 v0, s[4:7], s29 offen lds
    s_add_u32 m0, s27, 84992
    s_add_u32 s29, s43, 30720
    buffer_load_dwordx4 v1, s[4:7], s29 offen lds
    s_add_u32 m0, s27, 98304
    s_add_u32 s30, s52, s32
    buffer_load_dwordx4 v4, s[8:11], s30 offen offset:0 lds
    buffer_load_dwordx4 v5, s[8:11], s30 offen offset:1024 lds
    buffer_load_dwordx4 v6, s[8:11], s30 offen offset:2048 lds
    buffer_load_dwordx4 v7, s[8:11], s30 offen offset:3072 lds
    s_waitcnt vmcnt(18) lgkmcnt(0)
    s_barrier
    v_xor_b32 v12, 0, v11
    ds_read_b128 v[96:99], v12 offset:16384
    ds_read_b128 a[0:3], v14 offset:0
    ds_read_b64_tr_b16 a[4:5], v9 offset:49152
    ds_read_b64_tr_b16 a[6:7], v9 offset:49664
    ds_read_b64_tr_b16 a[8:9], v10 offset:49152
    ds_read_b64_tr_b16 a[10:11], v10 offset:49664
    v_xor_b32 v13, 32, v11
    ds_read_b128 v[100:103], v13 offset:16384
    ds_read_b128 a[12:15], v14 offset:32
    ds_read_b64_tr_b16 a[16:17], v9 offset:51200
    ds_read_b64_tr_b16 a[18:19], v9 offset:51712
    s_waitcnt lgkmcnt(4)
    v_mfma_f32_16x16x32_bf16 a[96:99], a[0:3], v[96:99], 0
    v_mfma_f32_4x4x4_16b_bf16 a[100:103], v[96:97], v[96:97], 0
    v_mfma_f32_4x4x4_16b_bf16 a[104:107], v[98:99], v[98:99], 0
    ds_read_b64_tr_b16 a[20:21], v10 offset:51200
    ds_read_b64_tr_b16 a[22:23], v10 offset:51712
    s_add_u32 m0, s27, 114688
    s_add_u32 s29, s44, 0
    buffer_load_dwordx4 v0, s[4:7], s29 offen lds
    v_mfma_f32_32x32x16_bf16 v[16:31], a[4:7], v[96:99], 0
    v_xor_b32 v12, 64, v11
    ds_read_b128 v[104:107], v12 offset:16384
    ds_read_b128 a[24:27], v14 offset:64
    s_add_u32 m0, s27, 115712
    s_add_u32 s29, s44, 10240
    buffer_load_dwordx4 v1, s[4:7], s29 offen lds
    v_mfma_f32_32x32x16_bf16 v[32:47], a[8:11], v[96:99], 0
    ds_read_b64_tr_b16 a[28:29], v9 offset:53248
    ds_read_b64_tr_b16 a[30:31], v9 offset:53760
    s_add_u32 m0, s27, 116736
    s_add_u32 s29, s44, 20480
    buffer_load_dwordx4 v0, s[4:7], s29 offen lds
    s_waitcnt lgkmcnt(4)
    v_mfma_f32_16x16x32_bf16 a[96:99], a[12:15], v[100:103], a[96:99]
    v_mfma_f32_4x4x4_16b_bf16 a[100:103], v[100:101], v[100:101], a[100:103]
    v_mfma_f32_4x4x4_16b_bf16 a[104:107], v[102:103], v[102:103], a[104:107]
    ds_read_b64_tr_b16 a[32:33], v10 offset:53248
    ds_read_b64_tr_b16 a[34:35], v10 offset:53760
    s_add_u32 m0, s27, 117760
    s_add_u32 s29, s44, 30720
    buffer_load_dwordx4 v1, s[4:7], s29 offen lds
    v_mfma_f32_32x32x16_bf16 v[16:31], a[16:19], v[100:103], v[16:31]
    v_xor_b32 v13, 96, v11
    ds_read_b128 v[108:111], v13 offset:16384
    ds_read_b128 a[36:39], v14 offset:96
    s_add_u32 m0, s27, 131072
    s_add_u32 s29, s45, 0
    buffer_load_dwordx4 v0, s[4:7], s29 offen lds
    v_mfma_f32_32x32x16_bf16 v[32:47], a[20:23], v[100:103], v[32:47]
    ds_read_b64_tr_b16 a[40:41], v9 offset:55296
    ds_read_b64_tr_b16 a[42:43], v9 offset:55808
    s_add_u32 m0, s27, 132096
    s_add_u32 s29, s45, 10240
    buffer_load_dwordx4 v1, s[4:7], s29 offen lds
    s_waitcnt lgkmcnt(4)
    v_mfma_f32_16x16x32_bf16 a[96:99], a[24:27], v[104:107], a[96:99]
    v_mfma_f32_4x4x4_16b_bf16 a[100:103], v[104:105], v[104:105], a[100:103]
    v_mfma_f32_4x4x4_16b_bf16 a[104:107], v[106:107], v[106:107], a[104:107]
    ds_read_b64_tr_b16 a[44:45], v10 offset:55296
    ds_read_b64_tr_b16 a[46:47], v10 offset:55808
    s_add_u32 m0, s27, 133120
    s_add_u32 s29, s45, 20480
    buffer_load_dwordx4 v0, s[4:7], s29 offen lds
    v_mfma_f32_32x32x16_bf16 v[16:31], a[28:31], v[104:107], v[16:31]
    v_xor_b32 v12, 0, v11
    ds_read_b128 v[112:115], v12 offset:32768
    ds_read_b128 a[0:3], v14 offset:128
    s_add_u32 m0, s27, 134144
    s_add_u32 s29, s45, 30720
    buffer_load_dwordx4 v1, s[4:7], s29 offen lds
    v_mfma_f32_32x32x16_bf16 v[32:47], a[32:35], v[104:107], v[32:47]
    ds_read_b64_tr_b16 a[4:5], v9 offset:57344
    ds_read_b64_tr_b16 a[6:7], v9 offset:57856
    s_add_u32 m0, s27, 147456
    s_add_u32 s30, s54, s32
    buffer_load_dwordx4 v4, s[8:11], s30 offen offset:0 lds
    s_waitcnt lgkmcnt(4)
    v_mfma_f32_16x16x32_bf16 a[96:99], a[36:39], v[108:111], a[96:99]
    v_mfma_f32_4x4x4_16b_bf16 a[100:103], v[108:109], v[108:109], a[100:103]
    v_mfma_f32_4x4x4_16b_bf16 a[104:107], v[110:111], v[110:111], a[104:107]
    ds_read_b64_tr_b16 a[8:9], v10 offset:57344
    ds_read_b64_tr_b16 a[10:11], v10 offset:57856
    buffer_load_dwordx4 v5, s[8:11], s30 offen offset:1024 lds
    v_mfma_f32_32x32x16_bf16 v[16:31], a[40:43], v[108:111], v[16:31]
    v_xor_b32 v13, 32, v11
    ds_read_b128 v[116:119], v13 offset:32768
    ds_read_b128 a[12:15], v14 offset:160
    buffer_load_dwordx4 v6, s[8:11], s30 offen offset:2048 lds
    v_mfma_f32_32x32x16_bf16 v[32:47], a[44:47], v[108:111], v[32:47]
    ds_read_b64_tr_b16 a[16:17], v9 offset:59392
    ds_read_b64_tr_b16 a[18:19], v9 offset:59904
    buffer_load_dwordx4 v7, s[8:11], s30 offen offset:3072 lds
    s_waitcnt lgkmcnt(4)
    v_mfma_f32_16x16x32_bf16 a[96:99], a[0:3], v[112:115], a[96:99]
    v_mfma_f32_4x4x4_16b_bf16 a[100:103], v[112:113], v[112:113], a[100:103]
    v_mfma_f32_4x4x4_16b_bf16 a[104:107], v[114:115], v[114:115], a[104:107]
    ds_read_b64_tr_b16 a[20:21], v10 offset:59392
    ds_read_b64_tr_b16 a[22:23], v10 offset:59904
    v_mfma_f32_32x32x16_bf16 v[16:31], a[4:7], v[112:115], v[16:31]
    v_xor_b32 v12, 64, v11
    ds_read_b128 v[120:123], v12 offset:32768
    ds_read_b128 a[24:27], v14 offset:192
    v_mfma_f32_32x32x16_bf16 v[32:47], a[8:11], v[112:115], v[32:47]
    ds_read_b64_tr_b16 a[28:29], v9 offset:61440
    ds_read_b64_tr_b16 a[30:31], v9 offset:61952
    s_waitcnt lgkmcnt(4)
    v_mfma_f32_16x16x32_bf16 a[96:99], a[12:15], v[116:119], a[96:99]
    v_mfma_f32_4x4x4_16b_bf16 a[100:103], v[116:117], v[116:117], a[100:103]
    v_mfma_f32_4x4x4_16b_bf16 a[104:107], v[118:119], v[118:119], a[104:107]
    ds_read_b64_tr_b16 a[32:33], v10 offset:61440
    ds_read_b64_tr_b16 a[34:35], v10 offset:61952
    v_mfma_f32_32x32x16_bf16 v[16:31], a[16:19], v[116:119], v[16:31]
    v_xor_b32 v13, 96, v11
    ds_read_b128 v[124:127], v13 offset:32768
    ds_read_b128 a[36:39], v14 offset:224
    v_mfma_f32_32x32x16_bf16 v[32:47], a[20:23], v[116:119], v[32:47]
    ds_read_b64_tr_b16 a[40:41], v9 offset:63488
    ds_read_b64_tr_b16 a[42:43], v9 offset:64000
    s_waitcnt lgkmcnt(4)
    v_mfma_f32_16x16x32_bf16 a[96:99], a[24:27], v[120:123], a[96:99]
    v_mfma_f32_4x4x4_16b_bf16 a[100:103], v[120:121], v[120:121], a[100:103]
    v_mfma_f32_4x4x4_16b_bf16 a[104:107], v[122:123], v[122:123], a[104:107]
    ds_read_b64_tr_b16 a[44:45], v10 offset:63488
    ds_read_b64_tr_b16 a[46:47], v10 offset:64000
    v_mfma_f32_32x32x16_bf16 v[16:31], a[28:31], v[120:123], v[16:31]
    s_waitcnt vmcnt(12) lgkmcnt(0)
    s_barrier
    v_xor_b32 v12, 65536, v11
    ds_read_b128 v[128:131], v12 offset:0
    ds_read_b128 a[0:3], v14 offset:256
    s_add_u32 m0, s27, 16384
    s_add_u32 s29, s46, 0
    buffer_load_dwordx4 v0, s[4:7], s29 offen lds
    v_mfma_f32_32x32x16_bf16 v[32:47], a[32:35], v[120:123], v[32:47]
    v_add_u32 v9, 98304, v9
    ds_read_b64_tr_b16 a[4:5], v9 offset:0
    ds_read_b64_tr_b16 a[6:7], v9 offset:512
    s_add_u32 m0, s27, 17408
    s_add_u32 s29, s46, 10240
    buffer_load_dwordx4 v1, s[4:7], s29 offen lds
    v_mfma_f32_16x16x32_bf16 a[96:99], a[36:39], v[124:127], a[96:99]
    v_mfma_f32_4x4x4_16b_bf16 a[100:103], v[124:125], v[124:125], a[100:103]
    v_mfma_f32_4x4x4_16b_bf16 a[104:107], v[126:127], v[126:127], a[104:107]
    v_add_u32 v10, 98304, v10
    ds_read_b64_tr_b16 a[8:9], v10 offset:0
    ds_read_b64_tr_b16 a[10:11], v10 offset:512
    s_add_u32 m0, s27, 18432
    s_add_u32 s29, s46, 20480
    buffer_load_dwordx4 v0, s[4:7], s29 offen lds
    v_mfma_f32_32x32x16_bf16 v[16:31], a[40:43], v[124:127], v[16:31]
    v_xor_b32 v13, 65568, v11
    ds_read_b128 v[132:135], v13 offset:0
    ds_read_b128 a[12:15], v14 offset:288
    s_add_u32 m0, s27, 19456
    s_add_u32 s29, s46, 30720
    buffer_load_dwordx4 v1, s[4:7], s29 offen lds
    v_mfma_f32_32x32x16_bf16 v[32:47], a[44:47], v[124:127], v[32:47]
    ds_read_b64_tr_b16 a[16:17], v9 offset:2048
    ds_read_b64_tr_b16 a[18:19], v9 offset:2560
    s_add_u32 m0, s27, 32768
    s_add_u32 s29, s47, 0
    buffer_load_dwordx4 v0, s[4:7], s29 offen lds
    s_waitcnt lgkmcnt(4)
    v_mfma_f32_16x16x32_bf16 a[96:99], a[0:3], v[128:131], a[96:99]
    v_mfma_f32_4x4x4_16b_bf16 a[100:103], v[128:129], v[128:129], a[100:103]
    v_mfma_f32_4x4x4_16b_bf16 a[104:107], v[130:131], v[130:131], a[104:107]
    ds_read_b64_tr_b16 a[20:21], v10 offset:2048
    ds_read_b64_tr_b16 a[22:23], v10 offset:2560
    s_add_u32 m0, s27, 33792
    s_add_u32 s29, s47, 10240
    buffer_load_dwordx4 v1, s[4:7], s29 offen lds
    v_mfma_f32_32x32x16_bf16 v[16:31], a[4:7], v[128:131], v[16:31]
    v_xor_b32 v12, 65600, v11
    ds_read_b128 v[136:139], v12 offset:0
    ds_read_b128 a[24:27], v14 offset:320
    s_add_u32 m0, s27, 34816
    s_add_u32 s29, s47, 20480
    buffer_load_dwordx4 v0, s[4:7], s29 offen lds
    v_mfma_f32_32x32x16_bf16 v[32:47], a[8:11], v[128:131], v[32:47]
    ds_read_b64_tr_b16 a[28:29], v9 offset:4096
    ds_read_b64_tr_b16 a[30:31], v9 offset:4608
    s_add_u32 m0, s27, 35840
    s_add_u32 s29, s47, 30720
    buffer_load_dwordx4 v1, s[4:7], s29 offen lds
    s_waitcnt lgkmcnt(4)
    v_mfma_f32_16x16x32_bf16 a[96:99], a[12:15], v[132:135], a[96:99]
    v_mfma_f32_4x4x4_16b_bf16 a[100:103], v[132:133], v[132:133], a[100:103]
    v_mfma_f32_4x4x4_16b_bf16 a[104:107], v[134:135], v[134:135], a[104:107]
    ds_read_b64_tr_b16 a[32:33], v10 offset:4096
    ds_read_b64_tr_b16 a[34:35], v10 offset:4608
    s_add_u32 m0, s27, 49152
    s_add_u32 s30, s56, s32
    buffer_load_dwordx4 v4, s[8:11], s30 offen offset:0 lds
    v_mfma_f32_32x32x16_bf16 v[16:31], a[16:19], v[132:135], v[16:31]
    v_xor_b32 v13, 65632, v11
    ds_read_b128 v[140:143], v13 offset:0
    ds_read_b128 a[36:39], v14 offset:352
    buffer_load_dwordx4 v5, s[8:11], s30 offen offset:1024 lds
    v_mfma_f32_32x32x16_bf16 v[32:47], a[20:23], v[132:135], v[32:47]
    ds_read_b64_tr_b16 a[40:41], v9 offset:6144
    ds_read_b64_tr_b16 a[42:43], v9 offset:6656
    buffer_load_dwordx4 v6, s[8:11], s30 offen offset:2048 lds
    s_waitcnt lgkmcnt(4)
    v_mfma_f32_16x16x32_bf16 a[96:99], a[24:27], v[136:139], a[96:99]
    v_mfma_f32_4x4x4_16b_bf16 a[100:103], v[136:137], v[136:137], a[100:103]
    v_mfma_f32_4x4x4_16b_bf16 a[104:107], v[138:139], v[138:139], a[104:107]
    ds_read_b64_tr_b16 a[44:45], v10 offset:6144
    ds_read_b64_tr_b16 a[46:47], v10 offset:6656
    buffer_load_dwordx4 v7, s[8:11], s30 offen offset:3072 lds
    v_mfma_f32_32x32x16_bf16 v[16:31], a[28:31], v[136:139], v[16:31]
    v_xor_b32 v12, 65536, v11
    ds_read_b128 v[144:147], v12 offset:16384
    ds_read_b128 a[0:3], v14 offset:384
    v_mfma_f32_32x32x16_bf16 v[32:47], a[32:35], v[136:139], v[32:47]
    ds_read_b64_tr_b16 a[4:5], v9 offset:8192
    ds_read_b64_tr_b16 a[6:7], v9 offset:8704
    s_waitcnt lgkmcnt(4)
    v_mfma_f32_16x16x32_bf16 a[96:99], a[36:39], v[140:143], a[96:99]
    v_mfma_f32_4x4x4_16b_bf16 a[100:103], v[140:141], v[140:141], a[100:103]
    v_mfma_f32_4x4x4_16b_bf16 a[104:107], v[142:143], v[142:143], a[104:107]
    ds_read_b64_tr_b16 a[8:9], v10 offset:8192
    ds_read_b64_tr_b16 a[10:11], v10 offset:8704
    v_mfma_f32_32x32x16_bf16 v[16:31], a[40:43], v[140:143], v[16:31]
    v_xor_b32 v13, 65568, v11
    ds_read_b128 v[148:151], v13 offset:16384
    ds_read_b128 a[12:15], v14 offset:416
    v_mfma_f32_32x32x16_bf16 v[32:47], a[44:47], v[140:143], v[32:47]
    ds_read_b64_tr_b16 a[16:17], v9 offset:10240
    ds_read_b64_tr_b16 a[18:19], v9 offset:10752
    s_waitcnt lgkmcnt(4)
    v_mfma_f32_16x16x32_bf16 a[96:99], a[0:3], v[144:147], a[96:99]
    v_mfma_f32_4x4x4_16b_bf16 a[100:103], v[144:145], v[144:145], a[100:103]
    v_mfma_f32_4x4x4_16b_bf16 a[104:107], v[146:147], v[146:147], a[104:107]
    ds_read_b64_tr_b16 a[20:21], v10 offset:10240
    ds_read_b64_tr_b16 a[22:23], v10 offset:10752
    v_mfma_f32_32x32x16_bf16 v[16:31], a[4:7], v[144:147], v[16:31]
    v_xor_b32 v12, 65600, v11
    ds_read_b128 v[152:155], v12 offset:16384
    ds_read_b128 a[24:27], v14 offset:448
    v_mfma_f32_32x32x16_bf16 v[32:47], a[8:11], v[144:147], v[32:47]
    ds_read_b64_tr_b16 a[28:29], v9 offset:12288
    ds_read_b64_tr_b16 a[30:31], v9 offset:12800
    s_waitcnt lgkmcnt(4)
    v_mfma_f32_16x16x32_bf16 a[96:99], a[12:15], v[148:151], a[96:99]
    v_mfma_f32_4x4x4_16b_bf16 a[100:103], v[148:149], v[148:149], a[100:103]
    v_mfma_f32_4x4x4_16b_bf16 a[104:107], v[150:151], v[150:151], a[104:107]
    ds_read_b64_tr_b16 a[32:33], v10 offset:12288
    ds_read_b64_tr_b16 a[34:35], v10 offset:12800
    v_mfma_f32_32x32x16_bf16 v[16:31], a[16:19], v[148:151], v[16:31]
    v_xor_b32 v13, 65632, v11
    ds_read_b128 v[156:159], v13 offset:16384
    ds_read_b128 a[36:39], v14 offset:480
    v_mfma_f32_32x32x16_bf16 v[32:47], a[20:23], v[148:151], v[32:47]
    ds_read_b64_tr_b16 a[40:41], v9 offset:14336
    ds_read_b64_tr_b16 a[42:43], v9 offset:14848
    s_waitcnt lgkmcnt(4)
    v_mfma_f32_16x16x32_bf16 a[96:99], a[24:27], v[152:155], a[96:99]
    v_mfma_f32_4x4x4_16b_bf16 a[100:103], v[152:153], v[152:153], a[100:103]
    v_mfma_f32_4x4x4_16b_bf16 a[104:107], v[154:155], v[154:155], a[104:107]
    ds_read_b64_tr_b16 a[44:45], v10 offset:14336
    ds_read_b64_tr_b16 a[46:47], v10 offset:14848
    v_mfma_f32_32x32x16_bf16 v[16:31], a[28:31], v[152:155], v[16:31]
    s_waitcnt vmcnt(12) lgkmcnt(0)
    s_barrier
    v_xor_b32 v12, 65536, v11
    ds_read_b128 v[160:163], v12 offset:49152
    ds_read_b128 a[0:3], v14 offset:512
    s_add_u32 m0, s27, 65536
    s_add_u32 s29, s48, 0
    buffer_load_dwordx4 v0, s[4:7], s29 offen lds
    v_mfma_f32_32x32x16_bf16 v[32:47], a[32:35], v[152:155], v[32:47]
    ds_read_b64_tr_b16 a[4:5], v9 offset:49152
    ds_read_b64_tr_b16 a[6:7], v9 offset:49664
    s_add_u32 m0, s27, 66560
    s_add_u32 s29, s48, 10240
    buffer_load_dwordx4 v1, s[4:7], s29 offen lds
    v_mfma_f32_16x16x32_bf16 a[96:99], a[36:39], v[156:159], a[96:99]
    v_mfma_f32_4x4x4_16b_bf16 a[100:103], v[156:157], v[156:157], a[100:103]
    v_mfma_f32_4x4x4_16b_bf16 a[104:107], v[158:159], v[158:159], a[104:107]
    ds_read_b64_tr_b16 a[8:9], v10 offset:49152
    ds_read_b64_tr_b16 a[10:11], v10 offset:49664
    s_add_u32 m0, s27, 67584
    s_add_u32 s29, s48, 20480
    buffer_load_dwordx4 v0, s[4:7], s29 offen lds
    v_mfma_f32_32x32x16_bf16 v[16:31], a[40:43], v[156:159], v[16:31]
    v_xor_b32 v13, 65568, v11
    ds_read_b128 v[164:167], v13 offset:49152
    ds_read_b128 a[12:15], v14 offset:544
    s_add_u32 m0, s27, 68608
    s_add_u32 s29, s48, 30720
    buffer_load_dwordx4 v1, s[4:7], s29 offen lds
    v_mfma_f32_32x32x16_bf16 v[32:47], a[44:47], v[156:159], v[32:47]
    ds_read_b64_tr_b16 a[16:17], v9 offset:51200
    ds_read_b64_tr_b16 a[18:19], v9 offset:51712
    s_add_u32 m0, s27, 81920
    s_add_u32 s29, s49, 0
    buffer_load_dwordx4 v0, s[4:7], s29 offen lds
    s_waitcnt lgkmcnt(4)
    v_mfma_f32_16x16x32_bf16 a[96:99], a[0:3], v[160:163], a[96:99]
    v_mfma_f32_4x4x4_16b_bf16 a[100:103], v[160:161], v[160:161], a[100:103]
    v_mfma_f32_4x4x4_16b_bf16 a[104:107], v[162:163], v[162:163], a[104:107]
    ds_read_b64_tr_b16 a[20:21], v10 offset:51200
    ds_read_b64_tr_b16 a[22:23], v10 offset:51712
    s_add_u32 m0, s27, 82944
    s_add_u32 s29, s49, 10240
    buffer_load_dwordx4 v1, s[4:7], s29 offen lds
    v_mfma_f32_32x32x16_bf16 v[16:31], a[4:7], v[160:163], v[16:31]
    v_xor_b32 v12, 65600, v11
    ds_read_b128 v[168:171], v12 offset:49152
    ds_read_b128 a[24:27], v14 offset:576
    s_add_u32 m0, s27, 83968
    s_add_u32 s29, s49, 20480
    buffer_load_dwordx4 v0, s[4:7], s29 offen lds
    v_mfma_f32_32x32x16_bf16 v[32:47], a[8:11], v[160:163], v[32:47]
    ds_read_b64_tr_b16 a[28:29], v9 offset:53248
    ds_read_b64_tr_b16 a[30:31], v9 offset:53760
    s_add_u32 m0, s27, 84992
    s_add_u32 s29, s49, 30720
    buffer_load_dwordx4 v1, s[4:7], s29 offen lds
    s_waitcnt lgkmcnt(4)
    v_mfma_f32_16x16x32_bf16 a[96:99], a[12:15], v[164:167], a[96:99]
    v_mfma_f32_4x4x4_16b_bf16 a[100:103], v[164:165], v[164:165], a[100:103]
    v_mfma_f32_4x4x4_16b_bf16 a[104:107], v[166:167], v[166:167], a[104:107]
    ds_read_b64_tr_b16 a[32:33], v10 offset:53248
    ds_read_b64_tr_b16 a[34:35], v10 offset:53760
    s_add_u32 m0, s27, 98304
    s_add_u32 s30, s58, s32
    buffer_load_dwordx4 v4, s[8:11], s30 offen offset:0 lds
    v_mfma_f32_32x32x16_bf16 v[16:31], a[16:19], v[164:167], v[16:31]
    v_xor_b32 v13, 65632, v11
    ds_read_b128 v[172:175], v13 offset:49152
    ds_read_b128 a[36:39], v14 offset:608
    buffer_load_dwordx4 v5, s[8:11], s30 offen offset:1024 lds
    v_mfma_f32_32x32x16_bf16 v[32:47], a[20:23], v[164:167], v[32:47]
    ds_read_b64_tr_b16 a[40:41], v9 offset:55296
    ds_read_b64_tr_b16 a[42:43], v9 offset:55808
    buffer_load_dwordx4 v6, s[8:11], s30 offen offset:2048 lds
    s_waitcnt lgkmcnt(4)
    v_mfma_f32_16x16x32_bf16 a[96:99], a[24:27], v[168:171], a[96:99]
    v_mfma_f32_4x4x4_16b_bf16 a[100:103], v[168:169], v[168:169], a[100:103]
    v_mfma_f32_4x4x4_16b_bf16 a[104:107], v[170:171], v[170:171], a[104:107]
    ds_read_b64_tr_b16 a[44:45], v10 offset:55296
    ds_read_b64_tr_b16 a[46:47], v10 offset:55808
    buffer_load_dwordx4 v7, s[8:11], s30 offen offset:3072 lds
    v_mfma_f32_32x32x16_bf16 v[16:31], a[28:31], v[168:171], v[16:31]
    v_xor_b32 v12, 131072, v11
    ds_read_b128 v[176:179], v12 offset:0
    ds_read_b128 a[0:3], v14 offset:640
    v_mfma_f32_32x32x16_bf16 v[32:47], a[32:35], v[168:171], v[32:47]
    ds_read_b64_tr_b16 a[4:5], v9 offset:57344
    ds_read_b64_tr_b16 a[6:7], v9 offset:57856
    s_waitcnt lgkmcnt(4)
    v_mfma_f32_16x16x32_bf16 a[96:99], a[36:39], v[172:175], a[96:99]
    v_mfma_f32_4x4x4_16b_bf16 a[100:103], v[172:173], v[172:173], a[100:103]
    v_mfma_f32_4x4x4_16b_bf16 a[104:107], v[174:175], v[174:175], a[104:107]
    ds_read_b64_tr_b16 a[8:9], v10 offset:57344
    ds_read_b64_tr_b16 a[10:11], v10 offset:57856
    v_mfma_f32_32x32x16_bf16 v[16:31], a[40:43], v[172:175], v[16:31]
    v_xor_b32 v13, 131104, v11
    ds_read_b128 v[180:183], v13 offset:0
    ds_read_b128 a[12:15], v14 offset:672
    v_mfma_f32_32x32x16_bf16 v[32:47], a[44:47], v[172:175], v[32:47]
    ds_read_b64_tr_b16 a[16:17], v9 offset:59392
    ds_read_b64_tr_b16 a[18:19], v9 offset:59904
    s_waitcnt lgkmcnt(4)
    v_mfma_f32_16x16x32_bf16 a[96:99], a[0:3], v[176:179], a[96:99]
    v_mfma_f32_4x4x4_16b_bf16 a[100:103], v[176:177], v[176:177], a[100:103]
    v_mfma_f32_4x4x4_16b_bf16 a[104:107], v[178:179], v[178:179], a[104:107]
    ds_read_b64_tr_b16 a[20:21], v10 offset:59392
    ds_read_b64_tr_b16 a[22:23], v10 offset:59904
    v_mfma_f32_32x32x16_bf16 v[16:31], a[4:7], v[176:179], v[16:31]
    v_xor_b32 v12, 131136, v11
    ds_read_b128 v[184:187], v12 offset:0
    ds_read_b128 a[24:27], v14 offset:704
    v_mfma_f32_32x32x16_bf16 v[32:47], a[8:11], v[176:179], v[32:47]
    ds_read_b64_tr_b16 a[28:29], v9 offset:61440
    ds_read_b64_tr_b16 a[30:31], v9 offset:61952
    s_waitcnt lgkmcnt(4)
    v_mfma_f32_16x16x32_bf16 a[96:99], a[12:15], v[180:183], a[96:99]
    v_mfma_f32_4x4x4_16b_bf16 a[100:103], v[180:181], v[180:181], a[100:103]
    v_mfma_f32_4x4x4_16b_bf16 a[104:107], v[182:183], v[182:183], a[104:107]
    ds_read_b64_tr_b16 a[32:33], v10 offset:61440
    ds_read_b64_tr_b16 a[34:35], v10 offset:61952
    v_mfma_f32_32x32x16_bf16 v[16:31], a[16:19], v[180:183], v[16:31]
    v_xor_b32 v13, 131168, v11
    ds_read_b128 v[188:191], v13 offset:0
    ds_read_b128 a[36:39], v14 offset:736
    v_mfma_f32_32x32x16_bf16 v[32:47], a[20:23], v[180:183], v[32:47]
    ds_read_b64_tr_b16 a[40:41], v9 offset:63488
    ds_read_b64_tr_b16 a[42:43], v9 offset:64000
    s_waitcnt lgkmcnt(4)
    v_mfma_f32_16x16x32_bf16 a[96:99], a[24:27], v[184:187], a[96:99]
    v_mfma_f32_4x4x4_16b_bf16 a[100:103], v[184:185], v[184:185], a[100:103]
    v_mfma_f32_4x4x4_16b_bf16 a[104:107], v[186:187], v[186:187], a[104:107]
    ds_read_b64_tr_b16 a[44:45], v10 offset:63488
    ds_read_b64_tr_b16 a[46:47], v10 offset:64000
    v_mfma_f32_32x32x16_bf16 v[16:31], a[28:31], v[184:187], v[16:31]
    s_waitcnt vmcnt(12) lgkmcnt(0)
    s_barrier
    v_xor_b32 v12, 0, v11
    ds_read_b128 v[192:195], v12 offset:16384
    ds_read_b128 a[0:3], v14 offset:768
    v_accvgpr_read_b32 v4, a112
    v_accvgpr_read_b32 v5, a113
    v_accvgpr_read_b32 v6, a114
    v_accvgpr_read_b32 v7, a115
    s_add_u32 m0, s27, 114688
    s_add_u32 s30, s60, s33
    buffer_load_dwordx4 v4, s[12:15], s30 offen offset:0 lds
    v_mfma_f32_32x32x16_bf16 v[32:47], a[32:35], v[184:187], v[32:47]
    v_add_u32 v9, 4294918144, v9
    ds_read_b64_tr_b16 a[4:5], v9 offset:0
    ds_read_b64_tr_b16 a[6:7], v9 offset:512
    buffer_load_dwordx4 v5, s[12:15], s30 offen offset:1024 lds
    v_mfma_f32_16x16x32_bf16 a[96:99], a[36:39], v[188:191], a[96:99]
    v_mfma_f32_4x4x4_16b_bf16 a[100:103], v[188:189], v[188:189], a[100:103]
    v_mfma_f32_4x4x4_16b_bf16 a[104:107], v[190:191], v[190:191], a[104:107]
    v_add_u32 v10, 4294918144, v10
    ds_read_b64_tr_b16 a[8:9], v10 offset:0
    ds_read_b64_tr_b16 a[10:11], v10 offset:512
    buffer_load_dwordx4 v6, s[12:15], s30 offen offset:2048 lds
    v_mfma_f32_32x32x16_bf16 v[16:31], a[40:43], v[188:191], v[16:31]
    v_xor_b32 v13, 32, v11
    ds_read_b128 v[196:199], v13 offset:16384
    ds_read_b128 a[12:15], v14 offset:800
    buffer_load_dwordx4 v7, s[12:15], s30 offen offset:3072 lds
    v_mfma_f32_32x32x16_bf16 v[32:47], a[44:47], v[188:191], v[32:47]
    ds_read_b64_tr_b16 a[16:17], v9 offset:2048
    ds_read_b64_tr_b16 a[18:19], v9 offset:2560
    s_add_u32 m0, s27, 131072
    s_add_u32 s30, s61, s33
    buffer_load_dwordx4 v4, s[12:15], s30 offen offset:0 lds
    s_waitcnt lgkmcnt(4)
    v_mfma_f32_16x16x32_bf16 a[96:99], a[0:3], v[192:195], a[96:99]
    v_mfma_f32_4x4x4_16b_bf16 a[100:103], v[192:193], v[192:193], a[100:103]
    v_mfma_f32_4x4x4_16b_bf16 a[104:107], v[194:195], v[194:195], a[104:107]
    ds_read_b64_tr_b16 a[20:21], v10 offset:2048
    ds_read_b64_tr_b16 a[22:23], v10 offset:2560
    buffer_load_dwordx4 v5, s[12:15], s30 offen offset:1024 lds
    v_mfma_f32_32x32x16_bf16 v[16:31], a[4:7], v[192:195], v[16:31]
    v_xor_b32 v12, 64, v11
    ds_read_b128 v[200:203], v12 offset:16384
    ds_read_b128 a[24:27], v14 offset:832
    buffer_load_dwordx4 v6, s[12:15], s30 offen offset:2048 lds
    v_mfma_f32_32x32x16_bf16 v[32:47], a[8:11], v[192:195], v[32:47]
    ds_read_b64_tr_b16 a[28:29], v9 offset:4096
    ds_read_b64_tr_b16 a[30:31], v9 offset:4608
    buffer_load_dwordx4 v7, s[12:15], s30 offen offset:3072 lds
    s_waitcnt lgkmcnt(4)
    v_mfma_f32_16x16x32_bf16 a[96:99], a[12:15], v[196:199], a[96:99]
    v_mfma_f32_4x4x4_16b_bf16 a[100:103], v[196:197], v[196:197], a[100:103]
    v_mfma_f32_4x4x4_16b_bf16 a[104:107], v[198:199], v[198:199], a[104:107]
    ds_read_b64_tr_b16 a[32:33], v10 offset:4096
    ds_read_b64_tr_b16 a[34:35], v10 offset:4608
    s_add_u32 m0, s27, 147456
    s_add_u32 s30, s62, s33
    buffer_load_dwordx4 v4, s[12:15], s30 offen offset:0 lds
    v_mfma_f32_32x32x16_bf16 v[16:31], a[16:19], v[196:199], v[16:31]
    v_xor_b32 v13, 96, v11
    ds_read_b128 v[204:207], v13 offset:16384
    ds_read_b128 a[36:39], v14 offset:864
    buffer_load_dwordx4 v5, s[12:15], s30 offen offset:1024 lds
    v_mfma_f32_32x32x16_bf16 v[32:47], a[20:23], v[196:199], v[32:47]
    ds_read_b64_tr_b16 a[40:41], v9 offset:6144
    ds_read_b64_tr_b16 a[42:43], v9 offset:6656
    buffer_load_dwordx4 v6, s[12:15], s30 offen offset:2048 lds
    s_waitcnt lgkmcnt(4)
    v_mfma_f32_16x16x32_bf16 a[96:99], a[24:27], v[200:203], a[96:99]
    v_mfma_f32_4x4x4_16b_bf16 a[100:103], v[200:201], v[200:201], a[100:103]
    v_mfma_f32_4x4x4_16b_bf16 a[104:107], v[202:203], v[202:203], a[104:107]
    ds_read_b64_tr_b16 a[44:45], v10 offset:6144
    ds_read_b64_tr_b16 a[46:47], v10 offset:6656
    buffer_load_dwordx4 v7, s[12:15], s30 offen offset:3072 lds
    v_mfma_f32_32x32x16_bf16 v[16:31], a[28:31], v[200:203], v[16:31]
    v_xor_b32 v12, 0, v11
    ds_read_b128 v[208:211], v12 offset:32768
    ds_read_b128 a[0:3], v14 offset:896
    v_mfma_f32_32x32x16_bf16 v[32:47], a[32:35], v[200:203], v[32:47]
    ds_read_b64_tr_b16 a[4:5], v9 offset:8192
    ds_read_b64_tr_b16 a[6:7], v9 offset:8704
    s_waitcnt lgkmcnt(4)
    v_mfma_f32_16x16x32_bf16 a[96:99], a[36:39], v[204:207], a[96:99]
    v_mfma_f32_4x4x4_16b_bf16 a[100:103], v[204:205], v[204:205], a[100:103]
    v_mfma_f32_4x4x4_16b_bf16 a[104:107], v[206:207], v[206:207], a[104:107]
    ds_read_b64_tr_b16 a[8:9], v10 offset:8192
    ds_read_b64_tr_b16 a[10:11], v10 offset:8704
    v_mfma_f32_32x32x16_bf16 v[16:31], a[40:43], v[204:207], v[16:31]
    v_xor_b32 v13, 32, v11
    ds_read_b128 v[212:215], v13 offset:32768
    ds_read_b128 a[12:15], v14 offset:928
    v_mfma_f32_32x32x16_bf16 v[32:47], a[44:47], v[204:207], v[32:47]
    ds_read_b64_tr_b16 a[16:17], v9 offset:10240
    ds_read_b64_tr_b16 a[18:19], v9 offset:10752
    s_waitcnt lgkmcnt(4)
    v_mfma_f32_16x16x32_bf16 a[96:99], a[0:3], v[208:211], a[96:99]
    v_mfma_f32_4x4x4_16b_bf16 a[100:103], v[208:209], v[208:209], a[100:103]
    v_mfma_f32_4x4x4_16b_bf16 a[104:107], v[210:211], v[210:211], a[104:107]
    ds_read_b64_tr_b16 a[20:21], v10 offset:10240
    ds_read_b64_tr_b16 a[22:23], v10 offset:10752
    v_mfma_f32_32x32x16_bf16 v[16:31], a[4:7], v[208:211], v[16:31]
    v_xor_b32 v12, 64, v11
    ds_read_b128 v[216:219], v12 offset:32768
    ds_read_b128 a[24:27], v14 offset:960
    v_mfma_f32_32x32x16_bf16 v[32:47], a[8:11], v[208:211], v[32:47]
    ds_read_b64_tr_b16 a[28:29], v9 offset:12288
    ds_read_b64_tr_b16 a[30:31], v9 offset:12800
    s_waitcnt lgkmcnt(4)
    v_mfma_f32_16x16x32_bf16 a[96:99], a[12:15], v[212:215], a[96:99]
    v_mfma_f32_4x4x4_16b_bf16 a[100:103], v[212:213], v[212:213], a[100:103]
    v_mfma_f32_4x4x4_16b_bf16 a[104:107], v[214:215], v[214:215], a[104:107]
    ds_read_b64_tr_b16 a[32:33], v10 offset:12288
    ds_read_b64_tr_b16 a[34:35], v10 offset:12800
    v_mfma_f32_32x32x16_bf16 v[16:31], a[16:19], v[212:215], v[16:31]
    v_xor_b32 v13, 96, v11
    ds_read_b128 v[220:223], v13 offset:32768
    ds_read_b128 a[36:39], v14 offset:992
    v_mfma_f32_32x32x16_bf16 v[32:47], a[20:23], v[212:215], v[32:47]
    ds_read_b64_tr_b16 a[40:41], v9 offset:14336
    ds_read_b64_tr_b16 a[42:43], v9 offset:14848
    s_waitcnt lgkmcnt(4)
    v_mfma_f32_16x16x32_bf16 a[96:99], a[24:27], v[216:219], a[96:99]
    v_mfma_f32_4x4x4_16b_bf16 a[100:103], v[216:217], v[216:217], a[100:103]
    v_mfma_f32_4x4x4_16b_bf16 a[104:107], v[218:219], v[218:219], a[104:107]
    ds_read_b64_tr_b16 a[44:45], v10 offset:14336
    ds_read_b64_tr_b16 a[46:47], v10 offset:14848
    v_mfma_f32_32x32x16_bf16 v[16:31], a[28:31], v[216:219], v[16:31]
    s_waitcnt vmcnt(12) lgkmcnt(0)
    s_barrier
    v_xor_b32 v12, 65536, v11
    ds_read_b128 v[224:227], v12 offset:0
    ds_read_b128 a[0:3], v14 offset:1024
    s_add_u32 m0, s27, 16384
    s_add_u32 s30, s63, s33
    buffer_load_dwordx4 v4, s[12:15], s30 offen offset:0 lds
    v_mfma_f32_32x32x16_bf16 v[32:47], a[32:35], v[216:219], v[32:47]
    ds_read_b64_tr_b16 a[4:5], v9 offset:49152
    ds_read_b64_tr_b16 a[6:7], v9 offset:49664
    buffer_load_dwordx4 v5, s[12:15], s30 offen offset:1024 lds
    v_mfma_f32_16x16x32_bf16 a[96:99], a[36:39], v[220:223], a[96:99]
    v_mfma_f32_4x4x4_16b_bf16 a[100:103], v[220:221], v[220:221], a[100:103]
    v_mfma_f32_4x4x4_16b_bf16 a[104:107], v[222:223], v[222:223], a[104:107]
    ds_read_b64_tr_b16 a[8:9], v10 offset:49152
    ds_read_b64_tr_b16 a[10:11], v10 offset:49664
    buffer_load_dwordx4 v6, s[12:15], s30 offen offset:2048 lds
    v_mfma_f32_32x32x16_bf16 v[16:31], a[40:43], v[220:223], v[16:31]
    v_xor_b32 v13, 65568, v11
    ds_read_b128 v[228:231], v13 offset:0
    ds_read_b128 a[12:15], v14 offset:1056
    buffer_load_dwordx4 v7, s[12:15], s30 offen offset:3072 lds
    v_mfma_f32_32x32x16_bf16 v[32:47], a[44:47], v[220:223], v[32:47]
    ds_read_b64_tr_b16 a[16:17], v9 offset:51200
    ds_read_b64_tr_b16 a[18:19], v9 offset:51712
    s_add_u32 m0, s27, 32768
    s_add_u32 s30, s64, s33
    buffer_load_dwordx4 v4, s[12:15], s30 offen offset:0 lds
    s_waitcnt lgkmcnt(4)
    v_mfma_f32_16x16x32_bf16 a[96:99], a[0:3], v[224:227], a[96:99]
    v_mfma_f32_4x4x4_16b_bf16 a[100:103], v[224:225], v[224:225], a[100:103]
    v_mfma_f32_4x4x4_16b_bf16 a[104:107], v[226:227], v[226:227], a[104:107]
    ds_read_b64_tr_b16 a[20:21], v10 offset:51200
    ds_read_b64_tr_b16 a[22:23], v10 offset:51712
    buffer_load_dwordx4 v5, s[12:15], s30 offen offset:1024 lds
    v_mfma_f32_32x32x16_bf16 v[16:31], a[4:7], v[224:227], v[16:31]
    v_xor_b32 v12, 65600, v11
    ds_read_b128 v[232:235], v12 offset:0
    ds_read_b128 a[24:27], v14 offset:1088
    buffer_load_dwordx4 v6, s[12:15], s30 offen offset:2048 lds
    v_mfma_f32_32x32x16_bf16 v[32:47], a[8:11], v[224:227], v[32:47]
    ds_read_b64_tr_b16 a[28:29], v9 offset:53248
    ds_read_b64_tr_b16 a[30:31], v9 offset:53760
    buffer_load_dwordx4 v7, s[12:15], s30 offen offset:3072 lds
    s_waitcnt lgkmcnt(4)
    v_mfma_f32_16x16x32_bf16 a[96:99], a[12:15], v[228:231], a[96:99]
    v_mfma_f32_4x4x4_16b_bf16 a[100:103], v[228:229], v[228:229], a[100:103]
    v_mfma_f32_4x4x4_16b_bf16 a[104:107], v[230:231], v[230:231], a[104:107]
    ds_read_b64_tr_b16 a[32:33], v10 offset:53248
    ds_read_b64_tr_b16 a[34:35], v10 offset:53760
    s_add_u32 m0, s27, 49152
    s_add_u32 s30, s60, s34
    buffer_load_dwordx4 v4, s[12:15], s30 offen offset:0 lds
    v_mfma_f32_32x32x16_bf16 v[16:31], a[16:19], v[228:231], v[16:31]
    v_xor_b32 v13, 65632, v11
    ds_read_b128 v[236:239], v13 offset:0
    ds_read_b128 a[36:39], v14 offset:1120
    buffer_load_dwordx4 v5, s[12:15], s30 offen offset:1024 lds
    v_mfma_f32_32x32x16_bf16 v[32:47], a[20:23], v[228:231], v[32:47]
    ds_read_b64_tr_b16 a[40:41], v9 offset:55296
    ds_read_b64_tr_b16 a[42:43], v9 offset:55808
    buffer_load_dwordx4 v6, s[12:15], s30 offen offset:2048 lds
    s_waitcnt lgkmcnt(4)
    v_mfma_f32_16x16x32_bf16 a[96:99], a[24:27], v[232:235], a[96:99]
    v_mfma_f32_4x4x4_16b_bf16 a[100:103], v[232:233], v[232:233], a[100:103]
    v_mfma_f32_4x4x4_16b_bf16 a[104:107], v[234:235], v[234:235], a[104:107]
    ds_read_b64_tr_b16 a[44:45], v10 offset:55296
    ds_read_b64_tr_b16 a[46:47], v10 offset:55808
    buffer_load_dwordx4 v7, s[12:15], s30 offen offset:3072 lds
    v_mfma_f32_32x32x16_bf16 v[16:31], a[28:31], v[232:235], v[16:31]
    v_xor_b32 v12, 65536, v11
    ds_read_b128 v[240:243], v12 offset:16384
    ds_read_b128 a[0:3], v14 offset:1152
    v_mfma_f32_32x32x16_bf16 v[32:47], a[32:35], v[232:235], v[32:47]
    ds_read_b64_tr_b16 a[4:5], v9 offset:57344
    ds_read_b64_tr_b16 a[6:7], v9 offset:57856
    s_waitcnt lgkmcnt(4)
    v_mfma_f32_16x16x32_bf16 a[96:99], a[36:39], v[236:239], a[96:99]
    v_mfma_f32_4x4x4_16b_bf16 a[100:103], v[236:237], v[236:237], a[100:103]
    v_mfma_f32_4x4x4_16b_bf16 a[104:107], v[238:239], v[238:239], a[104:107]
    ds_read_b64_tr_b16 a[8:9], v10 offset:57344
    ds_read_b64_tr_b16 a[10:11], v10 offset:57856
    v_mfma_f32_32x32x16_bf16 v[16:31], a[40:43], v[236:239], v[16:31]
    v_xor_b32 v13, 65568, v11
    ds_read_b128 v[244:247], v13 offset:16384
    ds_read_b128 a[12:15], v14 offset:1184
    v_mfma_f32_32x32x16_bf16 v[32:47], a[44:47], v[236:239], v[32:47]
    ds_read_b64_tr_b16 a[16:17], v9 offset:59392
    ds_read_b64_tr_b16 a[18:19], v9 offset:59904
    s_waitcnt lgkmcnt(4)
    v_mfma_f32_16x16x32_bf16 a[96:99], a[0:3], v[240:243], a[96:99]
    v_mfma_f32_4x4x4_16b_bf16 a[100:103], v[240:241], v[240:241], a[100:103]
    v_mfma_f32_4x4x4_16b_bf16 a[104:107], v[242:243], v[242:243], a[104:107]
    ds_read_b64_tr_b16 a[20:21], v10 offset:59392
    ds_read_b64_tr_b16 a[22:23], v10 offset:59904
    v_mfma_f32_32x32x16_bf16 v[16:31], a[4:7], v[240:243], v[16:31]
    v_xor_b32 v12, 65600, v11
    ds_read_b128 v[248:251], v12 offset:16384
    ds_read_b128 a[24:27], v14 offset:1216
    v_mfma_f32_32x32x16_bf16 v[32:47], a[8:11], v[240:243], v[32:47]
    ds_read_b64_tr_b16 a[28:29], v9 offset:61440
    ds_read_b64_tr_b16 a[30:31], v9 offset:61952
    s_waitcnt lgkmcnt(4)
    v_mfma_f32_16x16x32_bf16 a[96:99], a[12:15], v[244:247], a[96:99]
    v_mfma_f32_4x4x4_16b_bf16 a[100:103], v[244:245], v[244:245], a[100:103]
    v_mfma_f32_4x4x4_16b_bf16 a[104:107], v[246:247], v[246:247], a[104:107]
    ds_read_b64_tr_b16 a[32:33], v10 offset:61440
    ds_read_b64_tr_b16 a[34:35], v10 offset:61952
    v_mfma_f32_32x32x16_bf16 v[16:31], a[16:19], v[244:247], v[16:31]
    v_xor_b32 v13, 65632, v11
    ds_read_b128 v[252:255], v13 offset:16384
    ds_read_b128 a[36:39], v14 offset:1248
    v_mfma_f32_32x32x16_bf16 v[32:47], a[20:23], v[244:247], v[32:47]
    ds_read_b64_tr_b16 a[40:41], v9 offset:63488
    ds_read_b64_tr_b16 a[42:43], v9 offset:64000
    s_waitcnt lgkmcnt(4)
    v_mfma_f32_16x16x32_bf16 a[96:99], a[24:27], v[248:251], a[96:99]
    v_mfma_f32_4x4x4_16b_bf16 a[100:103], v[248:249], v[248:249], a[100:103]
    v_mfma_f32_4x4x4_16b_bf16 a[104:107], v[250:251], v[250:251], a[104:107]
    ds_read_b64_tr_b16 a[44:45], v10 offset:63488
    ds_read_b64_tr_b16 a[46:47], v10 offset:64000
    v_mfma_f32_32x32x16_bf16 v[16:31], a[28:31], v[248:251], v[16:31]
    v_mfma_f32_32x32x16_bf16 v[32:47], a[32:35], v[248:251], v[32:47]
    s_waitcnt lgkmcnt(0)
    v_mfma_f32_16x16x32_bf16 a[96:99], a[36:39], v[252:255], a[96:99]
    v_mfma_f32_4x4x4_16b_bf16 a[100:103], v[252:253], v[252:253], a[100:103]
    v_mfma_f32_4x4x4_16b_bf16 a[104:107], v[254:255], v[254:255], a[104:107]
    v_mfma_f32_32x32x16_bf16 v[16:31], a[40:43], v[252:255], v[16:31]
    v_mfma_f32_32x32x16_bf16 v[32:47], a[44:47], v[252:255], v[32:47]
    buffer_load_dwordx4 a[244:247], off, s[96:99], 0 sc1
    s_barrier
    s_add_u32 m0, s27, 65536
    s_add_u32 s30, s61, s34
    buffer_load_dwordx4 v4, s[12:15], s30 offen offset:0 lds
    buffer_load_dwordx4 v5, s[12:15], s30 offen offset:1024 lds
    buffer_load_dwordx4 v6, s[12:15], s30 offen offset:2048 lds
    buffer_load_dwordx4 v7, s[12:15], s30 offen offset:3072 lds
    s_add_u32 m0, s27, 81920
    s_add_u32 s30, s62, s34
    buffer_load_dwordx4 v4, s[12:15], s30 offen offset:0 lds
    buffer_load_dwordx4 v5, s[12:15], s30 offen offset:1024 lds
    buffer_load_dwordx4 v6, s[12:15], s30 offen offset:2048 lds
    buffer_load_dwordx4 v7, s[12:15], s30 offen offset:3072 lds
    s_add_u32 m0, s27, 98304
    s_add_u32 s30, s63, s34
    buffer_load_dwordx4 v4, s[12:15], s30 offen offset:0 lds
    buffer_load_dwordx4 v5, s[12:15], s30 offen offset:1024 lds
    buffer_load_dwordx4 v6, s[12:15], s30 offen offset:2048 lds
    buffer_load_dwordx4 v7, s[12:15], s30 offen offset:3072 lds
    s_nop 3
    v_accvgpr_read_b32 v80, a96
    v_accvgpr_read_b32 v81, a97
    v_accvgpr_read_b32 v82, a98
    v_accvgpr_read_b32 v83, a99
    v_accvgpr_read_b32 v84, a100
    v_accvgpr_read_b32 v85, a101
    v_accvgpr_read_b32 v86, a102
    v_accvgpr_read_b32 v87, a103
    v_accvgpr_read_b32 v88, a104
    v_accvgpr_read_b32 v89, a105
    v_accvgpr_read_b32 v90, a106
    v_accvgpr_read_b32 v91, a107
    v_add_f32 v84, v84, v88
    v_add_f32 v85, v85, v89
    v_add_f32 v86, v86, v90
    v_add_f32 v87, v87, v91
    v_and_b32 v13, 16, v3
    v_cmp_ne_u32 vcc, 0, v13
    v_and_b32 v13, 1, v3
    v_cmp_ne_u32 s[74:75], 0, v13
    v_cndmask_b32 v11, v80, v81, vcc
    v_cndmask_b32 v12, v82, v83, vcc
    v_and_b32 v13, 2, v3
    v_cmp_ne_u32 vcc, 0, v13
    v_cndmask_b32 v84, v84, v85, s[74:75]
    v_cndmask_b32 v86, v86, v87, s[74:75]
    v_cndmask_b32 v2, v84, v86, vcc
    v_mov_b32 v3, v2
    s_nop 1
    v_permlane32_swap_b32 v2, v3
    v_mul_f32 v12, 0x3acccccd, v12
    v_add_f32 v2, v2, v3
    v_mul_f32 v2, 0x3acccccd, v2
    v_fma_f32 v2, -v12, v12, v2
    v_max_f32 v2, 0, v2
    v_add_f32 v2, 0x3727c5ac, v2
    v_sqrt_f32 v13, v2
    v_mul_f32 v11, s66, v11
    v_exp_f32 v14, v11
    v_exp_f32_e64 v11, -v11
    v_rcp_f32 v15, v13
    v_add_f32 v14, 1.0, v14
    v_add_f32 v11, 1.0, v11
    v_min_f32 v14, 0x6f000000, v14
    v_rcp_f32 v11, v11
    v_mul_f32 v3, v14, v13
    v_mul_f32 v1, 0xc0135761, v15
    v_mul_f32 v2, v15, v15
    v_mul_f32 v2, v2, v1
    v_mul_f32 v2, 0x3d372713, v2
    v_mbcnt_lo_u32_b32 v14, -1, 0
    v_mbcnt_hi_u32_b32 v14, -1, v14
    v_cmp_gt_u32 vcc, 32, v14
    v_and_b32 v14, 31, v14
    v_lshlrev_b32 v14, 2, v14
    buffer_store_dword v11, v14, s[16:19], s69 offen sc1
    v_and_b32 v15, 0xffff0000, v13
    v_sub_f32 v13, v13, v15
    v_cndmask_b32 v13, v13, v15, vcc
    v_lshrrev_b32 v13, 16, v13
    v_accvgpr_write_b32 a80, v13
    v_accvgpr_read_b32 v0, a116
    v_sub_f32 v80, 0, v12
    v_sub_f32 v81, 0, v12
    v_sub_f32 v82, 0, v12
    v_sub_f32 v83, 0, v12
    v_sub_f32 v84, 0, v12
    v_sub_f32 v85, 0, v12
    v_sub_f32 v86, 0, v12
    v_sub_f32 v87, 0, v12
    v_sub_f32 v88, 0, v12
    v_sub_f32 v89, 0, v12
    v_sub_f32 v90, 0, v12
    v_sub_f32 v91, 0, v12
    v_sub_f32 v92, 0, v12
    v_sub_f32 v93, 0, v12
    v_sub_f32 v94, 0, v12
    v_sub_f32 v95, 0, v12
    v_add_u32 v8, 0x1000, v0
    s_nop 1
    v_mfma_f32_32x32x16_bf16 v[48:63], a[84:87], v[96:99], v[80:95]
    s_nop 1
    v_mfma_f32_32x32x16_bf16 v[48:63], a[88:91], v[100:103], v[48:63]
    v_mfma_f32_32x32x16_bf16 v[64:79], a[84:87], v[104:107], v[80:95]
    v_mul_f32_e64 v11, v16, s66
    v_mul_f32_e64 v12, v17, s66
    v_mul_f32_e64 v13, v18, s66
    v_mul_f32_e64 v14, v19, s66
    v_exp_f32_e64 v11, v11 clamp
    s_nop 5
    v_mfma_f32_32x32x16_bf16 v[64:79], a[88:91], v[108:111], v[64:79]
    v_cvt_pk_bf16_f32 v96, v48, v49
    v_cvt_pk_bf16_f32 v97, v50, v51
    v_cvt_pk_bf16_f32 v98, v52, v53
    v_cvt_pk_bf16_f32 v99, v54, v55
    v_cvt_pk_bf16_f32 v100, v56, v57
    v_cvt_pk_bf16_f32 v101, v58, v59
    v_cvt_pk_bf16_f32 v102, v60, v61
    v_cvt_pk_bf16_f32 v103, v62, v63
    v_mfma_f32_32x32x16_bf16 v[48:63], a[84:87], v[112:115], v[80:95]
    v_exp_f32_e64 v12, v12 clamp
    v_exp_f32_e64 v13, v13 clamp
    v_exp_f32_e64 v14, v14 clamp
    v_max_f32_e64 v16, v16, 0
    v_max_f32_e64 v17, v17, 0
    v_mfma_f32_32x32x16_bf16 v[48:63], a[88:91], v[116:119], v[48:63]
    v_cvt_pk_bf16_f32 v104, v64, v65
    v_cvt_pk_bf16_f32 v105, v66, v67
    v_cvt_pk_bf16_f32 v106, v68, v69
    v_cvt_pk_bf16_f32 v107, v70, v71
    v_cvt_pk_bf16_f32 v108, v72, v73
    v_cvt_pk_bf16_f32 v109, v74, v75
    v_cvt_pk_bf16_f32 v110, v76, v77
    v_cvt_pk_bf16_f32 v111, v78, v79
    v_mfma_f32_32x32x16_bf16 v[64:79], a[84:87], v[120:123], v[80:95]
    v_max_f32_e64 v18, v18, 0
    v_max_f32_e64 v19, v19, 0
    v_add_f32_e64 v11, v11, s67
    v_add_f32_e64 v12, v12, s67
    v_add_f32_e64 v13, v13, s67
    v_mfma_f32_32x32x16_bf16 v[64:79], a[88:91], v[124:127], v[64:79]
    v_cvt_pk_bf16_f32 v112, v48, v49
    v_cvt_pk_bf16_f32 v113, v50, v51
    v_cvt_pk_bf16_f32 v114, v52, v53
    v_cvt_pk_bf16_f32 v115, v54, v55
    v_cvt_pk_bf16_f32 v116, v56, v57
    v_cvt_pk_bf16_f32 v117, v58, v59
    v_cvt_pk_bf16_f32 v118, v60, v61
    v_cvt_pk_bf16_f32 v119, v62, v63
    v_mfma_f32_32x32x16_bf16 v[48:63], a[84:87], v[128:131], v[80:95]
    v_add_f32_e64 v14, v14, s67
    v_add_f32_e64 v16, v16, v11
    v_add_f32_e64 v17, v17, v12
    v_add_f32_e64 v18, v18, v13
    v_add_f32_e64 v19, v19, v14
    v_mfma_f32_32x32x16_bf16 v[48:63], a[88:91], v[132:135], v[48:63]
    v_cvt_pk_bf16_f32 v120, v64, v65
    v_cvt_pk_bf16_f32 v121, v66, v67
    v_cvt_pk_bf16_f32 v122, v68, v69
    v_cvt_pk_bf16_f32 v123, v70, v71
    v_cvt_pk_bf16_f32 v124, v72, v73
    v_cvt_pk_bf16_f32 v125, v74, v75
    v_cvt_pk_bf16_f32 v126, v76, v77
    v_cvt_pk_bf16_f32 v127, v78, v79
    v_mfma_f32_32x32x16_bf16 v[64:79], a[84:87], v[136:139], v[80:95]
    v_cvt_pk_bf16_f32 v16, v16, v17
    v_cvt_pk_bf16_f32 v17, v18, v19
    v_mul_f32_e64 v11, v20, s66
    v_mul_f32_e64 v12, v21, s66
    v_mul_f32_e64 v13, v22, s66
    v_mfma_f32_32x32x16_bf16 v[64:79], a[88:91], v[140:143], v[64:79]
    v_cvt_pk_bf16_f32 v128, v48, v49
    v_cvt_pk_bf16_f32 v129, v50, v51
    v_cvt_pk_bf16_f32 v130, v52, v53
    v_cvt_pk_bf16_f32 v131, v54, v55
    v_cvt_pk_bf16_f32 v132, v56, v57
    v_cvt_pk_bf16_f32 v133, v58, v59
    v_cvt_pk_bf16_f32 v134, v60, v61
    v_cvt_pk_bf16_f32 v135, v62, v63
    v_mfma_f32_32x32x16_bf16 v[48:63], a[84:87], v[144:147], v[80:95]
    v_mul_f32_e64 v14, v23, s66
    v_exp_f32_e64 v11, v11 clamp
    v_exp_f32_e64 v12, v12 clamp
    v_exp_f32_e64 v13, v13 clamp
    v_exp_f32_e64 v14, v14 clamp
    v_mfma_f32_32x32x16_bf16 v[48:63], a[88:91], v[148:151], v[48:63]
    v_cvt_pk_bf16_f32 v136, v64, v65
    v_cvt_pk_bf16_f32 v137, v66, v67
    v_cvt_pk_bf16_f32 v138, v68, v69
    v_cvt_pk_bf16_f32 v139, v70, v71
    v_cvt_pk_bf16_f32 v140, v72, v73
    v_cvt_pk_bf16_f32 v141, v74, v75
    v_cvt_pk_bf16_f32 v142, v76, v77
    v_cvt_pk_bf16_f32 v143, v78, v79
    v_mfma_f32_32x32x16_bf16 v[64:79], a[84:87], v[152:155], v[80:95]
    v_max_f32_e64 v20, v20, 0
    v_max_f32_e64 v21, v21, 0
    v_max_f32_e64 v22, v22, 0
    v_max_f32_e64 v23, v23, 0
    v_add_f32_e64 v11, v11, s67
    v_mfma_f32_32x32x16_bf16 v[64:79], a[88:91], v[156:159], v[64:79]
    v_cvt_pk_bf16_f32 v144, v48, v49
    v_cvt_pk_bf16_f32 v145, v50, v51
    v_cvt_pk_bf16_f32 v146, v52, v53
    v_cvt_pk_bf16_f32 v147, v54, v55
    v_cvt_pk_bf16_f32 v148, v56, v57
    v_cvt_pk_bf16_f32 v149, v58, v59
    v_cvt_pk_bf16_f32 v150, v60, v61
    v_cvt_pk_bf16_f32 v151, v62, v63
    v_mfma_f32_32x32x16_bf16 v[48:63], a[84:87], v[160:163], v[80:95]
    v_add_f32_e64 v12, v12, s67
    v_add_f32_e64 v13, v13, s67
    v_add_f32_e64 v14, v14, s67
    v_add_f32_e64 v20, v20, v11
    v_add_f32_e64 v21, v21, v12
    v_mfma_f32_32x32x16_bf16 v[48:63], a[88:91], v[164:167], v[48:63]
    v_cvt_pk_bf16_f32 v152, v64, v65
    v_cvt_pk_bf16_f32 v153, v66, v67
    v_cvt_pk_bf16_f32 v154, v68, v69
    v_cvt_pk_bf16_f32 v155, v70, v71
    v_cvt_pk_bf16_f32 v156, v72, v73
    v_cvt_pk_bf16_f32 v157, v74, v75
    v_cvt_pk_bf16_f32 v158, v76, v77
    v_cvt_pk_bf16_f32 v159, v78, v79
    v_mfma_f32_32x32x16_bf16 v[64:79], a[84:87], v[168:171], v[80:95]
    v_add_f32_e64 v22, v22, v13
    v_add_f32_e64 v23, v23, v14
    v_cvt_pk_bf16_f32 v18, v20, v21
    v_cvt_pk_bf16_f32 v19, v22, v23
    buffer_store_dwordx4 v[16:19], v0, s[16:19], s36 offen offset:0 sc1
    v_mfma_f32_32x32x16_bf16 v[64:79], a[88:91], v[172:175], v[64:79]
    v_cvt_pk_bf16_f32 v160, v48, v49
    v_cvt_pk_bf16_f32 v161, v50, v51
    v_cvt_pk_bf16_f32 v162, v52, v53
    v_cvt_pk_bf16_f32 v163, v54, v55
    v_cvt_pk_bf16_f32 v164, v56, v57
    v_cvt_pk_bf16_f32 v165, v58, v59
    v_cvt_pk_bf16_f32 v166, v60, v61
    v_cvt_pk_bf16_f32 v167, v62, v63
    v_mfma_f32_32x32x16_bf16 v[48:63], a[84:87], v[176:179], v[80:95]
    v_mul_f32_e64 v11, v24, s66
    v_mul_f32_e64 v12, v25, s66
    v_mul_f32_e64 v13, v26, s66
    v_mul_f32_e64 v14, v27, s66
    v_exp_f32_e64 v11, v11 clamp
    v_mfma_f32_32x32x16_bf16 v[48:63], a[88:91], v[180:183], v[48:63]
    v_cvt_pk_bf16_f32 v168, v64, v65
    v_cvt_pk_bf16_f32 v169, v66, v67
    v_cvt_pk_bf16_f32 v170, v68, v69
    v_cvt_pk_bf16_f32 v171, v70, v71
    v_cvt_pk_bf16_f32 v172, v72, v73
    v_cvt_pk_bf16_f32 v173, v74, v75
    v_cvt_pk_bf16_f32 v174, v76, v77
    v_cvt_pk_bf16_f32 v175, v78, v79
    v_mfma_f32_32x32x16_bf16 v[64:79], a[84:87], v[184:187], v[80:95]
    v_exp_f32_e64 v12, v12 clamp
    v_exp_f32_e64 v13, v13 clamp
    v_exp_f32_e64 v14, v14 clamp
    v_max_f32_e64 v24, v24, 0
    v_max_f32_e64 v25, v25, 0
    v_mfma_f32_32x32x16_bf16 v[64:79], a[88:91], v[188:191], v[64:79]
    v_cvt_pk_bf16_f32 v176, v48, v49
    v_cvt_pk_bf16_f32 v177, v50, v51
    v_cvt_pk_bf16_f32 v178, v52, v53
    v_cvt_pk_bf16_f32 v179, v54, v55
    v_cvt_pk_bf16_f32 v180, v56, v57
    v_cvt_pk_bf16_f32 v181, v58, v59
    v_cvt_pk_bf16_f32 v182, v60, v61
    v_cvt_pk_bf16_f32 v183, v62, v63
    v_mfma_f32_32x32x16_bf16 v[48:63], a[84:87], v[192:195], v[80:95]
    v_max_f32_e64 v26, v26, 0
    v_max_f32_e64 v27, v27, 0
    v_add_f32_e64 v11, v11, s67
    v_add_f32_e64 v12, v12, s67
    v_add_f32_e64 v13, v13, s67
    v_mfma_f32_32x32x16_bf16 v[48:63], a[88:91], v[196:199], v[48:63]
    v_cvt_pk_bf16_f32 v184, v64, v65
    v_cvt_pk_bf16_f32 v185, v66, v67
    v_cvt_pk_bf16_f32 v186, v68, v69
    v_cvt_pk_bf16_f32 v187, v70, v71
    v_cvt_pk_bf16_f32 v188, v72, v73
    v_cvt_pk_bf16_f32 v189, v74, v75
    v_cvt_pk_bf16_f32 v190, v76, v77
    v_cvt_pk_bf16_f32 v191, v78, v79
    v_mfma_f32_32x32x16_bf16 v[64:79], a[84:87], v[200:203], v[80:95]
    v_add_f32_e64 v14, v14, s67
    v_add_f32_e64 v24, v24, v11
    v_add_f32_e64 v25, v25, v12
    v_add_f32_e64 v26, v26, v13
    v_add_f32_e64 v27, v27, v14
    v_mfma_f32_32x32x16_bf16 v[64:79], a[88:91], v[204:207], v[64:79]
    v_cvt_pk_bf16_f32 v192, v48, v49
    v_cvt_pk_bf16_f32 v193, v50, v51
    v_cvt_pk_bf16_f32 v194, v52, v53
    v_cvt_pk_bf16_f32 v195, v54, v55
    v_cvt_pk_bf16_f32 v196, v56, v57
    v_cvt_pk_bf16_f32 v197, v58, v59
    v_cvt_pk_bf16_f32 v198, v60, v61
    v_cvt_pk_bf16_f32 v199, v62, v63
    v_mfma_f32_32x32x16_bf16 v[48:63], a[84:87], v[208:211], v[80:95]
    v_cvt_pk_bf16_f32 v20, v24, v25
    v_cvt_pk_bf16_f32 v21, v26, v27
    v_mul_f32_e64 v11, v28, s66
    v_mul_f32_e64 v12, v29, s66
    v_mul_f32_e64 v13, v30, s66
    v_mfma_f32_32x32x16_bf16 v[48:63], a[88:91], v[212:215], v[48:63]
    v_cvt_pk_bf16_f32 v200, v64, v65
    v_cvt_pk_bf16_f32 v201, v66, v67
    v_cvt_pk_bf16_f32 v202, v68, v69
    v_cvt_pk_bf16_f32 v203, v70, v71
    v_cvt_pk_bf16_f32 v204, v72, v73
    v_cvt_pk_bf16_f32 v205, v74, v75
    v_cvt_pk_bf16_f32 v206, v76, v77
    v_cvt_pk_bf16_f32 v207, v78, v79
    v_mfma_f32_32x32x16_bf16 v[64:79], a[84:87], v[216:219], v[80:95]
    v_mul_f32_e64 v14, v31, s66
    v_exp_f32_e64 v11, v11 clamp
    v_exp_f32_e64 v12, v12 clamp
    v_exp_f32_e64 v13, v13 clamp
    v_exp_f32_e64 v14, v14 clamp
    v_mfma_f32_32x32x16_bf16 v[64:79], a[88:91], v[220:223], v[64:79]
    v_cvt_pk_bf16_f32 v208, v48, v49
    v_cvt_pk_bf16_f32 v209, v50, v51
    v_cvt_pk_bf16_f32 v210, v52, v53
    v_cvt_pk_bf16_f32 v211, v54, v55
    v_cvt_pk_bf16_f32 v212, v56, v57
    v_cvt_pk_bf16_f32 v213, v58, v59
    v_cvt_pk_bf16_f32 v214, v60, v61
    v_cvt_pk_bf16_f32 v215, v62, v63
    v_mfma_f32_32x32x16_bf16 v[48:63], a[84:87], v[224:227], v[80:95]
    v_max_f32_e64 v28, v28, 0
    v_max_f32_e64 v29, v29, 0
    v_max_f32_e64 v30, v30, 0
    v_max_f32_e64 v31, v31, 0
    v_add_f32_e64 v11, v11, s67
    v_mfma_f32_32x32x16_bf16 v[48:63], a[88:91], v[228:231], v[48:63]
    v_cvt_pk_bf16_f32 v216, v64, v65
    v_cvt_pk_bf16_f32 v217, v66, v67
    v_cvt_pk_bf16_f32 v218, v68, v69
    v_cvt_pk_bf16_f32 v219, v70, v71
    v_cvt_pk_bf16_f32 v220, v72, v73
    v_cvt_pk_bf16_f32 v221, v74, v75
    v_cvt_pk_bf16_f32 v222, v76, v77
    v_cvt_pk_bf16_f32 v223, v78, v79
    v_mfma_f32_32x32x16_bf16 v[64:79], a[84:87], v[232:235], v[80:95]
    v_add_f32_e64 v12, v12, s67
    v_add_f32_e64 v13, v13, s67
    v_add_f32_e64 v14, v14, s67
    v_add_f32_e64 v28, v28, v11
    v_add_f32_e64 v29, v29, v12
    v_mfma_f32_32x32x16_bf16 v[64:79], a[88:91], v[236:239], v[64:79]
    v_cvt_pk_bf16_f32 v224, v48, v49
    v_cvt_pk_bf16_f32 v225, v50, v51
    v_cvt_pk_bf16_f32 v226, v52, v53
    v_cvt_pk_bf16_f32 v227, v54, v55
    v_cvt_pk_bf16_f32 v228, v56, v57
    v_cvt_pk_bf16_f32 v229, v58, v59
    v_cvt_pk_bf16_f32 v230, v60, v61
    v_cvt_pk_bf16_f32 v231, v62, v63
    v_mfma_f32_32x32x16_bf16 v[48:63], a[84:87], v[240:243], v[80:95]
    v_add_f32_e64 v30, v30, v13
    v_add_f32_e64 v31, v31, v14
    v_cvt_pk_bf16_f32 v22, v28, v29
    v_cvt_pk_bf16_f32 v23, v30, v31
    buffer_store_dwordx4 v[20:23], v0, s[16:19], s36 offen offset:512 sc1
    v_mfma_f32_32x32x16_bf16 v[48:63], a[88:91], v[244:247], v[48:63]
    v_cvt_pk_bf16_f32 v232, v64, v65
    v_cvt_pk_bf16_f32 v233, v66, v67
    v_cvt_pk_bf16_f32 v234, v68, v69
    v_cvt_pk_bf16_f32 v235, v70, v71
    v_cvt_pk_bf16_f32 v236, v72, v73
    v_cvt_pk_bf16_f32 v237, v74, v75
    v_cvt_pk_bf16_f32 v238, v76, v77
    v_cvt_pk_bf16_f32 v239, v78, v79
    v_mfma_f32_32x32x16_bf16 v[64:79], a[84:87], v[248:251], v[80:95]
    v_mul_f32_e64 v11, v32, s66
    v_mul_f32_e64 v12, v33, s66
    v_mul_f32_e64 v13, v34, s66
    v_mul_f32_e64 v14, v35, s66
    v_exp_f32_e64 v11, v11 clamp
    v_mfma_f32_32x32x16_bf16 v[64:79], a[88:91], v[252:255], v[64:79]
    v_cvt_pk_bf16_f32 v240, v48, v49
    v_cvt_pk_bf16_f32 v241, v50, v51
    v_cvt_pk_bf16_f32 v242, v52, v53
    v_cvt_pk_bf16_f32 v243, v54, v55
    v_cvt_pk_bf16_f32 v244, v56, v57
    v_cvt_pk_bf16_f32 v245, v58, v59
    v_cvt_pk_bf16_f32 v246, v60, v61
    v_cvt_pk_bf16_f32 v247, v62, v63
    s_nop 9
    v_cvt_pk_bf16_f32 v248, v64, v65
    v_cvt_pk_bf16_f32 v249, v66, v67
    v_cvt_pk_bf16_f32 v250, v68, v69
    v_cvt_pk_bf16_f32 v251, v70, v71
    v_cvt_pk_bf16_f32 v252, v72, v73
    v_cvt_pk_bf16_f32 v253, v74, v75
    v_cvt_pk_bf16_f32 v254, v76, v77
    v_cvt_pk_bf16_f32 v255, v78, v79
    s_waitcnt vmcnt(15)
    s_mov_b32 s75, 0
    s_branch K1_pA_c
K1_pA_l:
    s_sleep 8
    buffer_load_dwordx4 a[244:247], off, s[96:99], 0 sc1
    s_add_u32 s75, s75, 1
    s_waitcnt vmcnt(0)
    s_cmp_ge_u32 s75, 0x20000
    s_cbranch_scc1 K1_pA_ok
K1_pA_c:
    v_accvgpr_read_b32 v15, a244
    s_nop 1
    v_readfirstlane_b32 s74, v15
    s_bfe_u32 s74, s74, 524288
    s_cmp_ge_u32 s74, 32
    s_cbranch_scc0 K1_pA_l
K1_pA_ok:
    s_barrier
    v_add_u32 v9, 65536, v9
    ds_read_b64_tr_b16 a[0:1], v9 offset:0
    ds_read_b64_tr_b16 a[2:3], v9 offset:512
    v_add_u32 v10, 65536, v10
    ds_read_b64_tr_b16 a[4:5], v10 offset:0
    ds_read_b64_tr_b16 a[6:7], v10 offset:512
    ds_read_b64_tr_b16 a[8:9], v9 offset:2048
    ds_read_b64_tr_b16 a[10:11], v9 offset:2560
    ds_read_b64_tr_b16 a[12:13], v10 offset:2048
    ds_read_b64_tr_b16 a[14:15], v10 offset:2560
    ds_read_b64_tr_b16 a[16:17], v9 offset:4096
    ds_read_b64_tr_b16 a[18:19], v9 offset:4608
    s_waitcnt lgkmcnt(6)
    v_mfma_f32_32x32x16_bf16 v[48:63], a[64:67], a[80:83], 0
    ds_read_b64_tr_b16 a[20:21], v10 offset:4096
    ds_read_b64_tr_b16 a[22:23], v10 offset:4608
    v_exp_f32_e64 v12, v12 clamp
    v_exp_f32_e64 v13, v13 clamp
    v_mfma_f32_32x32x16_bf16 v[64:79], a[66:69], a[80:83], 0
    ds_read_b64_tr_b16 a[24:25], v9 offset:6144
    ds_read_b64_tr_b16 a[26:27], v9 offset:6656
    v_exp_f32_e64 v14, v14 clamp
    v_max_f32_e64 v32, v32, 0
    v_mfma_f32_32x32x16_bf16 v[48:63], a[0:3], v[96:99], v[48:63]
    ds_read_b64_tr_b16 a[28:29], v10 offset:6144
    ds_read_b64_tr_b16 a[30:31], v10 offset:6656
    v_max_f32_e64 v33, v33, 0
    v_max_f32_e64 v34, v34, 0
    v_mfma_f32_32x32x16_bf16 v[64:79], a[4:7], v[96:99], v[64:79]
    ds_read_b64_tr_b16 a[32:33], v9 offset:8192
    ds_read_b64_tr_b16 a[34:35], v9 offset:8704
    v_max_f32_e64 v35, v35, 0
    v_add_f32_e64 v11, v11, s67
    s_waitcnt lgkmcnt(6)
    v_mfma_f32_32x32x16_bf16 v[48:63], a[8:11], v[100:103], v[48:63]
    ds_read_b64_tr_b16 a[36:37], v10 offset:8192
    ds_read_b64_tr_b16 a[38:39], v10 offset:8704
    v_add_f32_e64 v12, v12, s67
    v_add_f32_e64 v13, v13, s67
    v_mfma_f32_32x32x16_bf16 v[64:79], a[12:15], v[100:103], v[64:79]
    ds_read_b64_tr_b16 a[40:41], v9 offset:10240
    ds_read_b64_tr_b16 a[42:43], v9 offset:10752
    v_add_f32_e64 v14, v14, s67
    v_add_f32_e64 v32, v32, v11
    v_mfma_f32_32x32x16_bf16 v[48:63], a[16:19], v[104:107], v[48:63]
    ds_read_b64_tr_b16 a[44:45], v10 offset:10240
    ds_read_b64_tr_b16 a[46:47], v10 offset:10752
    v_add_f32_e64 v33, v33, v12
    v_add_f32_e64 v34, v34, v13
    v_mfma_f32_32x32x16_bf16 v[64:79], a[20:23], v[104:107], v[64:79]
    ds_read_b64_tr_b16 a[0:1], v9 offset:12288
    ds_read_b64_tr_b16 a[2:3], v9 offset:12800
    v_add_f32_e64 v35, v35, v14
    v_cvt_pk_bf16_f32 v32, v32, v33
    s_waitcnt lgkmcnt(6)
    v_mfma_f32_32x32x16_bf16 v[48:63], a[24:27], v[108:111], v[48:63]
    ds_read_b64_tr_b16 a[4:5], v10 offset:12288
    ds_read_b64_tr_b16 a[6:7], v10 offset:12800
    v_cvt_pk_bf16_f32 v33, v34, v35
    v_mul_f32_e64 v11, v36, s66
    v_mfma_f32_32x32x16_bf16 v[64:79], a[28:31], v[108:111], v[64:79]
    ds_read_b64_tr_b16 a[8:9], v9 offset:14336
    ds_read_b64_tr_b16 a[10:11], v9 offset:14848
    v_mul_f32_e64 v12, v37, s66
    v_mul_f32_e64 v13, v38, s66
    v_mfma_f32_32x32x16_bf16 v[48:63], a[32:35], v[112:115], v[48:63]
    ds_read_b64_tr_b16 a[12:13], v10 offset:14336
    ds_read_b64_tr_b16 a[14:15], v10 offset:14848
    v_mul_f32_e64 v14, v39, s66
    v_exp_f32_e64 v11, v11 clamp
    v_mfma_f32_32x32x16_bf16 v[64:79], a[36:39], v[112:115], v[64:79]
    s_barrier
    ds_read_b64_tr_b16 a[16:17], v9 offset:16384
    ds_read_b64_tr_b16 a[18:19], v9 offset:16896
    v_exp_f32_e64 v12, v12 clamp
    v_exp_f32_e64 v13, v13 clamp
    s_waitcnt lgkmcnt(6)
    v_mfma_f32_32x32x16_bf16 v[48:63], a[40:43], v[116:119], v[48:63]
    ds_read_b64_tr_b16 a[20:21], v10 offset:16384
    ds_read_b64_tr_b16 a[22:23], v10 offset:16896
    v_exp_f32_e64 v14, v14 clamp
    v_max_f32_e64 v36, v36, 0
    v_mfma_f32_32x32x16_bf16 v[64:79], a[44:47], v[116:119], v[64:79]
    ds_read_b64_tr_b16 a[24:25], v9 offset:18432
    ds_read_b64_tr_b16 a[26:27], v9 offset:18944
    v_max_f32_e64 v37, v37, 0
    v_max_f32_e64 v38, v38, 0
    v_mfma_f32_32x32x16_bf16 v[48:63], a[0:3], v[120:123], v[48:63]
    ds_read_b64_tr_b16 a[28:29], v10 offset:18432
    ds_read_b64_tr_b16 a[30:31], v10 offset:18944
    v_max_f32_e64 v39, v39, 0
    v_add_f32_e64 v11, v11, s67
    v_mfma_f32_32x32x16_bf16 v[64:79], a[4:7], v[120:123], v[64:79]
    ds_read_b64_tr_b16 a[32:33], v9 offset:20480
    ds_read_b64_tr_b16 a[34:35], v9 offset:20992
    v_add_f32_e64 v12, v12, s67
    v_add_f32_e64 v13, v13, s67
    s_waitcnt lgkmcnt(6)
    v_mfma_f32_32x32x16_bf16 v[48:63], a[8:11], v[124:127], v[48:63]
    ds_read_b64_tr_b16 a[36:37], v10 offset:20480
    ds_read_b64_tr_b16 a[38:39], v10 offset:20992
    v_add_f32_e64 v14, v14, s67
    v_add_f32_e64 v36, v36, v11
    v_mfma_f32_32x32x16_bf16 v[64:79], a[12:15], v[124:127], v[64:79]
    ds_read_b64_tr_b16 a[40:41], v9 offset:22528
    ds_read_b64_tr_b16 a[42:43], v9 offset:23040
    v_add_f32_e64 v37, v37, v12
    v_add_f32_e64 v38, v38, v13
    v_mfma_f32_32x32x16_bf16 v[48:63], a[16:19], v[128:131], v[48:63]
    ds_read_b64_tr_b16 a[44:45], v10 offset:22528
    ds_read_b64_tr_b16 a[46:47], v10 offset:23040
    v_add_f32_e64 v39, v39, v14
    v_cvt_pk_bf16_f32 v34, v36, v37
    v_mfma_f32_32x32x16_bf16 v[64:79], a[20:23], v[128:131], v[64:79]
    ds_read_b64_tr_b16 a[0:1], v9 offset:24576
    ds_read_b64_tr_b16 a[2:3], v9 offset:25088
    v_cvt_pk_bf16_f32 v35, v38, v39
    buffer_store_dwordx4 v[32:35], v8, s[16:19], s36 offen offset:0 sc1
    s_waitcnt lgkmcnt(6)
    v_mfma_f32_32x32x16_bf16 v[48:63], a[24:27], v[132:135], v[48:63]
    ds_read_b64_tr_b16 a[4:5], v10 offset:24576
    ds_read_b64_tr_b16 a[6:7], v10 offset:25088
    v_mul_f32_e64 v11, v40, s66
    v_mul_f32_e64 v12, v41, s66
    v_mfma_f32_32x32x16_bf16 v[64:79], a[28:31], v[132:135], v[64:79]
    ds_read_b64_tr_b16 a[8:9], v9 offset:26624
    ds_read_b64_tr_b16 a[10:11], v9 offset:27136
    v_mul_f32_e64 v13, v42, s66
    v_mul_f32_e64 v14, v43, s66
    v_mfma_f32_32x32x16_bf16 v[48:63], a[32:35], v[136:139], v[48:63]
    ds_read_b64_tr_b16 a[12:13], v10 offset:26624
    ds_read_b64_tr_b16 a[14:15], v10 offset:27136
    v_exp_f32_e64 v11, v11 clamp
    v_exp_f32_e64 v12, v12 clamp
    v_mfma_f32_32x32x16_bf16 v[64:79], a[36:39], v[136:139], v[64:79]
    ds_read_b64_tr_b16 a[16:17], v9 offset:28672
    ds_read_b64_tr_b16 a[18:19], v9 offset:29184
    v_exp_f32_e64 v13, v13 clamp
    v_exp_f32_e64 v14, v14 clamp
    s_waitcnt lgkmcnt(6)
    v_mfma_f32_32x32x16_bf16 v[48:63], a[40:43], v[140:143], v[48:63]
    ds_read_b64_tr_b16 a[20:21], v10 offset:28672
    ds_read_b64_tr_b16 a[22:23], v10 offset:29184
    v_max_f32_e64 v40, v40, 0
    v_max_f32_e64 v41, v41, 0
    v_mfma_f32_32x32x16_bf16 v[64:79], a[44:47], v[140:143], v[64:79]
    ds_read_b64_tr_b16 a[24:25], v9 offset:30720
    ds_read_b64_tr_b16 a[26:27], v9 offset:31232
    v_max_f32_e64 v42, v42, 0
    v_mfma_f32_32x32x16_bf16 v[48:63], a[0:3], v[144:147], v[48:63]
    ds_read_b64_tr_b16 a[28:29], v10 offset:30720
    ds_read_b64_tr_b16 a[30:31], v10 offset:31232
    v_max_f32_e64 v43, v43, 0
    v_mfma_f32_32x32x16_bf16 v[64:79], a[4:7], v[144:147], v[64:79]
    s_barrier
    ds_read_b64_tr_b16 a[32:33], v9 offset:32768
    ds_read_b64_tr_b16 a[34:35], v9 offset:33280
    s_add_u32 m0, s27, 114688
    s_add_u32 s30, s64, s34
    buffer_load_dwordx4 v4, s[12:15], s30 offen offset:0 lds
    v_add_f32_e64 v11, v11, s67
    s_waitcnt lgkmcnt(6)
    v_mfma_f32_32x32x16_bf16 v[48:63], a[8:11], v[148:151], v[48:63]
    ds_read_b64_tr_b16 a[36:37], v10 offset:32768
    ds_read_b64_tr_b16 a[38:39], v10 offset:33280
    buffer_load_dwordx4 v5, s[12:15], s30 offen offset:1024 lds
    v_add_f32_e64 v12, v12, s67
    v_mfma_f32_32x32x16_bf16 v[64:79], a[12:15], v[148:151], v[64:79]
    ds_read_b64_tr_b16 a[40:41], v9 offset:34816
    ds_read_b64_tr_b16 a[42:43], v9 offset:35328
    buffer_load_dwordx4 v6, s[12:15], s30 offen offset:2048 lds
    v_add_f32_e64 v13, v13, s67
    v_mfma_f32_32x32x16_bf16 v[48:63], a[16:19], v[152:155], v[48:63]
    ds_read_b64_tr_b16 a[44:45], v10 offset:34816
    ds_read_b64_tr_b16 a[46:47], v10 offset:35328
    buffer_load_dwordx4 v7, s[12:15], s30 offen offset:3072 lds
    v_add_f32_e64 v14, v14, s67
    v_mfma_f32_32x32x16_bf16 v[64:79], a[20:23], v[152:155], v[64:79]
    ds_read_b64_tr_b16 a[0:1], v9 offset:36864
    ds_read_b64_tr_b16 a[2:3], v9 offset:37376
    v_add_f32_e64 v40, v40, v11
    s_waitcnt lgkmcnt(6)
    v_mfma_f32_32x32x16_bf16 v[48:63], a[24:27], v[156:159], v[48:63]
    ds_read_b64_tr_b16 a[4:5], v10 offset:36864
    ds_read_b64_tr_b16 a[6:7], v10 offset:37376
    v_add_f32_e64 v41, v41, v12
    v_mfma_f32_32x32x16_bf16 v[64:79], a[28:31], v[156:159], v[64:79]
    ds_read_b64_tr_b16 a[8:9], v9 offset:38912
    ds_read_b64_tr_b16 a[10:11], v9 offset:39424
    v_add_f32_e64 v42, v42, v13
    v_mfma_f32_32x32x16_bf16 v[48:63], a[32:35], v[160:163], v[48:63]
    ds_read_b64_tr_b16 a[12:13], v10 offset:38912
    ds_read_b64_tr_b16 a[14:15], v10 offset:39424
    v_add_f32_e64 v43, v43, v14
    v_mfma_f32_32x32x16_bf16 v[64:79], a[36:39], v[160:163], v[64:79]
    ds_read_b64_tr_b16 a[16:17], v9 offset:40960
    ds_read_b64_tr_b16 a[18:19], v9 offset:41472
    v_cvt_pk_bf16_f32 v36, v40, v41
    s_waitcnt lgkmcnt(6)
    v_mfma_f32_32x32x16_bf16 v[48:63], a[40:43], v[164:167], v[48:63]
    ds_read_b64_tr_b16 a[20:21], v10 offset:40960
    ds_read_b64_tr_b16 a[22:23], v10 offset:41472
    v_cvt_pk_bf16_f32 v37, v42, v43
    v_mfma_f32_32x32x16_bf16 v[64:79], a[44:47], v[164:167], v[64:79]
    ds_read_b64_tr_b16 a[24:25], v9 offset:43008
    ds_read_b64_tr_b16 a[26:27], v9 offset:43520
    v_mul_f32_e64 v11, v44, s66
    v_mfma_f32_32x32x16_bf16 v[48:63], a[0:3], v[168:171], v[48:63]
    ds_read_b64_tr_b16 a[28:29], v10 offset:43008
    ds_read_b64_tr_b16 a[30:31], v10 offset:43520
    v_mul_f32_e64 v12, v45, s66
    v_mfma_f32_32x32x16_bf16 v[64:79], a[4:7], v[168:171], v[64:79]
    ds_read_b64_tr_b16 a[32:33], v9 offset:45056
    ds_read_b64_tr_b16 a[34:35], v9 offset:45568
    v_mul_f32_e64 v13, v46, s66
    s_waitcnt lgkmcnt(6)
    v_mfma_f32_32x32x16_bf16 v[48:63], a[8:11], v[172:175], v[48:63]
    ds_read_b64_tr_b16 a[36:37], v10 offset:45056
    ds_read_b64_tr_b16 a[38:39], v10 offset:45568
    v_mul_f32_e64 v14, v47, s66
    v_mfma_f32_32x32x16_bf16 v[64:79], a[12:15], v[172:175], v[64:79]
    ds_read_b64_tr_b16 a[40:41], v9 offset:47104
    ds_read_b64_tr_b16 a[42:43], v9 offset:47616
    v_exp_f32_e64 v11, v11 clamp
    v_mfma_f32_32x32x16_bf16 v[48:63], a[16:19], v[176:179], v[48:63]
    ds_read_b64_tr_b16 a[44:45], v10 offset:47104
    ds_read_b64_tr_b16 a[46:47], v10 offset:47616
    v_exp_f32_e64 v12, v12 clamp
    v_mfma_f32_32x32x16_bf16 v[64:79], a[20:23], v[176:179], v[64:79]
    s_barrier
    v_add_u32 v9, 4294868992, v9
    ds_read_b64_tr_b16 a[0:1], v9 offset:0
    ds_read_b64_tr_b16 a[2:3], v9 offset:512
    s_add_u32 m0, s27, 131072
    s_add_u32 s30, s60, s35
    buffer_load_dwordx4 v4, s[12:15], s30 offen offset:0 lds
    v_exp_f32_e64 v13, v13 clamp
    s_waitcnt lgkmcnt(6)
    v_mfma_f32_32x32x16_bf16 v[48:63], a[24:27], v[180:183], v[48:63]
    v_add_u32 v10, 4294868992, v10
    ds_read_b64_tr_b16 a[4:5], v10 offset:0
    ds_read_b64_tr_b16 a[6:7], v10 offset:512
    buffer_load_dwordx4 v5, s[12:15], s30 offen offset:1024 lds
    v_exp_f32_e64 v14, v14 clamp
    v_mfma_f32_32x32x16_bf16 v[64:79], a[28:31], v[180:183], v[64:79]
    ds_read_b64_tr_b16 a[8:9], v9 offset:2048
    ds_read_b64_tr_b16 a[10:11], v9 offset:2560
    buffer_load_dwordx4 v6, s[12:15], s30 offen offset:2048 lds
    v_max_f32_e64 v44, v44, 0
    v_mfma_f32_32x32x16_bf16 v[48:63], a[32:35], v[184:187], v[48:63]
    ds_read_b64_tr_b16 a[12:13], v10 offset:2048
    ds_read_b64_tr_b16 a[14:15], v10 offset:2560
    buffer_load_dwordx4 v7, s[12:15], s30 offen offset:3072 lds
    v_max_f32_e64 v45, v45, 0
    v_mfma_f32_32x32x16_bf16 v[64:79], a[36:39], v[184:187], v[64:79]
    ds_read_b64_tr_b16 a[16:17], v9 offset:4096
    ds_read_b64_tr_b16 a[18:19], v9 offset:4608
    v_max_f32_e64 v46, v46, 0
    s_waitcnt lgkmcnt(6)
    v_mfma_f32_32x32x16_bf16 v[48:63], a[40:43], v[188:191], v[48:63]
    ds_read_b64_tr_b16 a[20:21], v10 offset:4096
    ds_read_b64_tr_b16 a[22:23], v10 offset:4608
    v_max_f32_e64 v47, v47, 0
    v_mfma_f32_32x32x16_bf16 v[64:79], a[44:47], v[188:191], v[64:79]
    ds_read_b64_tr_b16 a[24:25], v9 offset:6144
    ds_read_b64_tr_b16 a[26:27], v9 offset:6656
    v_add_f32_e64 v11, v11, s67
    v_mfma_f32_32x32x16_bf16 v[48:63], a[0:3], v[192:195], v[48:63]
    ds_read_b64_tr_b16 a[28:29], v10 offset:6144
    ds_read_b64_tr_b16 a[30:31], v10 offset:6656
    v_add_f32_e64 v12, v12, s67
    v_mfma_f32_32x32x16_bf16 v[64:79], a[4:7], v[192:195], v[64:79]
    ds_read_b64_tr_b16 a[32:33], v9 offset:8192
    ds_read_b64_tr_b16 a[34:35], v9 offset:8704
    v_add_f32_e64 v13, v13, s67
    s_waitcnt lgkmcnt(6)
    v_mfma_f32_32x32x16_bf16 v[48:63], a[8:11], v[196:199], v[48:63]
    ds_read_b64_tr_b16 a[36:37], v10 offset:8192
    ds_read_b64_tr_b16 a[38:39], v10 offset:8704
    v_add_f32_e64 v14, v14, s67
    v_mfma_f32_32x32x16_bf16 v[64:79], a[12:15], v[196:199], v[64:79]
    ds_read_b64_tr_b16 a[40:41], v9 offset:10240
    ds_read_b64_tr_b16 a[42:43], v9 offset:10752
    v_add_f32_e64 v44, v44, v11
    v_mfma_f32_32x32x16_bf16 v[48:63], a[16:19], v[200:203], v[48:63]
    ds_read_b64_tr_b16 a[44:45], v10 offset:10240
    ds_read_b64_tr_b16 a[46:47], v10 offset:10752
    v_add_f32_e64 v45, v45, v12
    v_mfma_f32_32x32x16_bf16 v[64:79], a[20:23], v[200:203], v[64:79]
    ds_read_b64_tr_b16 a[0:1], v9 offset:12288
    ds_read_b64_tr_b16 a[2:3], v9 offset:12800
    v_add_f32_e64 v46, v46, v13
    s_waitcnt lgkmcnt(6)
    v_mfma_f32_32x32x16_bf16 v[48:63], a[24:27], v[204:207], v[48:63]
    ds_read_b64_tr_b16 a[4:5], v10 offset:12288
    ds_read_b64_tr_b16 a[6:7], v10 offset:12800
    v_add_f32_e64 v47, v47, v14
    v_mfma_f32_32x32x16_bf16 v[64:79], a[28:31], v[204:207], v[64:79]
    ds_read_b64_tr_b16 a[8:9], v9 offset:14336
    ds_read_b64_tr_b16 a[10:11], v9 offset:14848
    v_cvt_pk_bf16_f32 v38, v44, v45
    v_mfma_f32_32x32x16_bf16 v[48:63], a[32:35], v[208:211], v[48:63]
    ds_read_b64_tr_b16 a[12:13], v10 offset:14336
    ds_read_b64_tr_b16 a[14:15], v10 offset:14848
    v_cvt_pk_bf16_f32 v39, v46, v47
    v_mfma_f32_32x32x16_bf16 v[64:79], a[36:39], v[208:211], v[64:79]
    s_barrier
    ds_read_b64_tr_b16 a[16:17], v9 offset:16384
    ds_read_b64_tr_b16 a[18:19], v9 offset:16896
    s_add_u32 m0, s27, 147456
    s_add_u32 s30, s61, s35
    buffer_load_dwordx4 v4, s[12:15], s30 offen offset:0 lds
    buffer_store_dwordx4 v[36:39], v8, s[16:19], s36 offen offset:512 sc1
    s_waitcnt lgkmcnt(6)
    v_mfma_f32_32x32x16_bf16 v[48:63], a[40:43], v[212:215], v[48:63]
    ds_read_b64_tr_b16 a[20:21], v10 offset:16384
    ds_read_b64_tr_b16 a[22:23], v10 offset:16896
    buffer_load_dwordx4 v5, s[12:15], s30 offen offset:1024 lds
    v_mfma_f32_32x32x16_bf16 v[64:79], a[44:47], v[212:215], v[64:79]
    ds_read_b64_tr_b16 a[24:25], v9 offset:18432
    ds_read_b64_tr_b16 a[26:27], v9 offset:18944
    buffer_load_dwordx4 v6, s[12:15], s30 offen offset:2048 lds
    v_mfma_f32_32x32x16_bf16 v[48:63], a[0:3], v[216:219], v[48:63]
    ds_read_b64_tr_b16 a[28:29], v10 offset:18432
    ds_read_b64_tr_b16 a[30:31], v10 offset:18944
    buffer_load_dwordx4 v7, s[12:15], s30 offen offset:3072 lds
    v_mfma_f32_32x32x16_bf16 v[64:79], a[4:7], v[216:219], v[64:79]
    ds_read_b64_tr_b16 a[32:33], v9 offset:20480
    ds_read_b64_tr_b16 a[34:35], v9 offset:20992
    s_waitcnt lgkmcnt(6)
    v_mfma_f32_32x32x16_bf16 v[48:63], a[8:11], v[220:223], v[48:63]
    ds_read_b64_tr_b16 a[36:37], v10 offset:20480
    ds_read_b64_tr_b16 a[38:39], v10 offset:20992
    v_mfma_f32_32x32x16_bf16 v[64:79], a[12:15], v[220:223], v[64:79]
    ds_read_b64_tr_b16 a[40:41], v9 offset:22528
    ds_read_b64_tr_b16 a[42:43], v9 offset:23040
    v_mfma_f32_32x32x16_bf16 v[48:63], a[16:19], v[224:227], v[48:63]
    ds_read_b64_tr_b16 a[44:45], v10 offset:22528
    ds_read_b64_tr_b16 a[46:47], v10 offset:23040
    v_mfma_f32_32x32x16_bf16 v[64:79], a[20:23], v[224:227], v[64:79]
    ds_read_b64_tr_b16 a[0:1], v9 offset:24576
    ds_read_b64_tr_b16 a[2:3], v9 offset:25088
    s_waitcnt lgkmcnt(6)
    v_mfma_f32_32x32x16_bf16 v[48:63], a[24:27], v[228:231], v[48:63]
    ds_read_b64_tr_b16 a[4:5], v10 offset:24576
    ds_read_b64_tr_b16 a[6:7], v10 offset:25088
    v_mfma_f32_32x32x16_bf16 v[64:79], a[28:31], v[228:231], v[64:79]
    ds_read_b64_tr_b16 a[8:9], v9 offset:26624
    ds_read_b64_tr_b16 a[10:11], v9 offset:27136
    v_mfma_f32_32x32x16_bf16 v[48:63], a[32:35], v[232:235], v[48:63]
    ds_read_b64_tr_b16 a[12:13], v10 offset:26624
    ds_read_b64_tr_b16 a[14:15], v10 offset:27136
    v_mfma_f32_32x32x16_bf16 v[64:79], a[36:39], v[232:235], v[64:79]
    ds_read_b64_tr_b16 a[16:17], v9 offset:28672
    ds_read_b64_tr_b16 a[18:19], v9 offset:29184
    s_waitcnt lgkmcnt(6)
    v_mfma_f32_32x32x16_bf16 v[48:63], a[40:43], v[236:239], v[48:63]
    ds_read_b64_tr_b16 a[20:21], v10 offset:28672
    ds_read_b64_tr_b16 a[22:23], v10 offset:29184
    v_mfma_f32_32x32x16_bf16 v[64:79], a[44:47], v[236:239], v[64:79]
    ds_read_b64_tr_b16 a[24:25], v9 offset:30720
    ds_read_b64_tr_b16 a[26:27], v9 offset:31232
    v_mfma_f32_32x32x16_bf16 v[48:63], a[0:3], v[240:243], v[48:63]
    ds_read_b64_tr_b16 a[28:29], v10 offset:30720
    ds_read_b64_tr_b16 a[30:31], v10 offset:31232
    v_mfma_f32_32x32x16_bf16 v[64:79], a[4:7], v[240:243], v[64:79]
    s_waitcnt lgkmcnt(4)
    v_mfma_f32_32x32x16_bf16 v[48:63], a[8:11], v[244:247], v[48:63]
    v_mfma_f32_32x32x16_bf16 v[64:79], a[12:15], v[244:247], v[64:79]
    s_barrier
    ds_read_b64_tr_b16 a[32:33], v9 offset:32768
    ds_read_b64_tr_b16 a[34:35], v9 offset:33280
    s_add_u32 m0, s27, 16384
    s_add_u32 s30, s62, s35
    buffer_load_dwordx4 v4, s[12:15], s30 offen offset:0 lds
    v_mfma_f32_32x32x16_bf16 v[48:63], a[16:19], v[248:251], v[48:63]
    ds_read_b64_tr_b16 a[36:37], v10 offset:32768
    ds_read_b64_tr_b16 a[38:39], v10 offset:33280
    buffer_load_dwordx4 v5, s[12:15], s30 offen offset:1024 lds
    v_mfma_f32_32x32x16_bf16 v[64:79], a[20:23], v[248:251], v[64:79]
    ds_read_b64_tr_b16 a[40:41], v9 offset:34816
    ds_read_b64_tr_b16 a[42:43], v9 offset:35328
    buffer_load_dwordx4 v6, s[12:15], s30 offen offset:2048 lds
    s_waitcnt lgkmcnt(6)
    v_mfma_f32_32x32x16_bf16 v[48:63], a[24:27], v[252:255], v[48:63]
    ds_read_b64_tr_b16 a[44:45], v10 offset:34816
    ds_read_b64_tr_b16 a[46:47], v10 offset:35328
    buffer_load_dwordx4 v7, s[12:15], s30 offen offset:3072 lds
    v_mfma_f32_32x32x16_bf16 v[64:79], a[28:31], v[252:255], v[64:79]
    ds_read_b64_tr_b16 a[0:1], v9 offset:36864
    ds_read_b64_tr_b16 a[2:3], v9 offset:37376
    v_mfma_f32_32x32x16_bf16 v[16:31], a[68:71], a[80:83], 0
    ds_read_b64_tr_b16 a[4:5], v10 offset:36864
    ds_read_b64_tr_b16 a[6:7], v10 offset:37376
    v_mfma_f32_32x32x16_bf16 v[32:47], a[70:73], a[80:83], 0
    ds_read_b64_tr_b16 a[8:9], v9 offset:38912
    ds_read_b64_tr_b16 a[10:11], v9 offset:39424
    s_waitcnt lgkmcnt(6)
    v_mfma_f32_32x32x16_bf16 v[16:31], a[32:35], v[96:99], v[16:31]
    ds_read_b64_tr_b16 a[12:13], v10 offset:38912
    ds_read_b64_tr_b16 a[14:15], v10 offset:39424
    v_mfma_f32_32x32x16_bf16 v[32:47], a[36:39], v[96:99], v[32:47]
    ds_read_b64_tr_b16 a[16:17], v9 offset:40960
    ds_read_b64_tr_b16 a[18:19], v9 offset:41472
    v_mfma_f32_32x32x16_bf16 v[16:31], a[40:43], v[100:103], v[16:31]
    ds_read_b64_tr_b16 a[20:21], v10 offset:40960
    ds_read_b64_tr_b16 a[22:23], v10 offset:41472
    v_mul_f32_e64 v11, v48, v48
    v_mul_f32_e64 v12, v49, v49
    v_mul_f32_e64 v13, v50, v50
    v_mul_f32_e64 v14, v51, v51
    v_mfma_f32_32x32x16_bf16 v[32:47], a[44:47], v[100:103], v[32:47]
    ds_read_b64_tr_b16 a[24:25], v9 offset:43008
    ds_read_b64_tr_b16 a[26:27], v9 offset:43520
    v_fma_f32 v11, v11, v2, v1
    v_fma_f32 v12, v12, v2, v1
    v_fma_f32 v13, v13, v2, v1
    v_fma_f32 v14, v14, v2, v1
    s_waitcnt lgkmcnt(6)
    v_mfma_f32_32x32x16_bf16 v[16:31], a[0:3], v[104:107], v[16:31]
    ds_read_b64_tr_b16 a[28:29], v10 offset:43008
    ds_read_b64_tr_b16 a[30:31], v10 offset:43520
    v_mul_f32_e64 v11, v48, v11
    v_mul_f32_e64 v12, v49, v12
    v_mul_f32_e64 v13, v50, v13
    v_mul_f32_e64 v14, v51, v14
    v_mfma_f32_32x32x16_bf16 v[32:47], a[4:7], v[104:107], v[32:47]
    ds_read_b64_tr_b16 a[32:33], v9 offset:45056
    ds_read_b64_tr_b16 a[34:35], v9 offset:45568
    v_exp_f32_e64 v11, v11
    v_exp_f32_e64 v12, v12
    v_exp_f32_e64 v13, v13
    v_exp_f32_e64 v14, v14
    v_mfma_f32_32x32x16_bf16 v[16:31], a[8:11], v[108:111], v[16:31]
    ds_read_b64_tr_b16 a[36:37], v10 offset:45056
    ds_read_b64_tr_b16 a[38:39], v10 offset:45568
    v_fma_f32 v11, v11, v3, v3
    v_fma_f32 v12, v12, v3, v3
    v_fma_f32 v13, v13, v3, v3
    v_fma_f32 v14, v14, v3, v3
    v_mfma_f32_32x32x16_bf16 v[32:47], a[12:15], v[108:111], v[32:47]
    ds_read_b64_tr_b16 a[40:41], v9 offset:47104
    ds_read_b64_tr_b16 a[42:43], v9 offset:47616
    v_rcp_f32_e64 v11, v11
    v_rcp_f32_e64 v12, v12
    v_rcp_f32_e64 v13, v13
    v_rcp_f32_e64 v14, v14
    s_waitcnt lgkmcnt(6)
    v_mfma_f32_32x32x16_bf16 v[16:31], a[16:19], v[112:115], v[16:31]
    ds_read_b64_tr_b16 a[44:45], v10 offset:47104
    ds_read_b64_tr_b16 a[46:47], v10 offset:47616
    v_mul_f32_e64 v48, v48, v11
    v_mul_f32_e64 v49, v49, v12
    v_mul_f32_e64 v50, v50, v13
    v_mul_f32_e64 v51, v51, v14
    v_mfma_f32_32x32x16_bf16 v[32:47], a[20:23], v[112:115], v[32:47]
    s_waitcnt vmcnt(29)
    s_barrier
    ds_read_b64_tr_b16 a[0:1], v9 offset:49152
    ds_read_b64_tr_b16 a[2:3], v9 offset:49664
    s_add_u32 m0, s27, 32768
    s_add_u32 s30, s63, s35
    buffer_load_dwordx4 v4, s[12:15], s30 offen offset:0 lds
    v_cvt_pk_bf16_f32 v48, v48, v49
    v_cvt_pk_bf16_f32 v49, v50, v51
    v_mul_f32_e64 v11, v52, v52
    v_mul_f32_e64 v12, v53, v53
    v_mfma_f32_32x32x16_bf16 v[16:31], a[24:27], v[116:119], v[16:31]
    ds_read_b64_tr_b16 a[4:5], v10 offset:49152
    ds_read_b64_tr_b16 a[6:7], v10 offset:49664
    buffer_load_dwordx4 v5, s[12:15], s30 offen offset:1024 lds
    v_mul_f32_e64 v13, v54, v54
    v_mul_f32_e64 v14, v55, v55
    v_fma_f32 v11, v11, v2, v1
    v_fma_f32 v12, v12, v2, v1
    v_mfma_f32_32x32x16_bf16 v[32:47], a[28:31], v[116:119], v[32:47]
    ds_read_b64_tr_b16 a[8:9], v9 offset:51200
    ds_read_b64_tr_b16 a[10:11], v9 offset:51712
    buffer_load_dwordx4 v6, s[12:15], s30 offen offset:2048 lds
    v_fma_f32 v13, v13, v2, v1
    v_fma_f32 v14, v14, v2, v1
    v_mul_f32_e64 v11, v52, v11
    v_mul_f32_e64 v12, v53, v12
    s_waitcnt lgkmcnt(6)
    v_mfma_f32_32x32x16_bf16 v[16:31], a[32:35], v[120:123], v[16:31]
    ds_read_b64_tr_b16 a[12:13], v10 offset:51200
    ds_read_b64_tr_b16 a[14:15], v10 offset:51712
    buffer_load_dwordx4 v7, s[12:15], s30 offen offset:3072 lds
    v_mul_f32_e64 v13, v54, v13
    v_mul_f32_e64 v14, v55, v14
    v_exp_f32_e64 v11, v11
    v_exp_f32_e64 v12, v12
    v_mfma_f32_32x32x16_bf16 v[32:47], a[36:39], v[120:123], v[32:47]
    ds_read_b64_tr_b16 a[16:17], v9 offset:53248
    ds_read_b64_tr_b16 a[18:19], v9 offset:53760
    v_exp_f32_e64 v13, v13
    v_exp_f32_e64 v14, v14
    v_fma_f32 v11, v11, v3, v3
    v_fma_f32 v12, v12, v3, v3
    v_mfma_f32_32x32x16_bf16 v[16:31], a[40:43], v[124:127], v[16:31]
    ds_read_b64_tr_b16 a[20:21], v10 offset:53248
    ds_read_b64_tr_b16 a[22:23], v10 offset:53760
    v_fma_f32 v13, v13, v3, v3
    v_fma_f32 v14, v14, v3, v3
    v_rcp_f32_e64 v11, v11
    v_rcp_f32_e64 v12, v12
    v_mfma_f32_32x32x16_bf16 v[32:47], a[44:47], v[124:127], v[32:47]
    ds_read_b64_tr_b16 a[24:25], v9 offset:55296
    ds_read_b64_tr_b16 a[26:27], v9 offset:55808
    v_rcp_f32_e64 v13, v13
    v_rcp_f32_e64 v14, v14
    v_mul_f32_e64 v52, v52, v11
    v_mul_f32_e64 v53, v53, v12
    s_waitcnt lgkmcnt(6)
    v_mfma_f32_32x32x16_bf16 v[16:31], a[0:3], v[128:131], v[16:31]
    ds_read_b64_tr_b16 a[28:29], v10 offset:55296
    ds_read_b64_tr_b16 a[30:31], v10 offset:55808
    v_mul_f32_e64 v54, v54, v13
    v_mul_f32_e64 v55, v55, v14
    v_cvt_pk_bf16_f32 v50, v52, v53
    v_cvt_pk_bf16_f32 v51, v54, v55
    v_mfma_f32_32x32x16_bf16 v[32:47], a[4:7], v[128:131], v[32:47]
    ds_read_b64_tr_b16 a[32:33], v9 offset:57344
    ds_read_b64_tr_b16 a[34:35], v9 offset:57856
    buffer_store_dwordx4 v[48:51], v0, s[16:19], s37 offen offset:0 sc1
    v_mul_f32_e64 v11, v56, v56
    v_mul_f32_e64 v12, v57, v57
    v_mul_f32_e64 v13, v58, v58
    v_mfma_f32_32x32x16_bf16 v[16:31], a[8:11], v[132:135], v[16:31]
    ds_read_b64_tr_b16 a[36:37], v10 offset:57344
    ds_read_b64_tr_b16 a[38:39], v10 offset:57856
    v_mul_f32_e64 v14, v59, v59
    v_fma_f32 v11, v11, v2, v1
    v_fma_f32 v12, v12, v2, v1
    v_mfma_f32_32x32x16_bf16 v[32:47], a[12:15], v[132:135], v[32:47]
    ds_read_b64_tr_b16 a[40:41], v9 offset:59392
    ds_read_b64_tr_b16 a[42:43], v9 offset:59904
    v_fma_f32 v13, v13, v2, v1
    v_fma_f32 v14, v14, v2, v1
    v_mul_f32_e64 v11, v56, v11
    s_waitcnt lgkmcnt(6)
    v_mfma_f32_32x32x16_bf16 v[16:31], a[16:19], v[136:139], v[16:31]
    ds_read_b64_tr_b16 a[44:45], v10 offset:59392
    ds_read_b64_tr_b16 a[46:47], v10 offset:59904
    v_mul_f32_e64 v12, v57, v12
    v_mul_f32_e64 v13, v58, v13
    v_mul_f32_e64 v14, v59, v14
    v_mfma_f32_32x32x16_bf16 v[32:47], a[20:23], v[136:139], v[32:47]
    ds_read_b64_tr_b16 a[0:1], v9 offset:61440
    ds_read_b64_tr_b16 a[2:3], v9 offset:61952
    v_exp_f32_e64 v11, v11
    v_exp_f32_e64 v12, v12
    v_exp_f32_e64 v13, v13
    v_mfma_f32_32x32x16_bf16 v[16:31], a[24:27], v[140:143], v[16:31]
    ds_read_b64_tr_b16 a[4:5], v10 offset:61440
    ds_read_b64_tr_b16 a[6:7], v10 offset:61952
    v_exp_f32_e64 v14, v14
    v_fma_f32 v11, v11, v3, v3
    v_fma_f32 v12, v12, v3, v3
    v_mfma_f32_32x32x16_bf16 v[32:47], a[28:31], v[140:143], v[32:47]
    ds_read_b64_tr_b16 a[8:9], v9 offset:63488
    ds_read_b64_tr_b16 a[10:11], v9 offset:64000
    v_fma_f32 v13, v13, v3, v3
    v_fma_f32 v14, v14, v3, v3
    v_rcp_f32_e64 v11, v11
    s_waitcnt lgkmcnt(6)
    v_mfma_f32_32x32x16_bf16 v[16:31], a[32:35], v[144:147], v[16:31]
    ds_read_b64_tr_b16 a[12:13], v10 offset:63488
    ds_read_b64_tr_b16 a[14:15], v10 offset:64000
    v_rcp_f32_e64 v12, v12
    v_rcp_f32_e64 v13, v13
    v_rcp_f32_e64 v14, v14
    v_mfma_f32_32x32x16_bf16 v[32:47], a[36:39], v[144:147], v[32:47]
    s_waitcnt vmcnt(12)
    s_barrier
    v_add_u32 v9, 65536, v9
    ds_read_b64_tr_b16 a[16:17], v9 offset:0
    ds_read_b64_tr_b16 a[18:19], v9 offset:512
    v_mov_b32 v15, 1
    s_mov_b64 exec, 1
    buffer_atomic_add v15, off, s[16:19], s31  offset:0 sc1
    s_mov_b64 exec, -1
    s_add_u32 m0, s27, 49152
    s_add_u32 s30, s64, s35
    buffer_load_dwordx4 v4, s[12:15], s30 offen offset:0 lds
    v_mul_f32_e64 v56, v56, v11
    v_mul_f32_e64 v57, v57, v12
    v_mul_f32_e64 v58, v58, v13
    v_mfma_f32_32x32x16_bf16 v[16:31], a[40:43], v[148:151], v[16:31]
    v_add_u32 v10, 65536, v10
    ds_read_b64_tr_b16 a[20:21], v10 offset:0
    ds_read_b64_tr_b16 a[22:23], v10 offset:512
    buffer_load_dwordx4 v5, s[12:15], s30 offen offset:1024 lds
    v_mul_f32_e64 v59, v59, v14
    v_cvt_pk_bf16_f32 v52, v56, v57
    v_cvt_pk_bf16_f32 v53, v58, v59
    v_mfma_f32_32x32x16_bf16 v[32:47], a[44:47], v[148:151], v[32:47]
    ds_read_b64_tr_b16 a[24:25], v9 offset:2048
    ds_read_b64_tr_b16 a[26:27], v9 offset:2560
    buffer_load_dwordx4 v6, s[12:15], s30 offen offset:2048 lds
    v_mul_f32_e64 v11, v60, v60
    v_mul_f32_e64 v12, v61, v61
    v_mul_f32_e64 v13, v62, v62
    s_waitcnt lgkmcnt(6)
    v_mfma_f32_32x32x16_bf16 v[16:31], a[0:3], v[152:155], v[16:31]
    ds_read_b64_tr_b16 a[28:29], v10 offset:2048
    ds_read_b64_tr_b16 a[30:31], v10 offset:2560
    buffer_load_dwordx4 v7, s[12:15], s30 offen offset:3072 lds
    v_mul_f32_e64 v14, v63, v63
    v_fma_f32 v11, v11, v2, v1
    v_fma_f32 v12, v12, v2, v1
    v_mfma_f32_32x32x16_bf16 v[32:47], a[4:7], v[152:155], v[32:47]
    ds_read_b64_tr_b16 a[32:33], v9 offset:4096
    ds_read_b64_tr_b16 a[34:35], v9 offset:4608
    v_fma_f32 v13, v13, v2, v1
    v_fma_f32 v14, v14, v2, v1
    v_mul_f32_e64 v11, v60, v11
    v_mfma_f32_32x32x16_bf16 v[16:31], a[8:11], v[156:159], v[16:31]
    ds_read_b64_tr_b16 a[36:37], v10 offset:4096
    ds_read_b64_tr_b16 a[38:39], v10 offset:4608
    v_mul_f32_e64 v12, v61, v12
    v_mul_f32_e64 v13, v62, v13
    v_mul_f32_e64 v14, v63, v14
    v_mfma_f32_32x32x16_bf16 v[32:47], a[12:15], v[156:159], v[32:47]
    ds_read_b64_tr_b16 a[40:41], v9 offset:6144
    ds_read_b64_tr_b16 a[42:43], v9 offset:6656
    v_exp_f32_e64 v11, v11
    v_exp_f32_e64 v12, v12
    v_exp_f32_e64 v13, v13
    s_waitcnt lgkmcnt(6)
    v_mfma_f32_32x32x16_bf16 v[16:31], a[16:19], v[160:163], v[16:31]
    ds_read_b64_tr_b16 a[44:45], v10 offset:6144
    ds_read_b64_tr_b16 a[46:47], v10 offset:6656
    v_exp_f32_e64 v14, v14
    v_fma_f32 v11, v11, v3, v3
    v_fma_f32 v12, v12, v3, v3
    v_mfma_f32_32x32x16_bf16 v[32:47], a[20:23], v[160:163], v[32:47]
    ds_read_b64_tr_b16 a[0:1], v9 offset:8192
    ds_read_b64_tr_b16 a[2:3], v9 offset:8704
    v_fma_f32 v13, v13, v3, v3
    v_fma_f32 v14, v14, v3, v3
    v_rcp_f32_e64 v11, v11
    v_mfma_f32_32x32x16_bf16 v[16:31], a[24:27], v[164:167], v[16:31]
    ds_read_b64_tr_b16 a[4:5], v10 offset:8192
    ds_read_b64_tr_b16 a[6:7], v10 offset:8704
    v_rcp_f32_e64 v12, v12
    v_rcp_f32_e64 v13, v13
    v_rcp_f32_e64 v14, v14
    v_mfma_f32_32x32x16_bf16 v[32:47], a[28:31], v[164:167], v[32:47]
    ds_read_b64_tr_b16 a[8:9], v9 offset:10240
    ds_read_b64_tr_b16 a[10:11], v9 offset:10752
    v_mul_f32_e64 v60, v60, v11
    v_mul_f32_e64 v61, v61, v12
    v_mul_f32_e64 v62, v62, v13
    s_waitcnt lgkmcnt(6)
    v_mfma_f32_32x32x16_bf16 v[16:31], a[32:35], v[168:171], v[16:31]
    ds_read_b64_tr_b16 a[12:13], v10 offset:10240
    ds_read_b64_tr_b16 a[14:15], v10 offset:10752
    v_mul_f32_e64 v63, v63, v14
    v_cvt_pk_bf16_f32 v54, v60, v61
    v_cvt_pk_bf16_f32 v55, v62, v63
    v_mfma_f32_32x32x16_bf16 v[32:47], a[36:39], v[168:171], v[32:47]
    ds_read_b64_tr_b16 a[16:17], v9 offset:12288
    ds_read_b64_tr_b16 a[18:19], v9 offset:12800
    buffer_store_dwordx4 v[52:55], v0, s[16:19], s37 offen offset:512 sc1
    v_mul_f32_e64 v11, v64, v64
    v_mul_f32_e64 v12, v65, v65
    v_mfma_f32_32x32x16_bf16 v[16:31], a[40:43], v[172:175], v[16:31]
    ds_read_b64_tr_b16 a[20:21], v10 offset:12288
    ds_read_b64_tr_b16 a[22:23], v10 offset:12800
    v_mul_f32_e64 v13, v66, v66
    v_mul_f32_e64 v14, v67, v67
    v_fma_f32 v11, v11, v2, v1
    v_mfma_f32_32x32x16_bf16 v[32:47], a[44:47], v[172:175], v[32:47]
    ds_read_b64_tr_b16 a[24:25], v9 offset:14336
    ds_read_b64_tr_b16 a[26:27], v9 offset:14848
    v_fma_f32 v12, v12, v2, v1
    v_fma_f32 v13, v13, v2, v1
    v_fma_f32 v14, v14, v2, v1
    s_waitcnt lgkmcnt(6)
    v_mfma_f32_32x32x16_bf16 v[16:31], a[0:3], v[176:179], v[16:31]
    ds_read_b64_tr_b16 a[28:29], v10 offset:14336
    ds_read_b64_tr_b16 a[30:31], v10 offset:14848
    v_mul_f32_e64 v11, v64, v11
    v_mul_f32_e64 v12, v65, v12
    v_mul_f32_e64 v13, v66, v13
    v_mfma_f32_32x32x16_bf16 v[32:47], a[4:7], v[176:179], v[32:47]
    s_barrier
    ds_read_b64_tr_b16 a[32:33], v9 offset:16384
    ds_read_b64_tr_b16 a[34:35], v9 offset:16896
    v_mul_f32_e64 v14, v67, v14
    v_exp_f32_e64 v11, v11
    v_exp_f32_e64 v12, v12
    v_mfma_f32_32x32x16_bf16 v[16:31], a[8:11], v[180:183], v[16:31]
    ds_read_b64_tr_b16 a[36:37], v10 offset:16384
    ds_read_b64_tr_b16 a[38:39], v10 offset:16896
    v_exp_f32_e64 v13, v13
    v_exp_f32_e64 v14, v14
    v_fma_f32 v11, v11, v3, v3
    v_mfma_f32_32x32x16_bf16 v[32:47], a[12:15], v[180:183], v[32:47]
    ds_read_b64_tr_b16 a[40:41], v9 offset:18432
    ds_read_b64_tr_b16 a[42:43], v9 offset:18944
    v_fma_f32 v12, v12, v3, v3
    v_fma_f32 v13, v13, v3, v3
    v_fma_f32 v14, v14, v3, v3
    s_waitcnt lgkmcnt(6)
    v_mfma_f32_32x32x16_bf16 v[16:31], a[16:19], v[184:187], v[16:31]
    ds_read_b64_tr_b16 a[44:45], v10 offset:18432
    ds_read_b64_tr_b16 a[46:47], v10 offset:18944
    v_rcp_f32_e64 v11, v11
    v_rcp_f32_e64 v12, v12
    v_rcp_f32_e64 v13, v13
    v_mfma_f32_32x32x16_bf16 v[32:47], a[20:23], v[184:187], v[32:47]
    ds_read_b64_tr_b16 a[0:1], v9 offset:20480
    ds_read_b64_tr_b16 a[2:3], v9 offset:20992
    v_rcp_f32_e64 v14, v14
    v_mul_f32_e64 v64, v64, v11
    v_mul_f32_e64 v65, v65, v12
    v_mfma_f32_32x32x16_bf16 v[16:31], a[24:27], v[188:191], v[16:31]
    ds_read_b64_tr_b16 a[4:5], v10 offset:20480
    ds_read_b64_tr_b16 a[6:7], v10 offset:20992
    v_mul_f32_e64 v66, v66, v13
    v_mul_f32_e64 v67, v67, v14
    v_cvt_pk_bf16_f32 v64, v64, v65
    v_mfma_f32_32x32x16_bf16 v[32:47], a[28:31], v[188:191], v[32:47]
    ds_read_b64_tr_b16 a[8:9], v9 offset:22528
    ds_read_b64_tr_b16 a[10:11], v9 offset:23040
    v_cvt_pk_bf16_f32 v65, v66, v67
    v_mul_f32_e64 v11, v68, v68
    v_mul_f32_e64 v12, v69, v69
    s_waitcnt lgkmcnt(6)
    v_mfma_f32_32x32x16_bf16 v[16:31], a[32:35], v[192:195], v[16:31]
    ds_read_b64_tr_b16 a[12:13], v10 offset:22528
    ds_read_b64_tr_b16 a[14:15], v10 offset:23040
    v_mul_f32_e64 v13, v70, v70
    v_mul_f32_e64 v14, v71, v71
    v_fma_f32 v11, v11, v2, v1
    v_mfma_f32_32x32x16_bf16 v[32:47], a[36:39], v[192:195], v[32:47]
    ds_read_b64_tr_b16 a[16:17], v9 offset:24576
    ds_read_b64_tr_b16 a[18:19], v9 offset:25088
    v_fma_f32 v12, v12, v2, v1
    v_fma_f32 v13, v13, v2, v1
    v_fma_f32 v14, v14, v2, v1
    v_mfma_f32_32x32x16_bf16 v[16:31], a[40:43], v[196:199], v[16:31]
    ds_read_b64_tr_b16 a[20:21], v10 offset:24576
    ds_read_b64_tr_b16 a[22:23], v10 offset:25088
    v_mul_f32_e64 v11, v68, v11
    v_mul_f32_e64 v12, v69, v12
    v_mul_f32_e64 v13, v70, v13
    v_mfma_f32_32x32x16_bf16 v[32:47], a[44:47], v[196:199], v[32:47]
    ds_read_b64_tr_b16 a[24:25], v9 offset:26624
    ds_read_b64_tr_b16 a[26:27], v9 offset:27136
    v_mul_f32_e64 v14, v71, v14
    v_exp_f32_e64 v11, v11
    v_exp_f32_e64 v12, v12
    s_waitcnt lgkmcnt(6)
    v_mfma_f32_32x32x16_bf16 v[16:31], a[0:3], v[200:203], v[16:31]
    ds_read_b64_tr_b16 a[28:29], v10 offset:26624
    ds_read_b64_tr_b16 a[30:31], v10 offset:27136
    v_exp_f32_e64 v13, v13
    v_exp_f32_e64 v14, v14
    v_fma_f32 v11, v11, v3, v3
    v_mfma_f32_32x32x16_bf16 v[32:47], a[4:7], v[200:203], v[32:47]
    ds_read_b64_tr_b16 a[32:33], v9 offset:28672
    ds_read_b64_tr_b16 a[34:35], v9 offset:29184
    v_fma_f32 v12, v12, v3, v3
    v_fma_f32 v13, v13, v3, v3
    v_fma_f32 v14, v14, v3, v3
    v_mfma_f32_32x32x16_bf16 v[16:31], a[8:11], v[204:207], v[16:31]
    ds_read_b64_tr_b16 a[36:37], v10 offset:28672
    ds_read_b64_tr_b16 a[38:39], v10 offset:29184
    v_rcp_f32_e64 v11, v11
    v_rcp_f32_e64 v12, v12
    v_rcp_f32_e64 v13, v13
    v_mfma_f32_32x32x16_bf16 v[32:47], a[12:15], v[204:207], v[32:47]
    ds_read_b64_tr_b16 a[40:41], v9 offset:30720
    ds_read_b64_tr_b16 a[42:43], v9 offset:31232
    v_rcp_f32_e64 v14, v14
    v_mul_f32_e64 v68, v68, v11
    v_mul_f32_e64 v69, v69, v12
    s_waitcnt lgkmcnt(6)
    v_mfma_f32_32x32x16_bf16 v[16:31], a[16:19], v[208:211], v[16:31]
    ds_read_b64_tr_b16 a[44:45], v10 offset:30720
    ds_read_b64_tr_b16 a[46:47], v10 offset:31232
    v_mul_f32_e64 v70, v70, v13
    v_mul_f32_e64 v71, v71, v14
    v_cvt_pk_bf16_f32 v66, v68, v69
    v_mfma_f32_32x32x16_bf16 v[32:47], a[20:23], v[208:211], v[32:47]
    s_barrier
    ds_read_b64_tr_b16 a[0:1], v9 offset:32768
    ds_read_b64_tr_b16 a[2:3], v9 offset:33280
    v_cvt_pk_bf16_f32 v67, v70, v71
    buffer_store_dwordx4 v[64:67], v8, s[16:19], s37 offen offset:0 sc1
    v_mul_f32_e64 v11, v72, v72
    v_mfma_f32_32x32x16_bf16 v[16:31], a[24:27], v[212:215], v[16:31]
    ds_read_b64_tr_b16 a[4:5], v10 offset:32768
    ds_read_b64_tr_b16 a[6:7], v10 offset:33280
    v_mul_f32_e64 v12, v73, v73
    v_mul_f32_e64 v13, v74, v74
    v_mul_f32_e64 v14, v75, v75
    v_mfma_f32_32x32x16_bf16 v[32:47], a[28:31], v[212:215], v[32:47]
    ds_read_b64_tr_b16 a[8:9], v9 offset:34816
    ds_read_b64_tr_b16 a[10:11], v9 offset:35328
    v_fma_f32 v11, v11, v2, v1
    v_fma_f32 v12, v12, v2, v1
    v_fma_f32 v13, v13, v2, v1
    s_waitcnt lgkmcnt(6)
    v_mfma_f32_32x32x16_bf16 v[16:31], a[32:35], v[216:219], v[16:31]
    ds_read_b64_tr_b16 a[12:13], v10 offset:34816
    ds_read_b64_tr_b16 a[14:15], v10 offset:35328
    v_fma_f32 v14, v14, v2, v1
    v_mul_f32_e64 v11, v72, v11
    v_mul_f32_e64 v12, v73, v12
    v_mfma_f32_32x32x16_bf16 v[32:47], a[36:39], v[216:219], v[32:47]
    ds_read_b64_tr_b16 a[16:17], v9 offset:36864
    ds_read_b64_tr_b16 a[18:19], v9 offset:37376
    v_mul_f32_e64 v13, v74, v13
    v_mul_f32_e64 v14, v75, v14
    v_exp_f32_e64 v11, v11
    v_mfma_f32_32x32x16_bf16 v[16:31], a[40:43], v[220:223], v[16:31]
    ds_read_b64_tr_b16 a[20:21], v10 offset:36864
    ds_read_b64_tr_b16 a[22:23], v10 offset:37376
    v_exp_f32_e64 v12, v12
    v_exp_f32_e64 v13, v13
    v_exp_f32_e64 v14, v14
    v_mfma_f32_32x32x16_bf16 v[32:47], a[44:47], v[220:223], v[32:47]
    ds_read_b64_tr_b16 a[24:25], v9 offset:38912
    ds_read_b64_tr_b16 a[26:27], v9 offset:39424
    v_fma_f32 v11, v11, v3, v3
    v_fma_f32 v12, v12, v3, v3
    v_fma_f32 v13, v13, v3, v3
    s_waitcnt lgkmcnt(6)
    v_mfma_f32_32x32x16_bf16 v[16:31], a[0:3], v[224:227], v[16:31]
    ds_read_b64_tr_b16 a[28:29], v10 offset:38912
    ds_read_b64_tr_b16 a[30:31], v10 offset:39424
    v_fma_f32 v14, v14, v3, v3
    v_rcp_f32_e64 v11, v11
    v_rcp_f32_e64 v12, v12
    v_mfma_f32_32x32x16_bf16 v[32:47], a[4:7], v[224:227], v[32:47]
    ds_read_b64_tr_b16 a[32:33], v9 offset:40960
    ds_read_b64_tr_b16 a[34:35], v9 offset:41472
    v_rcp_f32_e64 v13, v13
    v_rcp_f32_e64 v14, v14
    v_mul_f32_e64 v72, v72, v11
    v_mfma_f32_32x32x16_bf16 v[16:31], a[8:11], v[228:231], v[16:31]
    ds_read_b64_tr_b16 a[36:37], v10 offset:40960
    ds_read_b64_tr_b16 a[38:39], v10 offset:41472
    v_mul_f32_e64 v73, v73, v12
    v_mul_f32_e64 v74, v74, v13
    v_mul_f32_e64 v75, v75, v14
    v_mfma_f32_32x32x16_bf16 v[32:47], a[12:15], v[228:231], v[32:47]
    ds_read_b64_tr_b16 a[40:41], v9 offset:43008
    ds_read_b64_tr_b16 a[42:43], v9 offset:43520
    v_cvt_pk_bf16_f32 v68, v72, v73
    v_cvt_pk_bf16_f32 v69, v74, v75
    v_mul_f32_e64 v11, v76, v76
    s_waitcnt lgkmcnt(6)
    v_mfma_f32_32x32x16_bf16 v[16:31], a[16:19], v[232:235], v[16:31]
    ds_read_b64_tr_b16 a[44:45], v10 offset:43008
    ds_read_b64_tr_b16 a[46:47], v10 offset:43520
    v_mul_f32_e64 v12, v77, v77
    v_mul_f32_e64 v13, v78, v78
    v_mul_f32_e64 v14, v79, v79
    v_mfma_f32_32x32x16_bf16 v[32:47], a[20:23], v[232:235], v[32:47]
    ds_read_b64_tr_b16 a[0:1], v9 offset:45056
    ds_read_b64_tr_b16 a[2:3], v9 offset:45568
    v_fma_f32 v11, v11, v2, v1
    v_fma_f32 v12, v12, v2, v1
    v_fma_f32 v13, v13, v2, v1
    v_mfma_f32_32x32x16_bf16 v[16:31], a[24:27], v[236:239], v[16:31]
    ds_read_b64_tr_b16 a[4:5], v10 offset:45056
    ds_read_b64_tr_b16 a[6:7], v10 offset:45568
    v_fma_f32 v14, v14, v2, v1
    v_mul_f32_e64 v11, v76, v11
    v_mul_f32_e64 v12, v77, v12
    v_mfma_f32_32x32x16_bf16 v[32:47], a[28:31], v[236:239], v[32:47]
    ds_read_b64_tr_b16 a[8:9], v9 offset:47104
    ds_read_b64_tr_b16 a[10:11], v9 offset:47616
    v_mul_f32_e64 v13, v78, v13
    v_mul_f32_e64 v14, v79, v14
    v_exp_f32_e64 v11, v11
    s_waitcnt lgkmcnt(6)
    v_mfma_f32_32x32x16_bf16 v[16:31], a[32:35], v[240:243], v[16:31]
    ds_read_b64_tr_b16 a[12:13], v10 offset:47104
    ds_read_b64_tr_b16 a[14:15], v10 offset:47616
    v_exp_f32_e64 v12, v12
    v_exp_f32_e64 v13, v13
    v_exp_f32_e64 v14, v14
    v_mfma_f32_32x32x16_bf16 v[32:47], a[36:39], v[240:243], v[32:47]
    v_fma_f32 v11, v11, v3, v3
    v_fma_f32 v12, v12, v3, v3
    v_fma_f32 v13, v13, v3, v3
    v_mfma_f32_32x32x16_bf16 v[16:31], a[40:43], v[244:247], v[16:31]
    s_barrier
    ds_read_b64_tr_b16 a[16:17], v9 offset:49152
    ds_read_b64_tr_b16 a[18:19], v9 offset:49664
    v_fma_f32 v14, v14, v3, v3
    v_rcp_f32_e64 v11, v11
    v_rcp_f32_e64 v12, v12
    v_mfma_f32_32x32x16_bf16 v[32:47], a[44:47], v[244:247], v[32:47]
    ds_read_b64_tr_b16 a[20:21], v9 offset:51200
    ds_read_b64_tr_b16 a[22:23], v9 offset:51712
    v_rcp_f32_e64 v13, v13
    v_rcp_f32_e64 v14, v14
    v_mul_f32_e64 v76, v76, v11
    s_waitcnt lgkmcnt(4)
    v_mfma_f32_32x32x16_bf16 v[16:31], a[0:3], v[248:251], v[16:31]
    ds_read_b64_tr_b16 a[24:25], v9 offset:53248
    ds_read_b64_tr_b16 a[26:27], v9 offset:53760
    v_mul_f32_e64 v77, v77, v12
    v_mul_f32_e64 v78, v78, v13
    v_mul_f32_e64 v79, v79, v14
    v_mfma_f32_32x32x16_bf16 v[32:47], a[4:7], v[248:251], v[32:47]
    ds_read_b64_tr_b16 a[28:29], v9 offset:55296
    ds_read_b64_tr_b16 a[30:31], v9 offset:55808
    v_cvt_pk_bf16_f32 v70, v76, v77
    v_cvt_pk_bf16_f32 v71, v78, v79
    buffer_store_dwordx4 v[68:71], v8, s[16:19], s37 offen offset:512 sc1
    v_mfma_f32_32x32x16_bf16 v[16:31], a[8:11], v[252:255], v[16:31]
    ds_read_b64_tr_b16 a[32:33], v9 offset:57344
    ds_read_b64_tr_b16 a[34:35], v9 offset:57856
    v_mfma_f32_32x32x16_bf16 v[32:47], a[12:15], v[252:255], v[32:47]
    ds_read_b64_tr_b16 a[36:37], v9 offset:59392
    ds_read_b64_tr_b16 a[38:39], v9 offset:59904
    s_waitcnt lgkmcnt(6)
    v_mfma_f32_32x32x16_bf16 v[48:63], a[72:75], a[80:83], 0
    ds_read_b64_tr_b16 a[40:41], v9 offset:61440
    ds_read_b64_tr_b16 a[42:43], v9 offset:61952
    v_mfma_f32_32x32x16_bf16 v[48:63], a[16:19], v[96:99], v[48:63]
    ds_read_b64_tr_b16 a[44:45], v9 offset:63488
    ds_read_b64_tr_b16 a[46:47], v9 offset:64000
    v_mfma_f32_32x32x16_bf16 v[48:63], a[20:23], v[100:103], v[48:63]
    s_waitcnt vmcnt(17)
    s_barrier
    v_add_u32 v9, 65536, v9
    ds_read_b64_tr_b16 a[0:1], v9 offset:0
    ds_read_b64_tr_b16 a[2:3], v9 offset:512
    v_mfma_f32_32x32x16_bf16 v[48:63], a[24:27], v[104:107], v[48:63]
    ds_read_b64_tr_b16 a[4:5], v9 offset:2048
    ds_read_b64_tr_b16 a[6:7], v9 offset:2560
    s_waitcnt lgkmcnt(6)
    v_mfma_f32_32x32x16_bf16 v[48:63], a[28:31], v[108:111], v[48:63]
    ds_read_b64_tr_b16 a[8:9], v9 offset:4096
    ds_read_b64_tr_b16 a[10:11], v9 offset:4608
    v_mul_f32_e64 v11, v16, v16
    v_mul_f32_e64 v12, v17, v17
    v_mul_f32_e64 v13, v18, v18
    v_mul_f32_e64 v14, v19, v19
    v_fma_f32 v11, v11, v2, v1
    v_fma_f32 v12, v12, v2, v1
    v_mfma_f32_32x32x16_bf16 v[48:63], a[32:35], v[112:115], v[48:63]
    ds_read_b64_tr_b16 a[12:13], v9 offset:6144
    ds_read_b64_tr_b16 a[14:15], v9 offset:6656
    v_fma_f32 v13, v13, v2, v1
    v_fma_f32 v14, v14, v2, v1
    v_mul_f32_e64 v11, v16, v11
    v_mul_f32_e64 v12, v17, v12
    v_mul_f32_e64 v13, v18, v13
    v_mul_f32_e64 v14, v19, v14
    v_mfma_f32_32x32x16_bf16 v[48:63], a[36:39], v[116:119], v[48:63]
    ds_read_b64_tr_b16 a[16:17], v9 offset:8192
    ds_read_b64_tr_b16 a[18:19], v9 offset:8704
    v_exp_f32_e64 v11, v11
    v_exp_f32_e64 v12, v12
    v_exp_f32_e64 v13, v13
    v_exp_f32_e64 v14, v14
    v_fma_f32 v11, v11, v3, v3
    v_fma_f32 v12, v12, v3, v3
    v_mfma_f32_32x32x16_bf16 v[48:63], a[40:43], v[120:123], v[48:63]
    ds_read_b64_tr_b16 a[20:21], v9 offset:10240
    ds_read_b64_tr_b16 a[22:23], v9 offset:10752
    v_fma_f32 v13, v13, v3, v3
    v_fma_f32 v14, v14, v3, v3
    v_rcp_f32_e64 v11, v11
    v_rcp_f32_e64 v12, v12
    v_rcp_f32_e64 v13, v13
    v_rcp_f32_e64 v14, v14
    s_waitcnt lgkmcnt(6)
    v_mfma_f32_32x32x16_bf16 v[48:63], a[44:47], v[124:127], v[48:63]
    ds_read_b64_tr_b16 a[24:25], v9 offset:12288
    ds_read_b64_tr_b16 a[26:27], v9 offset:12800
    v_mul_f32_e64 v16, v16, v11
    v_mul_f32_e64 v17, v17, v12
    v_mul_f32_e64 v18, v18, v13
    v_mul_f32_e64 v19, v19, v14
    v_cvt_pk_bf16_f32 v16, v16, v17
    v_cvt_pk_bf16_f32 v17, v18, v19
    v_mfma_f32_32x32x16_bf16 v[48:63], a[0:3], v[128:131], v[48:63]
    ds_read_b64_tr_b16 a[28:29], v9 offset:14336
    ds_read_b64_tr_b16 a[30:31], v9 offset:14848
    v_mul_f32_e64 v11, v20, v20
    v_mul_f32_e64 v12, v21, v21
    v_mul_f32_e64 v13, v22, v22
    v_mul_f32_e64 v14, v23, v23
    v_fma_f32 v11, v11, v2, v1
    v_fma_f32 v12, v12, v2, v1
    v_mfma_f32_32x32x16_bf16 v[48:63], a[4:7], v[132:135], v[48:63]
    s_waitcnt vmcnt(13)
    s_barrier
    v_add_u32 v9, 4294836224, v9
    ds_read_b64_tr_b16 a[32:33], v9 offset:0
    ds_read_b64_tr_b16 a[34:35], v9 offset:512
    v_fma_f32 v13, v13, v2, v1
    v_fma_f32 v14, v14, v2, v1
    v_mul_f32_e64 v11, v20, v11
    v_mul_f32_e64 v12, v21, v12
    v_mul_f32_e64 v13, v22, v13
    v_mul_f32_e64 v14, v23, v14
    v_mfma_f32_32x32x16_bf16 v[48:63], a[8:11], v[136:139], v[48:63]
    ds_read_b64_tr_b16 a[36:37], v9 offset:2048
    ds_read_b64_tr_b16 a[38:39], v9 offset:2560
    v_exp_f32_e64 v11, v11
    v_exp_f32_e64 v12, v12
    v_exp_f32_e64 v13, v13
    v_exp_f32_e64 v14, v14
    v_fma_f32 v11, v11, v3, v3
    v_fma_f32 v12, v12, v3, v3
    s_waitcnt lgkmcnt(6)
    v_mfma_f32_32x32x16_bf16 v[48:63], a[12:15], v[140:143], v[48:63]
    ds_read_b64_tr_b16 a[40:41], v9 offset:4096
    ds_read_b64_tr_b16 a[42:43], v9 offset:4608
    v_fma_f32 v13, v13, v3, v3
    v_fma_f32 v14, v14, v3, v3
    v_rcp_f32_e64 v11, v11
    v_rcp_f32_e64 v12, v12
    v_rcp_f32_e64 v13, v13
    v_rcp_f32_e64 v14, v14
    v_mfma_f32_32x32x16_bf16 v[48:63], a[16:19], v[144:147], v[48:63]
    ds_read_b64_tr_b16 a[44:45], v9 offset:6144
    ds_read_b64_tr_b16 a[46:47], v9 offset:6656
    v_mul_f32_e64 v20, v20, v11
    v_mul_f32_e64 v21, v21, v12
    v_mul_f32_e64 v22, v22, v13
    v_mul_f32_e64 v23, v23, v14
    v_cvt_pk_bf16_f32 v18, v20, v21
    v_cvt_pk_bf16_f32 v19, v22, v23
    v_mfma_f32_32x32x16_bf16 v[48:63], a[20:23], v[148:151], v[48:63]
    ds_read_b64_tr_b16 a[0:1], v9 offset:8192
    ds_read_b64_tr_b16 a[2:3], v9 offset:8704
    buffer_store_dwordx4 v[16:19], v0, s[16:19], s38 offen offset:0 sc1
    v_mul_f32_e64 v11, v24, v24
    v_mul_f32_e64 v12, v25, v25
    v_mul_f32_e64 v13, v26, v26
    v_mul_f32_e64 v14, v27, v27
    v_fma_f32 v11, v11, v2, v1
    v_mfma_f32_32x32x16_bf16 v[48:63], a[24:27], v[152:155], v[48:63]
    ds_read_b64_tr_b16 a[4:5], v9 offset:10240
    ds_read_b64_tr_b16 a[6:7], v9 offset:10752
    v_fma_f32 v12, v12, v2, v1
    v_fma_f32 v13, v13, v2, v1
    v_fma_f32 v14, v14, v2, v1
    v_mul_f32_e64 v11, v24, v11
    v_mul_f32_e64 v12, v25, v12
    v_mul_f32_e64 v13, v26, v13
    s_waitcnt lgkmcnt(6)
    v_mfma_f32_32x32x16_bf16 v[48:63], a[28:31], v[156:159], v[48:63]
    ds_read_b64_tr_b16 a[8:9], v9 offset:12288
    ds_read_b64_tr_b16 a[10:11], v9 offset:12800
    v_mul_f32_e64 v14, v27, v14
    v_exp_f32_e64 v11, v11
    v_exp_f32_e64 v12, v12
    v_exp_f32_e64 v13, v13
    v_exp_f32_e64 v14, v14
    v_fma_f32 v11, v11, v3, v3
    v_mfma_f32_32x32x16_bf16 v[48:63], a[32:35], v[160:163], v[48:63]
    ds_read_b64_tr_b16 a[12:13], v9 offset:14336
    ds_read_b64_tr_b16 a[14:15], v9 offset:14848
    v_fma_f32 v12, v12, v3, v3
    v_fma_f32 v13, v13, v3, v3
    v_fma_f32 v14, v14, v3, v3
    v_rcp_f32_e64 v11, v11
    v_rcp_f32_e64 v12, v12
    v_rcp_f32_e64 v13, v13
    v_mfma_f32_32x32x16_bf16 v[48:63], a[36:39], v[164:167], v[48:63]
    s_waitcnt vmcnt(10)
    s_barrier
    ds_read_b64_tr_b16 a[16:17], v9 offset:16384
    ds_read_b64_tr_b16 a[18:19], v9 offset:16896
    v_rcp_f32_e64 v14, v14
    v_mul_f32_e64 v24, v24, v11
    v_mul_f32_e64 v25, v25, v12
    v_mul_f32_e64 v26, v26, v13
    v_mul_f32_e64 v27, v27, v14
    v_mfma_f32_32x32x16_bf16 v[48:63], a[40:43], v[168:171], v[48:63]
    ds_read_b64_tr_b16 a[20:21], v9 offset:18432
    ds_read_b64_tr_b16 a[22:23], v9 offset:18944
    v_cvt_pk_bf16_f32 v20, v24, v25
    v_cvt_pk_bf16_f32 v21, v26, v27
    v_mul_f32_e64 v11, v28, v28
    v_mul_f32_e64 v12, v29, v29
    v_mul_f32_e64 v13, v30, v30
    s_waitcnt lgkmcnt(6)
    v_mfma_f32_32x32x16_bf16 v[48:63], a[44:47], v[172:175], v[48:63]
    ds_read_b64_tr_b16 a[24:25], v9 offset:20480
    ds_read_b64_tr_b16 a[26:27], v9 offset:20992
    v_mul_f32_e64 v14, v31, v31
    v_fma_f32 v11, v11, v2, v1
    v_fma_f32 v12, v12, v2, v1
    v_fma_f32 v13, v13, v2, v1
    v_fma_f32 v14, v14, v2, v1
    v_mfma_f32_32x32x16_bf16 v[48:63], a[0:3], v[176:179], v[48:63]
    ds_read_b64_tr_b16 a[28:29], v9 offset:22528
    ds_read_b64_tr_b16 a[30:31], v9 offset:23040
    v_mul_f32_e64 v11, v28, v11
    v_mul_f32_e64 v12, v29, v12
    v_mul_f32_e64 v13, v30, v13
    v_mul_f32_e64 v14, v31, v14
    v_exp_f32_e64 v11, v11
    v_mfma_f32_32x32x16_bf16 v[48:63], a[4:7], v[180:183], v[48:63]
    ds_read_b64_tr_b16 a[32:33], v9 offset:24576
    ds_read_b64_tr_b16 a[34:35], v9 offset:25088
    v_exp_f32_e64 v12, v12
    v_exp_f32_e64 v13, v13
    v_exp_f32_e64 v14, v14
    v_fma_f32 v11, v11, v3, v3
    v_fma_f32 v12, v12, v3, v3
    v_mfma_f32_32x32x16_bf16 v[48:63], a[8:11], v[184:187], v[48:63]
    ds_read_b64_tr_b16 a[36:37], v9 offset:26624
    ds_read_b64_tr_b16 a[38:39], v9 offset:27136
    v_fma_f32 v13, v13, v3, v3
    v_fma_f32 v14, v14, v3, v3
    v_rcp_f32_e64 v11, v11
    v_rcp_f32_e64 v12, v12
    v_rcp_f32_e64 v13, v13
    s_waitcnt lgkmcnt(6)
    v_mfma_f32_32x32x16_bf16 v[48:63], a[12:15], v[188:191], v[48:63]
    ds_read_b64_tr_b16 a[40:41], v9 offset:28672
    ds_read_b64_tr_b16 a[42:43], v9 offset:29184
    v_rcp_f32_e64 v14, v14
    v_mul_f32_e64 v28, v28, v11
    v_mul_f32_e64 v29, v29, v12
    v_mul_f32_e64 v30, v30, v13
    v_mul_f32_e64 v31, v31, v14
    v_mfma_f32_32x32x16_bf16 v[48:63], a[16:19], v[192:195], v[48:63]
    ds_read_b64_tr_b16 a[44:45], v9 offset:30720
    ds_read_b64_tr_b16 a[46:47], v9 offset:31232
    v_cvt_pk_bf16_f32 v22, v28, v29
    v_cvt_pk_bf16_f32 v23, v30, v31
    buffer_store_dwordx4 v[20:23], v0, s[16:19], s38 offen offset:512 sc1
    v_mul_f32_e64 v11, v32, v32
    v_mul_f32_e64 v12, v33, v33
    v_mfma_f32_32x32x16_bf16 v[48:63], a[20:23], v[196:199], v[48:63]
    s_waitcnt vmcnt(2)
    s_barrier
    ds_read_b64_tr_b16 a[0:1], v9 offset:32768
    ds_read_b64_tr_b16 a[2:3], v9 offset:33280
    v_mov_b32 v15, 1
    s_mov_b64 exec, 1
    buffer_atomic_add v15, off, s[16:19], s3  offset:0 sc1
    s_mov_b64 exec, -1
    v_mul_f32_e64 v13, v34, v34
    v_mul_f32_e64 v14, v35, v35
    v_fma_f32 v11, v11, v2, v1
    v_fma_f32 v12, v12, v2, v1
    v_fma_f32 v13, v13, v2, v1
    v_mfma_f32_32x32x16_bf16 v[48:63], a[24:27], v[200:203], v[48:63]
    ds_read_b64_tr_b16 a[4:5], v9 offset:34816
    ds_read_b64_tr_b16 a[6:7], v9 offset:35328
    v_fma_f32 v14, v14, v2, v1
    v_mul_f32_e64 v11, v32, v11
    v_mul_f32_e64 v12, v33, v12
    v_mul_f32_e64 v13, v34, v13
    v_mul_f32_e64 v14, v35, v14
    s_waitcnt lgkmcnt(6)
    v_mfma_f32_32x32x16_bf16 v[48:63], a[28:31], v[204:207], v[48:63]
    ds_read_b64_tr_b16 a[8:9], v9 offset:36864
    ds_read_b64_tr_b16 a[10:11], v9 offset:37376
    v_exp_f32_e64 v11, v11
    v_exp_f32_e64 v12, v12
    v_exp_f32_e64 v13, v13
    v_exp_f32_e64 v14, v14
    v_fma_f32 v11, v11, v3, v3
    v_mfma_f32_32x32x16_bf16 v[48:63], a[32:35], v[208:211], v[48:63]
    ds_read_b64_tr_b16 a[12:13], v9 offset:38912
    ds_read_b64_tr_b16 a[14:15], v9 offset:39424
    v_fma_f32 v12, v12, v3, v3
    v_fma_f32 v13, v13, v3, v3
    v_fma_f32 v14, v14, v3, v3
    v_rcp_f32_e64 v11, v11
    v_rcp_f32_e64 v12, v12
    v_mfma_f32_32x32x16_bf16 v[48:63], a[36:39], v[212:215], v[48:63]
    ds_read_b64_tr_b16 a[16:17], v9 offset:40960
    ds_read_b64_tr_b16 a[18:19], v9 offset:41472
    v_rcp_f32_e64 v13, v13
    v_rcp_f32_e64 v14, v14
    v_mul_f32_e64 v32, v32, v11
    v_mul_f32_e64 v33, v33, v12
    v_mul_f32_e64 v34, v34, v13
    v_mfma_f32_32x32x16_bf16 v[48:63], a[40:43], v[216:219], v[48:63]
    ds_read_b64_tr_b16 a[20:21], v9 offset:43008
    ds_read_b64_tr_b16 a[22:23], v9 offset:43520
    v_mul_f32_e64 v35, v35, v14
    v_cvt_pk_bf16_f32 v32, v32, v33
    v_cvt_pk_bf16_f32 v33, v34, v35
    v_mul_f32_e64 v11, v36, v36
    v_mul_f32_e64 v12, v37, v37
    s_waitcnt lgkmcnt(6)
    v_mfma_f32_32x32x16_bf16 v[48:63], a[44:47], v[220:223], v[48:63]
    ds_read_b64_tr_b16 a[24:25], v9 offset:45056
    ds_read_b64_tr_b16 a[26:27], v9 offset:45568
    v_mul_f32_e64 v13, v38, v38
    v_mul_f32_e64 v14, v39, v39
    v_fma_f32 v11, v11, v2, v1
    v_fma_f32 v12, v12, v2, v1
    v_fma_f32 v13, v13, v2, v1
    v_mfma_f32_32x32x16_bf16 v[48:63], a[0:3], v[224:227], v[48:63]
    ds_read_b64_tr_b16 a[28:29], v9 offset:47104
    ds_read_b64_tr_b16 a[30:31], v9 offset:47616
    v_fma_f32 v14, v14, v2, v1
    v_mul_f32_e64 v11, v36, v11
    v_mul_f32_e64 v12, v37, v12
    v_mul_f32_e64 v13, v38, v13
    v_mul_f32_e64 v14, v39, v14
    v_mfma_f32_32x32x16_bf16 v[48:63], a[4:7], v[228:231], v[48:63]
    v_exp_f32_e64 v11, v11
    v_exp_f32_e64 v12, v12
    v_exp_f32_e64 v13, v13
    v_exp_f32_e64 v14, v14
    v_fma_f32 v11, v11, v3, v3
    v_mfma_f32_32x32x16_bf16 v[48:63], a[8:11], v[232:235], v[48:63]
    ds_read_b64_tr_b16 a[32:33], v10 offset:49152
    ds_read_b64_tr_b16 a[34:35], v10 offset:49664
    v_fma_f32 v12, v12, v3, v3
    v_fma_f32 v13, v13, v3, v3
    v_fma_f32 v14, v14, v3, v3
    v_rcp_f32_e64 v11, v11
    v_rcp_f32_e64 v12, v12
    s_waitcnt lgkmcnt(4)
    v_mfma_f32_32x32x16_bf16 v[48:63], a[12:15], v[236:239], v[48:63]
    ds_read_b64_tr_b16 a[36:37], v10 offset:51200
    ds_read_b64_tr_b16 a[38:39], v10 offset:51712
    v_rcp_f32_e64 v13, v13
    v_rcp_f32_e64 v14, v14
    v_mul_f32_e64 v36, v36, v11
    v_mul_f32_e64 v37, v37, v12
    v_mul_f32_e64 v38, v38, v13
    v_mfma_f32_32x32x16_bf16 v[48:63], a[16:19], v[240:243], v[48:63]
    ds_read_b64_tr_b16 a[40:41], v10 offset:53248
    ds_read_b64_tr_b16 a[42:43], v10 offset:53760
    v_mul_f32_e64 v39, v39, v14
    v_cvt_pk_bf16_f32 v34, v36, v37
    v_cvt_pk_bf16_f32 v35, v38, v39
    buffer_store_dwordx4 v[32:35], v8, s[16:19], s38 offen offset:0 sc1
    v_mul_f32_e64 v11, v40, v40
    v_mfma_f32_32x32x16_bf16 v[48:63], a[20:23], v[244:247], v[48:63]
    ds_read_b64_tr_b16 a[44:45], v10 offset:55296
    ds_read_b64_tr_b16 a[46:47], v10 offset:55808
    v_mul_f32_e64 v12, v41, v41
    v_mul_f32_e64 v13, v42, v42
    v_mul_f32_e64 v14, v43, v43
    v_fma_f32 v11, v11, v2, v1
    v_fma_f32 v12, v12, v2, v1
    v_mfma_f32_32x32x16_bf16 v[48:63], a[24:27], v[248:251], v[48:63]
    ds_read_b64_tr_b16 a[0:1], v10 offset:57344
    ds_read_b64_tr_b16 a[2:3], v10 offset:57856
    v_fma_f32 v13, v13, v2, v1
    v_fma_f32 v14, v14, v2, v1
    v_mul_f32_e64 v11, v40, v11
    v_mul_f32_e64 v12, v41, v12
    v_mul_f32_e64 v13, v42, v13
    s_waitcnt lgkmcnt(6)
    v_mfma_f32_32x32x16_bf16 v[48:63], a[28:31], v[252:255], v[48:63]
    ds_read_b64_tr_b16 a[4:5], v10 offset:59392
    ds_read_b64_tr_b16 a[6:7], v10 offset:59904
    v_mul_f32_e64 v14, v43, v14
    v_exp_f32_e64 v11, v11
    v_exp_f32_e64 v12, v12
    v_exp_f32_e64 v13, v13
    v_exp_f32_e64 v14, v14
    v_mfma_f32_32x32x16_bf16 v[64:79], a[74:77], a[80:83], 0
    ds_read_b64_tr_b16 a[8:9], v10 offset:61440
    ds_read_b64_tr_b16 a[10:11], v10 offset:61952
    v_fma_f32 v11, v11, v3, v3
    v_fma_f32 v12, v12, v3, v3
    v_fma_f32 v13, v13, v3, v3
    v_fma_f32 v14, v14, v3, v3
    v_rcp_f32_e64 v11, v11
    v_mfma_f32_32x32x16_bf16 v[64:79], a[32:35], v[96:99], v[64:79]
    ds_read_b64_tr_b16 a[12:13], v10 offset:63488
    ds_read_b64_tr_b16 a[14:15], v10 offset:64000
    v_rcp_f32_e64 v12, v12
    v_rcp_f32_e64 v13, v13
    v_rcp_f32_e64 v14, v14
    v_mul_f32_e64 v40, v40, v11
    v_mul_f32_e64 v41, v41, v12
    v_mfma_f32_32x32x16_bf16 v[64:79], a[36:39], v[100:103], v[64:79]
    v_add_u32 v10, 65536, v10
    ds_read_b64_tr_b16 a[16:17], v10 offset:0
    ds_read_b64_tr_b16 a[18:19], v10 offset:512
    v_mul_f32_e64 v42, v42, v13
    v_mul_f32_e64 v43, v43, v14
    v_cvt_pk_bf16_f32 v36, v40, v41
    v_cvt_pk_bf16_f32 v37, v42, v43
    v_mul_f32_e64 v11, v44, v44
    s_waitcnt lgkmcnt(6)
    v_mfma_f32_32x32x16_bf16 v[64:79], a[40:43], v[104:107], v[64:79]
    ds_read_b64_tr_b16 a[20:21], v10 offset:2048
    ds_read_b64_tr_b16 a[22:23], v10 offset:2560
    v_mul_f32_e64 v12, v45, v45
    v_mul_f32_e64 v13, v46, v46
    v_mul_f32_e64 v14, v47, v47
    v_fma_f32 v11, v11, v2, v1
    v_fma_f32 v12, v12, v2, v1
    v_mfma_f32_32x32x16_bf16 v[64:79], a[44:47], v[108:111], v[64:79]
    ds_read_b64_tr_b16 a[24:25], v10 offset:4096
    ds_read_b64_tr_b16 a[26:27], v10 offset:4608
    v_fma_f32 v13, v13, v2, v1
    v_fma_f32 v14, v14, v2, v1
    v_mul_f32_e64 v11, v44, v11
    v_mul_f32_e64 v12, v45, v12
    v_mul_f32_e64 v13, v46, v13
    v_mfma_f32_32x32x16_bf16 v[64:79], a[0:3], v[112:115], v[64:79]
    ds_read_b64_tr_b16 a[28:29], v10 offset:6144
    ds_read_b64_tr_b16 a[30:31], v10 offset:6656
    v_mul_f32_e64 v14, v47, v14
    v_exp_f32_e64 v11, v11
    v_exp_f32_e64 v12, v12
    v_exp_f32_e64 v13, v13
    v_exp_f32_e64 v14, v14
    v_mfma_f32_32x32x16_bf16 v[64:79], a[4:7], v[116:119], v[64:79]
    ds_read_b64_tr_b16 a[32:33], v10 offset:8192
    ds_read_b64_tr_b16 a[34:35], v10 offset:8704
    v_fma_f32 v11, v11, v3, v3
    v_fma_f32 v12, v12, v3, v3
    v_fma_f32 v13, v13, v3, v3
    v_fma_f32 v14, v14, v3, v3
    v_rcp_f32_e64 v11, v11
    s_waitcnt lgkmcnt(6)
    v_mfma_f32_32x32x16_bf16 v[64:79], a[8:11], v[120:123], v[64:79]
    ds_read_b64_tr_b16 a[36:37], v10 offset:10240
    ds_read_b64_tr_b16 a[38:39], v10 offset:10752
    v_rcp_f32_e64 v12, v12
    v_rcp_f32_e64 v13, v13
    v_rcp_f32_e64 v14, v14
    v_mul_f32_e64 v44, v44, v11
    v_mul_f32_e64 v45, v45, v12
    v_mfma_f32_32x32x16_bf16 v[64:79], a[12:15], v[124:127], v[64:79]
    ds_read_b64_tr_b16 a[40:41], v10 offset:12288
    ds_read_b64_tr_b16 a[42:43], v10 offset:12800
    v_mul_f32_e64 v46, v46, v13
    v_mul_f32_e64 v47, v47, v14
    v_cvt_pk_bf16_f32 v38, v44, v45
    v_cvt_pk_bf16_f32 v39, v46, v47
    buffer_store_dwordx4 v[36:39], v8, s[16:19], s38 offen offset:512 sc1
    v_mfma_f32_32x32x16_bf16 v[64:79], a[16:19], v[128:131], v[64:79]
    ds_read_b64_tr_b16 a[44:45], v10 offset:14336
    ds_read_b64_tr_b16 a[46:47], v10 offset:14848
    v_mul_f32_e64 v11, v48, v48
    v_mul_f32_e64 v12, v49, v49
    v_mul_f32_e64 v13, v50, v50
    v_mul_f32_e64 v14, v51, v51
    v_mfma_f32_32x32x16_bf16 v[64:79], a[20:23], v[132:135], v[64:79]
    v_add_u32 v10, 4294836224, v10
    ds_read_b64_tr_b16 a[0:1], v10 offset:0
    ds_read_b64_tr_b16 a[2:3], v10 offset:512
    v_fma_f32 v11, v11, v2, v1
    v_fma_f32 v12, v12, v2, v1
    v_fma_f32 v13, v13, v2, v1
    v_fma_f32 v14, v14, v2, v1
    s_waitcnt lgkmcnt(6)
    v_mfma_f32_32x32x16_bf16 v[64:79], a[24:27], v[136:139], v[64:79]
    ds_read_b64_tr_b16 a[4:5], v10 offset:2048
    ds_read_b64_tr_b16 a[6:7], v10 offset:2560
    v_mul_f32_e64 v11, v48, v11
    v_mul_f32_e64 v12, v49, v12
    v_mul_f32_e64 v13, v50, v13
    v_mul_f32_e64 v14, v51, v14
    v_mfma_f32_32x32x16_bf16 v[64:79], a[28:31], v[140:143], v[64:79]
    ds_read_b64_tr_b16 a[8:9], v10 offset:4096
    ds_read_b64_tr_b16 a[10:11], v10 offset:4608
    v_exp_f32_e64 v11, v11
    v_exp_f32_e64 v12, v12
    v_exp_f32_e64 v13, v13
    v_exp_f32_e64 v14, v14
    v_mfma_f32_32x32x16_bf16 v[64:79], a[32:35], v[144:147], v[64:79]
    ds_read_b64_tr_b16 a[12:13], v10 offset:6144
    ds_read_b64_tr_b16 a[14:15], v10 offset:6656
    v_fma_f32 v11, v11, v3, v3
    v_fma_f32 v12, v12, v3, v3
    v_fma_f32 v13, v13, v3, v3
    v_fma_f32 v14, v14, v3, v3
    v_mfma_f32_32x32x16_bf16 v[64:79], a[36:39], v[148:151], v[64:79]
    ds_read_b64_tr_b16 a[16:17], v10 offset:8192
    ds_read_b64_tr_b16 a[18:19], v10 offset:8704
    v_rcp_f32_e64 v11, v11
    v_rcp_f32_e64 v12, v12
    v_rcp_f32_e64 v13, v13
    v_rcp_f32_e64 v14, v14
    s_waitcnt lgkmcnt(6)
    v_mfma_f32_32x32x16_bf16 v[64:79], a[40:43], v[152:155], v[64:79]
    ds_read_b64_tr_b16 a[20:21], v10 offset:10240
    ds_read_b64_tr_b16 a[22:23], v10 offset:10752
    v_mul_f32_e64 v48, v48, v11
    v_mul_f32_e64 v49, v49, v12
    v_mul_f32_e64 v50, v50, v13
    v_mul_f32_e64 v51, v51, v14
    v_mfma_f32_32x32x16_bf16 v[64:79], a[44:47], v[156:159], v[64:79]
    ds_read_b64_tr_b16 a[24:25], v10 offset:12288
    ds_read_b64_tr_b16 a[26:27], v10 offset:12800
    v_cvt_pk_bf16_f32 v48, v48, v49
    v_cvt_pk_bf16_f32 v49, v50, v51
    v_mul_f32_e64 v11, v52, v52
    v_mul_f32_e64 v12, v53, v53
    v_mfma_f32_32x32x16_bf16 v[64:79], a[0:3], v[160:163], v[64:79]
    ds_read_b64_tr_b16 a[28:29], v10 offset:14336
    ds_read_b64_tr_b16 a[30:31], v10 offset:14848
    v_mul_f32_e64 v13, v54, v54
    v_mul_f32_e64 v14, v55, v55
    v_fma_f32 v11, v11, v2, v1
    v_fma_f32 v12, v12, v2, v1
    v_mfma_f32_32x32x16_bf16 v[64:79], a[4:7], v[164:167], v[64:79]
    ds_read_b64_tr_b16 a[32:33], v10 offset:16384
    ds_read_b64_tr_b16 a[34:35], v10 offset:16896
    v_fma_f32 v13, v13, v2, v1
    v_fma_f32 v14, v14, v2, v1
    v_mul_f32_e64 v11, v52, v11
    v_mul_f32_e64 v12, v53, v12
    s_waitcnt lgkmcnt(6)
    v_mfma_f32_32x32x16_bf16 v[64:79], a[8:11], v[168:171], v[64:79]
    ds_read_b64_tr_b16 a[36:37], v10 offset:18432
    ds_read_b64_tr_b16 a[38:39], v10 offset:18944
    v_mul_f32_e64 v13, v54, v13
    v_mul_f32_e64 v14, v55, v14
    v_exp_f32_e64 v11, v11
    v_exp_f32_e64 v12, v12
    v_mfma_f32_32x32x16_bf16 v[64:79], a[12:15], v[172:175], v[64:79]
    ds_read_b64_tr_b16 a[40:41], v10 offset:20480
    ds_read_b64_tr_b16 a[42:43], v10 offset:20992
    v_exp_f32_e64 v13, v13
    v_exp_f32_e64 v14, v14
    v_fma_f32 v11, v11, v3, v3
    v_fma_f32 v12, v12, v3, v3
    v_mfma_f32_32x32x16_bf16 v[64:79], a[16:19], v[176:179], v[64:79]
    ds_read_b64_tr_b16 a[44:45], v10 offset:22528
    ds_read_b64_tr_b16 a[46:47], v10 offset:23040
    v_fma_f32 v13, v13, v3, v3
    v_fma_f32 v14, v14, v3, v3
    v_rcp_f32_e64 v11, v11
    v_rcp_f32_e64 v12, v12
    v_mfma_f32_32x32x16_bf16 v[64:79], a[20:23], v[180:183], v[64:79]
    ds_read_b64_tr_b16 a[0:1], v10 offset:24576
    ds_read_b64_tr_b16 a[2:3], v10 offset:25088
    v_rcp_f32_e64 v13, v13
    v_rcp_f32_e64 v14, v14
    v_mul_f32_e64 v52, v52, v11
    v_mul_f32_e64 v53, v53, v12
    s_waitcnt lgkmcnt(6)
    v_mfma_f32_32x32x16_bf16 v[64:79], a[24:27], v[184:187], v[64:79]
    ds_read_b64_tr_b16 a[4:5], v10 offset:26624
    ds_read_b64_tr_b16 a[6:7], v10 offset:27136
    v_mul_f32_e64 v54, v54, v13
    v_mul_f32_e64 v55, v55, v14
    v_cvt_pk_bf16_f32 v50, v52, v53
    v_cvt_pk_bf16_f32 v51, v54, v55
    v_mfma_f32_32x32x16_bf16 v[64:79], a[28:31], v[188:191], v[64:79]
    ds_read_b64_tr_b16 a[8:9], v10 offset:28672
    ds_read_b64_tr_b16 a[10:11], v10 offset:29184
    buffer_store_dwordx4 v[48:51], v0, s[16:19], s39 offen offset:0 sc1
    v_mul_f32_e64 v11, v56, v56
    v_mul_f32_e64 v12, v57, v57
    v_mul_f32_e64 v13, v58, v58
    v_mfma_f32_32x32x16_bf16 v[64:79], a[32:35], v[192:195], v[64:79]
    ds_read_b64_tr_b16 a[12:13], v10 offset:30720
    ds_read_b64_tr_b16 a[14:15], v10 offset:31232
    v_mul_f32_e64 v14, v59, v59
    v_fma_f32 v11, v11, v2, v1
    v_fma_f32 v12, v12, v2, v1
    v_fma_f32 v13, v13, v2, v1
    v_mfma_f32_32x32x16_bf16 v[64:79], a[36:39], v[196:199], v[64:79]
    ds_read_b64_tr_b16 a[16:17], v10 offset:32768
    ds_read_b64_tr_b16 a[18:19], v10 offset:33280
    v_fma_f32 v14, v14, v2, v1
    v_mul_f32_e64 v11, v56, v11
    v_mul_f32_e64 v12, v57, v12
    v_mul_f32_e64 v13, v58, v13
    s_waitcnt lgkmcnt(6)
    v_mfma_f32_32x32x16_bf16 v[64:79], a[40:43], v[200:203], v[64:79]
    ds_read_b64_tr_b16 a[20:21], v10 offset:34816
    ds_read_b64_tr_b16 a[22:23], v10 offset:35328
    v_mul_f32_e64 v14, v59, v14
    v_exp_f32_e64 v11, v11
    v_exp_f32_e64 v12, v12
    v_exp_f32_e64 v13, v13
    v_mfma_f32_32x32x16_bf16 v[64:79], a[44:47], v[204:207], v[64:79]
    ds_read_b64_tr_b16 a[24:25], v10 offset:36864
    ds_read_b64_tr_b16 a[26:27], v10 offset:37376
    v_exp_f32_e64 v14, v14
    v_fma_f32 v11, v11, v3, v3
    v_fma_f32 v12, v12, v3, v3
    v_fma_f32 v13, v13, v3, v3
    v_mfma_f32_32x32x16_bf16 v[64:79], a[0:3], v[208:211], v[64:79]
    ds_read_b64_tr_b16 a[28:29], v10 offset:38912
    ds_read_b64_tr_b16 a[30:31], v10 offset:39424
    v_fma_f32 v14, v14, v3, v3
    v_rcp_f32_e64 v11, v11
    v_rcp_f32_e64 v12, v12
    v_rcp_f32_e64 v13, v13
    v_mfma_f32_32x32x16_bf16 v[64:79], a[4:7], v[212:215], v[64:79]
    ds_read_b64_tr_b16 a[32:33], v10 offset:40960
    ds_read_b64_tr_b16 a[34:35], v10 offset:41472
    v_rcp_f32_e64 v14, v14
    v_mul_f32_e64 v56, v56, v11
    v_mul_f32_e64 v57, v57, v12
    v_mul_f32_e64 v58, v58, v13
    s_waitcnt lgkmcnt(6)
    v_mfma_f32_32x32x16_bf16 v[64:79], a[8:11], v[216:219], v[64:79]
    ds_read_b64_tr_b16 a[36:37], v10 offset:43008
    ds_read_b64_tr_b16 a[38:39], v10 offset:43520
    v_mul_f32_e64 v59, v59, v14
    v_cvt_pk_bf16_f32 v52, v56, v57
    v_cvt_pk_bf16_f32 v53, v58, v59
    v_mul_f32_e64 v11, v60, v60
    v_mfma_f32_32x32x16_bf16 v[64:79], a[12:15], v[220:223], v[64:79]
    ds_read_b64_tr_b16 a[40:41], v10 offset:45056
    ds_read_b64_tr_b16 a[42:43], v10 offset:45568
    v_mul_f32_e64 v12, v61, v61
    v_mul_f32_e64 v13, v62, v62
    v_mul_f32_e64 v14, v63, v63
    v_fma_f32 v11, v11, v2, v1
    v_mfma_f32_32x32x16_bf16 v[64:79], a[16:19], v[224:227], v[64:79]
    ds_read_b64_tr_b16 a[44:45], v10 offset:47104
    ds_read_b64_tr_b16 a[46:47], v10 offset:47616
    v_fma_f32 v12, v12, v2, v1
    v_fma_f32 v13, v13, v2, v1
    v_fma_f32 v14, v14, v2, v1
    v_mul_f32_e64 v11, v60, v11
    v_mfma_f32_32x32x16_bf16 v[64:79], a[20:23], v[228:231], v[64:79]
    v_mul_f32_e64 v12, v61, v12
    v_mul_f32_e64 v13, v62, v13
    v_mul_f32_e64 v14, v63, v14
    v_exp_f32_e64 v11, v11
    s_waitcnt lgkmcnt(4)
    v_mfma_f32_32x32x16_bf16 v[64:79], a[24:27], v[232:235], v[64:79]
    v_exp_f32_e64 v12, v12
    v_exp_f32_e64 v13, v13
    v_exp_f32_e64 v14, v14
    v_mfma_f32_32x32x16_bf16 v[64:79], a[28:31], v[236:239], v[64:79]
    v_fma_f32 v11, v11, v3, v3
    v_fma_f32 v12, v12, v3, v3
    v_fma_f32 v13, v13, v3, v3
    v_mfma_f32_32x32x16_bf16 v[64:79], a[32:35], v[240:243], v[64:79]
    v_fma_f32 v14, v14, v3, v3
    v_rcp_f32_e64 v11, v11
    v_rcp_f32_e64 v12, v12
    v_mfma_f32_32x32x16_bf16 v[64:79], a[36:39], v[244:247], v[64:79]
    v_rcp_f32_e64 v13, v13
    v_rcp_f32_e64 v14, v14
    v_mul_f32_e64 v60, v60, v11
    s_waitcnt lgkmcnt(0)
    v_mfma_f32_32x32x16_bf16 v[64:79], a[40:43], v[248:251], v[64:79]
    v_mul_f32_e64 v61, v61, v12
    v_mul_f32_e64 v62, v62, v13
    v_mul_f32_e64 v63, v63, v14
    v_mfma_f32_32x32x16_bf16 v[64:79], a[44:47], v[252:255], v[64:79]
    v_cvt_pk_bf16_f32 v54, v60, v61
    v_cvt_pk_bf16_f32 v55, v62, v63
    buffer_store_dwordx4 v[52:55], v0, s[16:19], s39 offen offset:512 sc1
    s_waitcnt vmcnt(2)
    s_barrier
    v_mov_b32 v15, 256
    s_mov_b64 exec, 1
    buffer_atomic_add v15, off, s[16:19], s3  offset:0 sc1
    s_mov_b64 exec, -1
    s_bfe_u32 s48, s2, 0x20001
    s_andn2_b32 s49, 1, s2
    s_lshl2_add_u32 s48, s49, s48
    s_lshl_b32 s48, s48, 8
    s_add_u32 s48, s48, 20447360
    s_cmp_eq_u32 s24, 0
    s_cselect_b32 s48, s48, 2130706432
    buffer_load_dwordx4 a[244:247], off, s[16:19], s48 sc1
    v_mul_f32_e64 v11, v64, v64
    v_mul_f32_e64 v12, v65, v65
    v_mul_f32_e64 v13, v66, v66
    v_mul_f32_e64 v14, v67, v67
    v_fma_f32 v11, v11, v2, v1
    v_fma_f32 v12, v12, v2, v1
    v_fma_f32 v13, v13, v2, v1
    v_fma_f32 v14, v14, v2, v1
    v_mul_f32_e64 v11, v64, v11
    v_mul_f32_e64 v12, v65, v12
    v_mul_f32_e64 v13, v66, v13
    v_mul_f32_e64 v14, v67, v14
    v_exp_f32_e64 v11, v11
    v_exp_f32_e64 v12, v12
    v_exp_f32_e64 v13, v13
    v_exp_f32_e64 v14, v14
    v_fma_f32 v11, v11, v3, v3
    v_fma_f32 v12, v12, v3, v3
    v_fma_f32 v13, v13, v3, v3
    v_fma_f32 v14, v14, v3, v3
    v_rcp_f32_e64 v11, v11
    v_rcp_f32_e64 v12, v12
    v_rcp_f32_e64 v13, v13
    v_rcp_f32_e64 v14, v14
    v_mul_f32_e64 v64, v64, v11
    v_mul_f32_e64 v65, v65, v12
    v_mul_f32_e64 v66, v66, v13
    v_mul_f32_e64 v67, v67, v14
    v_cvt_pk_bf16_f32 v64, v64, v65
    v_cvt_pk_bf16_f32 v65, v66, v67
    v_mul_f32_e64 v11, v68, v68
    v_mul_f32_e64 v12, v69, v69
    v_mul_f32_e64 v13, v70, v70
    v_mul_f32_e64 v14, v71, v71
    v_fma_f32 v11, v11, v2, v1
    v_fma_f32 v12, v12, v2, v1
    v_fma_f32 v13, v13, v2, v1
    v_fma_f32 v14, v14, v2, v1
    v_mul_f32_e64 v11, v68, v11
    v_mul_f32_e64 v12, v69, v12
    v_mul_f32_e64 v13, v70, v13
    v_mul_f32_e64 v14, v71, v14
    v_exp_f32_e64 v11, v11
    v_exp_f32_e64 v12, v12
    v_exp_f32_e64 v13, v13
    v_exp_f32_e64 v14, v14
    v_fma_f32 v11, v11, v3, v3
    v_fma_f32 v12, v12, v3, v3
    v_fma_f32 v13, v13, v3, v3
    v_fma_f32 v14, v14, v3, v3
    v_rcp_f32_e64 v11, v11
    v_rcp_f32_e64 v12, v12
    v_rcp_f32_e64 v13, v13
    v_rcp_f32_e64 v14, v14
    v_mul_f32_e64 v68, v68, v11
    v_mul_f32_e64 v69, v69, v12
    v_mul_f32_e64 v70, v70, v13
    v_mul_f32_e64 v71, v71, v14
    v_cvt_pk_bf16_f32 v66, v68, v69
    v_cvt_pk_bf16_f32 v67, v70, v71
    buffer_store_dwordx4 v[64:67], v8, s[16:19], s39 offen offset:0 sc1
    v_mul_f32_e64 v11, v72, v72
    v_mul_f32_e64 v12, v73, v73
    v_mul_f32_e64 v13, v74, v74
    v_mul_f32_e64 v14, v75, v75
    v_fma_f32 v11, v11, v2, v1
    v_fma_f32 v12, v12, v2, v1
    v_fma_f32 v13, v13, v2, v1
    v_fma_f32 v14, v14, v2, v1
    v_mul_f32_e64 v11, v72, v11
    v_mul_f32_e64 v12, v73, v12
    v_mul_f32_e64 v13, v74, v13
    v_mul_f32_e64 v14, v75, v14
    v_exp_f32_e64 v11, v11
    v_exp_f32_e64 v12, v12
    v_exp_f32_e64 v13, v13
    v_exp_f32_e64 v14, v14
    v_fma_f32 v11, v11, v3, v3
    v_fma_f32 v12, v12, v3, v3
    v_fma_f32 v13, v13, v3, v3
    v_fma_f32 v14, v14, v3, v3
    v_rcp_f32_e64 v11, v11
    v_rcp_f32_e64 v12, v12
    v_rcp_f32_e64 v13, v13
    v_rcp_f32_e64 v14, v14
    v_mul_f32_e64 v72, v72, v11
    v_mul_f32_e64 v73, v73, v12
    v_mul_f32_e64 v74, v74, v13
    v_mul_f32_e64 v75, v75, v14
    v_cvt_pk_bf16_f32 v68, v72, v73
    v_cvt_pk_bf16_f32 v69, v74, v75
    v_mul_f32_e64 v11, v76, v76
    v_mul_f32_e64 v12, v77, v77
    v_mul_f32_e64 v13, v78, v78
    v_mul_f32_e64 v14, v79, v79
    v_fma_f32 v11, v11, v2, v1
    v_fma_f32 v12, v12, v2, v1
    v_fma_f32 v13, v13, v2, v1
    v_fma_f32 v14, v14, v2, v1
    v_mul_f32_e64 v11, v76, v11
    v_mul_f32_e64 v12, v77, v12
    v_mul_f32_e64 v13, v78, v13
    v_mul_f32_e64 v14, v79, v14
    v_exp_f32_e64 v11, v11
    v_exp_f32_e64 v12, v12
    v_exp_f32_e64 v13, v13
    v_exp_f32_e64 v14, v14
    v_fma_f32 v11, v11, v3, v3
    v_fma_f32 v12, v12, v3, v3
    v_fma_f32 v13, v13, v3, v3
    v_fma_f32 v14, v14, v3, v3
    v_rcp_f32_e64 v11, v11
    v_rcp_f32_e64 v12, v12
    v_rcp_f32_e64 v13, v13
    v_rcp_f32_e64 v14, v14
    v_mul_f32_e64 v76, v76, v11
    v_mul_f32_e64 v77, v77, v12
    v_mul_f32_e64 v78, v78, v13
    v_mul_f32_e64 v79, v79, v14
    v_cvt_pk_bf16_f32 v70, v76, v77
    v_cvt_pk_bf16_f32 v71, v78, v79
    buffer_store_dwordx4 v[68:71], v8, s[16:19], s39 offen offset:512 sc1
K1_P2C:
    s_mov_b32 s65, 0x10000
    s_mov_b32 s64, 1
K1_P2A:
    s_load_dwordx2 s[84:85], s[0:1], 72
    s_bfe_u32 s21, s2, 0x20001
    s_andn2_b32 s22, 1, s2
    s_lshl2_add_u32 s21, s22, s21
    s_lshr_b32 s22, s2, 3
    s_lshr_b32 s23, s22, 3
    s_lshl_b32 s26, s21, 2
    s_add_u32 s23, s23, s26
    s_lshr_b32 s42, s23, 1
    s_lshl_b32 s48, s42, 7
    s_add_u32 s48, s48, 20447232
    s_mov_b32 s20, s24
    s_cmp_eq_u32 s20, 0
    s_cselect_b32 s48, s48, 2130706432
    v_accvgpr_read_b32 v0, a117
    s_and_b32 s27, s22, 7
    s_mul_i32 s28, s23, 74
    s_mul_i32 s29, s27, 74
    v_and_b32 v3, 63, v0
    s_lshr_b32 s42, s42, 1
    s_mul_i32 s43, s42, 86
    s_lshr_b32 s43, s43, 8
    s_mul_i32 s43, s43, 3
    s_sub_u32 s42, s42, s43
    s_lshr_b32 s43, s20, 1
    s_lshl_b32 s43, s43, 2
    s_add_u32 s43, s43, s20
    v_lshlrev_b32 v1, 4, v3
    v_add_u32 v2, 0x1000, v1
    s_lshl_b32 s37, s42, 1
    s_add_u32 s37, s37, s43
    s_add_u32 s38, s37, s28
    s_lshl_b32 s50, s38, 12
    s_add_u32 s38, s37, s29
    s_mul_i32 s38, s38, 5120
    s_add_u32 s54, s38, 10485760
    s_add_u32 s42, s42, 1
    s_cmp_eq_u32 s42, 3
    s_cselect_b32 s42, 0, s42
    s_lshl_b32 s37, s42, 1
    s_add_u32 s37, s37, s43
    s_add_u32 s38, s37, s28
    s_lshl_b32 s51, s38, 12
    s_add_u32 s38, s37, s29
    s_mul_i32 s38, s38, 5120
    s_add_u32 s55, s38, 10485760
    s_add_u32 s42, s42, 1
    s_cmp_eq_u32 s42, 3
    s_cselect_b32 s42, 0, s42
    s_lshl_b32 s37, s42, 1
    s_add_u32 s37, s37, s43
    s_add_u32 s38, s37, s28
    s_lshl_b32 s52, s38, 12
    s_add_u32 s38, s37, s29
    s_mul_i32 s38, s38, 5120
    s_add_u32 s56, s38, 10485760
    s_add_u32 s28, s28, s20
    s_add_u32 s29, s29, s20
    s_lshl_b32 s53, s28, 12
    s_mul_i32 s29, s29, 5120
    s_add_u32 s57, s29, 10485760
    s_lshr_b32 s37, s2, 6
    s_mul_i32 s61, s37, 61440
    s_mul_i32 s62, s37, 20480
    s_add_u32 s63, s62, 245760
    s_cmp_eq_u32 s37, 2
    s_cselect_b32 s63, 358400, s63
    s_cmp_eq_u32 s37, 3
    s_cselect_b32 s63, 2130706432, s63
    s_add_u32 s63, s63, s57
    s_add_u32 s62, s62, s57
    s_add_u32 s62, s62, 276480
    s_add_u32 s49, s61, s55
    s_add_u32 s61, s61, s56
    v_min_u32 v23, 39, v3
    v_lshlrev_b32 v23, 7, v23
    s_waitcnt lgkmcnt(0)
    s_mov_b32 s8, s84
    s_and_b32 s9, s85, 0xffff
    s_mov_b32 s10, 2621440
    s_mov_b32 s11, 0x20000
    s_mov_b32 s12, s90
    s_and_b32 s13, s91, 0xffff
    s_mov_b32 s14, 1280
    s_mov_b32 s15, 0x20000
    s_cmp_lg_u32 s20, 0
    s_cbranch_scc1 P2Aa_ok
    s_waitcnt vmcnt(2)
    s_mov_b32 s38, 0
    s_branch P2Aa_c
P2Aa_l:
    s_sleep 8
    buffer_load_dwordx4 a[244:247], off, s[16:19], s48 sc1
    s_add_u32 s38, s38, 1
    s_waitcnt vmcnt(0)
    s_cmp_ge_u32 s38, 0x20000
    s_cbranch_scc1 P2Aa_ok
P2Aa_c:
    v_accvgpr_read_b32 v19, a244
    s_nop 1
    v_readfirstlane_b32 s37, v19
    s_bfe_u32 s37, s37, 524288
    s_cmp_ge_u32 s37, 8
    s_cbranch_scc0 P2Aa_l
    v_accvgpr_read_b32 v19, a245
    s_nop 1
    v_readfirstlane_b32 s37, v19
    s_bfe_u32 s37, s37, 524288
    s_cmp_ge_u32 s37, 48
    s_cbranch_scc0 P2Aa_l
P2Aa_ok:
    s_barrier
    s_add_u32 s24, s50, 0
    s_add_u32 s25, s54, 0
    buffer_load_dwordx4 v[44:47], v1, s[16:19], s25 offen offset:0 sc1
    buffer_load_dwordx4 v[48:51], v1, s[16:19], s25 offen offset:1024 sc1
    buffer_load_dwordx4 v[52:55], v1, s[16:19], s25 offen offset:2048 sc1
    buffer_load_dwordx4 v[56:59], v1, s[16:19], s25 offen offset:3072 sc1
    buffer_load_dwordx4 v[60:63], v2, s[16:19], s25 offen offset:0 sc1
    buffer_load_dwordx4 v[28:31], v1, s[16:19], s24 offen offset:0 sc1
    buffer_load_dwordx4 v[32:35], v1, s[16:19], s24 offen offset:1024 sc1
    buffer_load_dwordx4 v[36:39], v1, s[16:19], s24 offen offset:2048 sc1
    buffer_load_dwordx4 v[40:43], v1, s[16:19], s24 offen offset:3072 sc1
    s_add_u32 s24, s50, 49152
    s_add_u32 s25, s54, 61440
    buffer_load_dwordx4 v[80:83], v1, s[16:19], s25 offen offset:0 sc1
    buffer_load_dwordx4 v[84:87], v1, s[16:19], s25 offen offset:1024 sc1
    buffer_load_dwordx4 v[88:91], v1, s[16:19], s25 offen offset:2048 sc1
    buffer_load_dwordx4 v[92:95], v1, s[16:19], s25 offen offset:3072 sc1
    buffer_load_dwordx4 v[96:99], v2, s[16:19], s25 offen offset:0 sc1
    buffer_load_dwordx4 v[64:67], v1, s[16:19], s24 offen offset:0 sc1
    buffer_load_dwordx4 v[68:71], v1, s[16:19], s24 offen offset:1024 sc1
    buffer_load_dwordx4 v[72:75], v1, s[16:19], s24 offen offset:2048 sc1
    buffer_load_dwordx4 v[76:79], v1, s[16:19], s24 offen offset:3072 sc1
    s_add_u32 s24, s50, 98304
    s_add_u32 s25, s54, 122880
    buffer_load_dwordx4 v[116:119], v1, s[16:19], s25 offen offset:0 sc1
    buffer_load_dwordx4 v[120:123], v1, s[16:19], s25 offen offset:1024 sc1
    buffer_load_dwordx4 v[124:127], v1, s[16:19], s25 offen offset:2048 sc1
    buffer_load_dwordx4 v[128:131], v1, s[16:19], s25 offen offset:3072 sc1
    buffer_load_dwordx4 v[132:135], v2, s[16:19], s25 offen offset:0 sc1
    buffer_load_dwordx4 v[100:103], v1, s[16:19], s24 offen offset:0 sc1
    buffer_load_dwordx4 v[104:107], v1, s[16:19], s24 offen offset:1024 sc1
    buffer_load_dwordx4 v[108:111], v1, s[16:19], s24 offen offset:2048 sc1
    buffer_load_dwordx4 v[112:115], v1, s[16:19], s24 offen offset:3072 sc1
    s_waitcnt vmcnt(27)
    s_barrier
    v_mov_b32 v10, s65
    v_lshlrev_b32 v11, 7, v3
    s_mov_b64 exec, 1
    s_mov_b32 exec_lo, s64
    buffer_atomic_add v10, v11, s[16:19], s3 offen offset:0 sc1
    s_mov_b64 exec, -1
    buffer_load_dwordx4 a[244:247], off, s[16:19], s48 sc1
    s_add_u32 s24, s50, 147456
    s_add_u32 s25, s54, 184320
    buffer_load_dwordx4 v[152:155], v1, s[16:19], s25 offen offset:0 sc1
    buffer_load_dwordx4 v[156:159], v1, s[16:19], s25 offen offset:1024 sc1
    buffer_load_dwordx4 v[160:163], v1, s[16:19], s25 offen offset:2048 sc1
    buffer_load_dwordx4 v[164:167], v1, s[16:19], s25 offen offset:3072 sc1
    buffer_load_dwordx4 v[168:171], v2, s[16:19], s25 offen offset:0 sc1
    buffer_load_dwordx4 v[136:139], v1, s[16:19], s24 offen offset:0 sc1
    buffer_load_dwordx4 v[140:143], v1, s[16:19], s24 offen offset:1024 sc1
    buffer_load_dwordx4 v[144:147], v1, s[16:19], s24 offen offset:2048 sc1
    buffer_load_dwordx4 v[148:151], v1, s[16:19], s24 offen offset:3072 sc1
    s_cmp_lg_u32 s20, 0
    s_cbranch_scc1 P2Ab_ok
    s_waitcnt vmcnt(9)
    s_mov_b32 s38, 0
    s_branch P2Ab_c
P2Ab_l:
    s_sleep 8
    buffer_load_dwordx4 a[244:247], off, s[16:19], s48 sc1
    s_add_u32 s38, s38, 1
    s_waitcnt vmcnt(0)
    s_cmp_ge_u32 s38, 0x20000
    s_cbranch_scc1 P2Ab_ok
P2Ab_c:
    v_accvgpr_read_b32 v19, a244
    s_nop 1
    v_readfirstlane_b32 s37, v19
    s_bfe_u32 s37, s37, 524296
    s_cmp_ge_u32 s37, 8
    s_cbranch_scc0 P2Ab_l
P2Ab_ok:
    s_barrier
    s_add_u32 s24, s51, 0
    s_add_u32 s25, s55, 0
    buffer_load_dwordx4 a[96:99], v1, s[16:19], s25 offen offset:0 sc1
    buffer_load_dwordx4 a[100:103], v1, s[16:19], s25 offen offset:1024 sc1
    buffer_load_dwordx4 a[104:107], v1, s[16:19], s25 offen offset:2048 sc1
    buffer_load_dwordx4 a[108:111], v1, s[16:19], s25 offen offset:3072 sc1
    buffer_load_dwordx4 a[112:115], v2, s[16:19], s25 offen offset:0 sc1
    buffer_load_dwordx4 a[80:83], v1, s[16:19], s24 offen offset:0 sc1
    buffer_load_dwordx4 a[84:87], v1, s[16:19], s24 offen offset:1024 sc1
    buffer_load_dwordx4 a[88:91], v1, s[16:19], s24 offen offset:2048 sc1
    buffer_load_dwordx4 a[92:95], v1, s[16:19], s24 offen offset:3072 sc1
    s_waitcnt vmcnt(38)
    v_mfma_f32_16x16x32_bf16 a[0:3], v[44:47], v[28:31], 0
    buffer_load_dwordx4 a[244:247], off, s[16:19], s48 sc1
    v_mfma_f32_16x16x32_bf16 a[4:7], v[48:51], v[28:31], 0
    s_add_u32 s24, s51, 49152
    v_mfma_f32_16x16x32_bf16 a[8:11], v[52:55], v[28:31], 0
    s_add_u32 s25, s55, 61440
    v_mfma_f32_16x16x32_bf16 a[12:15], v[56:59], v[28:31], 0
    buffer_load_dwordx4 a[132:135], v1, s[16:19], s25 offen offset:0 sc1
    v_mfma_f32_16x16x32_bf16 a[16:19], v[60:63], v[28:31], 0
    buffer_load_dwordx4 a[136:139], v1, s[16:19], s25 offen offset:1024 sc1
    v_mfma_f32_16x16x32_bf16 a[20:23], v[44:47], v[32:35], 0
    buffer_load_dwordx4 a[140:143], v1, s[16:19], s25 offen offset:2048 sc1
    v_mfma_f32_16x16x32_bf16 a[24:27], v[48:51], v[32:35], 0
    buffer_load_dwordx4 a[144:147], v1, s[16:19], s25 offen offset:3072 sc1
    v_mfma_f32_16x16x32_bf16 a[28:31], v[52:55], v[32:35], 0
    buffer_load_dwordx4 a[148:151], v2, s[16:19], s25 offen offset:0 sc1
    v_mfma_f32_16x16x32_bf16 a[32:35], v[56:59], v[32:35], 0
    buffer_load_dwordx4 a[116:119], v1, s[16:19], s24 offen offset:0 sc1
    v_mfma_f32_16x16x32_bf16 a[36:39], v[60:63], v[32:35], 0
    buffer_load_dwordx4 a[120:123], v1, s[16:19], s24 offen offset:1024 sc1
    v_mfma_f32_16x16x32_bf16 a[40:43], v[44:47], v[36:39], 0
    buffer_load_dwordx4 a[124:127], v1, s[16:19], s24 offen offset:2048 sc1
    v_mfma_f32_16x16x32_bf16 a[44:47], v[48:51], v[36:39], 0
    buffer_load_dwordx4 a[128:131], v1, s[16:19], s24 offen offset:3072 sc1
    v_mfma_f32_16x16x32_bf16 a[48:51], v[52:55], v[36:39], 0
    v_mfma_f32_16x16x32_bf16 a[52:55], v[56:59], v[36:39], 0
    v_mfma_f32_16x16x32_bf16 a[56:59], v[60:63], v[36:39], 0
    v_mfma_f32_16x16x32_bf16 a[60:63], v[44:47], v[40:43], 0
    v_mfma_f32_16x16x32_bf16 a[64:67], v[48:51], v[40:43], 0
    v_mfma_f32_16x16x32_bf16 a[68:71], v[52:55], v[40:43], 0
    v_mfma_f32_16x16x32_bf16 a[72:75], v[56:59], v[40:43], 0
    v_mfma_f32_16x16x32_bf16 a[76:79], v[60:63], v[40:43], 0
    s_waitcnt vmcnt(39)
    v_mfma_f32_16x16x32_bf16 a[0:3], v[80:83], v[64:67], a[0:3]
    s_add_u32 s24, s51, 98304
    v_mfma_f32_16x16x32_bf16 a[4:7], v[84:87], v[64:67], a[4:7]
    s_add_u32 s25, s55, 122880
    v_mfma_f32_16x16x32_bf16 a[8:11], v[88:91], v[64:67], a[8:11]
    buffer_load_dwordx4 v[44:47], v1, s[16:19], s25 offen offset:0 sc1
    v_mfma_f32_16x16x32_bf16 a[12:15], v[92:95], v[64:67], a[12:15]
    buffer_load_dwordx4 v[48:51], v1, s[16:19], s25 offen offset:1024 sc1
    v_mfma_f32_16x16x32_bf16 a[16:19], v[96:99], v[64:67], a[16:19]
    buffer_load_dwordx4 v[52:55], v1, s[16:19], s25 offen offset:2048 sc1
    v_mfma_f32_16x16x32_bf16 a[20:23], v[80:83], v[68:71], a[20:23]
    buffer_load_dwordx4 v[56:59], v1, s[16:19], s25 offen offset:3072 sc1
    v_mfma_f32_16x16x32_bf16 a[24:27], v[84:87], v[68:71], a[24:27]
    buffer_load_dwordx4 v[60:63], v2, s[16:19], s25 offen offset:0 sc1
    v_mfma_f32_16x16x32_bf16 a[28:31], v[88:91], v[68:71], a[28:31]
    buffer_load_dwordx4 v[28:31], v1, s[16:19], s24 offen offset:0 sc1
    v_mfma_f32_16x16x32_bf16 a[32:35], v[92:95], v[68:71], a[32:35]
    buffer_load_dwordx4 v[32:35], v1, s[16:19], s24 offen offset:1024 sc1
    v_mfma_f32_16x16x32_bf16 a[36:39], v[96:99], v[68:71], a[36:39]
    buffer_load_dwordx4 v[36:39], v1, s[16:19], s24 offen offset:2048 sc1
    v_mfma_f32_16x16x32_bf16 a[40:43], v[80:83], v[72:75], a[40:43]
    buffer_load_dwordx4 v[40:43], v1, s[16:19], s24 offen offset:3072 sc1
    v_mfma_f32_16x16x32_bf16 a[44:47], v[84:87], v[72:75], a[44:47]
    v_mfma_f32_16x16x32_bf16 a[48:51], v[88:91], v[72:75], a[48:51]
    v_mfma_f32_16x16x32_bf16 a[52:55], v[92:95], v[72:75], a[52:55]
    v_mfma_f32_16x16x32_bf16 a[56:59], v[96:99], v[72:75], a[56:59]
    v_mfma_f32_16x16x32_bf16 a[60:63], v[80:83], v[76:79], a[60:63]
    v_mfma_f32_16x16x32_bf16 a[64:67], v[84:87], v[76:79], a[64:67]
    v_mfma_f32_16x16x32_bf16 a[68:71], v[88:91], v[76:79], a[68:71]
    v_mfma_f32_16x16x32_bf16 a[72:75], v[92:95], v[76:79], a[72:75]
    v_mfma_f32_16x16x32_bf16 a[76:79], v[96:99], v[76:79], a[76:79]
    s_waitcnt vmcnt(39)
    v_mfma_f32_16x16x32_bf16 a[0:3], v[116:119], v[100:103], a[0:3]
    s_add_u32 s24, s51, 147456
    v_mfma_f32_16x16x32_bf16 a[4:7], v[120:123], v[100:103], a[4:7]
    s_add_u32 s25, s55, 184320
    v_mfma_f32_16x16x32_bf16 a[8:11], v[124:127], v[100:103], a[8:11]
    buffer_load_dwordx4 v[80:83], v1, s[16:19], s25 offen offset:0 sc1
    v_mfma_f32_16x16x32_bf16 a[12:15], v[128:131], v[100:103], a[12:15]
    buffer_load_dwordx4 v[84:87], v1, s[16:19], s25 offen offset:1024 sc1
    v_mfma_f32_16x16x32_bf16 a[16:19], v[132:135], v[100:103], a[16:19]
    buffer_load_dwordx4 v[88:91], v1, s[16:19], s25 offen offset:2048 sc1
    v_mfma_f32_16x16x32_bf16 a[20:23], v[116:119], v[104:107], a[20:23]
    buffer_load_dwordx4 v[92:95], v1, s[16:19], s25 offen offset:3072 sc1
    v_mfma_f32_16x16x32_bf16 a[24:27], v[120:123], v[104:107], a[24:27]
    buffer_load_dwordx4 v[96:99], v2, s[16:19], s25 offen offset:0 sc1
    v_mfma_f32_16x16x32_bf16 a[28:31], v[124:127], v[104:107], a[28:31]
    buffer_load_dwordx4 v[64:67], v1, s[16:19], s24 offen offset:0 sc1
    v_mfma_f32_16x16x32_bf16 a[32:35], v[128:131], v[104:107], a[32:35]
    buffer_load_dwordx4 v[68:71], v1, s[16:19], s24 offen offset:1024 sc1
    v_mfma_f32_16x16x32_bf16 a[36:39], v[132:135], v[104:107], a[36:39]
    buffer_load_dwordx4 v[72:75], v1, s[16:19], s24 offen offset:2048 sc1
    v_mfma_f32_16x16x32_bf16 a[40:43], v[116:119], v[108:111], a[40:43]
    buffer_load_dwordx4 v[76:79], v1, s[16:19], s24 offen offset:3072 sc1
    v_mfma_f32_16x16x32_bf16 a[44:47], v[120:123], v[108:111], a[44:47]
    v_mfma_f32_16x16x32_bf16 a[48:51], v[124:127], v[108:111], a[48:51]
    v_mfma_f32_16x16x32_bf16 a[52:55], v[128:131], v[108:111], a[52:55]
    v_mfma_f32_16x16x32_bf16 a[56:59], v[132:135], v[108:111], a[56:59]
    v_mfma_f32_16x16x32_bf16 a[60:63], v[116:119], v[112:115], a[60:63]
    v_mfma_f32_16x16x32_bf16 a[64:67], v[120:123], v[112:115], a[64:67]
    v_mfma_f32_16x16x32_bf16 a[68:71], v[124:127], v[112:115], a[68:71]
    v_mfma_f32_16x16x32_bf16 a[72:75], v[128:131], v[112:115], a[72:75]
    v_mfma_f32_16x16x32_bf16 a[76:79], v[132:135], v[112:115], a[76:79]
    s_waitcnt vmcnt(37)
    s_cmp_lg_u32 s20, 0
    s_cbranch_scc1 P2Ac_ok
    s_waitcnt vmcnt(27)
    s_mov_b32 s38, 0
    s_branch P2Ac_c
P2Ac_l:
    s_sleep 8
    buffer_load_dwordx4 a[244:247], off, s[16:19], s48 sc1
    s_add_u32 s38, s38, 1
    s_waitcnt vmcnt(0)
    s_cmp_ge_u32 s38, 0x20000
    s_cbranch_scc1 P2Ac_ok
P2Ac_c:
    v_accvgpr_read_b32 v10, a244
    s_nop 1
    v_readfirstlane_b32 s37, v10
    s_bfe_u32 s37, s37, 524304
    s_cmp_ge_u32 s37, 11
    s_cbranch_scc0 P2Ac_l
P2Ac_ok:
    s_barrier
    v_mfma_f32_16x16x32_bf16 a[0:3], v[152:155], v[136:139], a[0:3]
    s_add_u32 s24, s52, 0
    v_mfma_f32_16x16x32_bf16 a[4:7], v[156:159], v[136:139], a[4:7]
    s_add_u32 s25, s56, 0
    v_mfma_f32_16x16x32_bf16 a[8:11], v[160:163], v[136:139], a[8:11]
    buffer_load_dwordx4 v[116:119], v1, s[16:19], s25 offen offset:0 sc1
    v_mfma_f32_16x16x32_bf16 a[12:15], v[164:167], v[136:139], a[12:15]
    buffer_load_dwordx4 v[120:123], v1, s[16:19], s25 offen offset:1024 sc1
    v_mfma_f32_16x16x32_bf16 a[16:19], v[168:171], v[136:139], a[16:19]
    buffer_load_dwordx4 v[124:127], v1, s[16:19], s25 offen offset:2048 sc1
    v_mfma_f32_16x16x32_bf16 a[20:23], v[152:155], v[140:143], a[20:23]
    buffer_load_dwordx4 v[128:131], v1, s[16:19], s25 offen offset:3072 sc1
    v_mfma_f32_16x16x32_bf16 a[24:27], v[156:159], v[140:143], a[24:27]
    buffer_load_dwordx4 v[132:135], v2, s[16:19], s25 offen offset:0 sc1
    v_mfma_f32_16x16x32_bf16 a[28:31], v[160:163], v[140:143], a[28:31]
    buffer_load_dwordx4 v[100:103], v1, s[16:19], s24 offen offset:0 sc1
    v_mfma_f32_16x16x32_bf16 a[32:35], v[164:167], v[140:143], a[32:35]
    buffer_load_dwordx4 v[104:107], v1, s[16:19], s24 offen offset:1024 sc1
    v_mfma_f32_16x16x32_bf16 a[36:39], v[168:171], v[140:143], a[36:39]
    buffer_load_dwordx4 v[108:111], v1, s[16:19], s24 offen offset:2048 sc1
    v_mfma_f32_16x16x32_bf16 a[40:43], v[152:155], v[144:147], a[40:43]
    buffer_load_dwordx4 v[112:115], v1, s[16:19], s24 offen offset:3072 sc1
    v_mfma_f32_16x16x32_bf16 a[44:47], v[156:159], v[144:147], a[44:47]
    v_mfma_f32_16x16x32_bf16 a[48:51], v[160:163], v[144:147], a[48:51]
    v_mfma_f32_16x16x32_bf16 a[52:55], v[164:167], v[144:147], a[52:55]
    v_mfma_f32_16x16x32_bf16 a[56:59], v[168:171], v[144:147], a[56:59]
    v_mfma_f32_16x16x32_bf16 a[60:63], v[152:155], v[148:151], a[60:63]
    v_mfma_f32_16x16x32_bf16 a[64:67], v[156:159], v[148:151], a[64:67]
    v_mfma_f32_16x16x32_bf16 a[68:71], v[160:163], v[148:151], a[68:71]
    v_mfma_f32_16x16x32_bf16 a[72:75], v[164:167], v[148:151], a[72:75]
    v_mfma_f32_16x16x32_bf16 a[76:79], v[168:171], v[148:151], a[76:79]
    s_waitcnt vmcnt(37)
    v_mfma_f32_16x16x32_bf16 a[0:3], a[96:99], a[80:83], a[0:3]
    s_add_u32 s24, s52, 49152
    v_mfma_f32_16x16x32_bf16 a[4:7], a[100:103], a[80:83], a[4:7]
    s_add_u32 s25, s56, 61440
    v_mfma_f32_16x16x32_bf16 a[8:11], a[104:107], a[80:83], a[8:11]
    buffer_load_dwordx4 v[152:155], v1, s[16:19], s25 offen offset:0 sc1
    v_mfma_f32_16x16x32_bf16 a[12:15], a[108:111], a[80:83], a[12:15]
    buffer_load_dwordx4 v[156:159], v1, s[16:19], s25 offen offset:1024 sc1
    v_mfma_f32_16x16x32_bf16 a[16:19], a[112:115], a[80:83], a[16:19]
    buffer_load_dwordx4 v[160:163], v1, s[16:19], s25 offen offset:2048 sc1
    v_mfma_f32_16x16x32_bf16 a[20:23], a[96:99], a[84:87], a[20:23]
    buffer_load_dwordx4 v[164:167], v1, s[16:19], s25 offen offset:3072 sc1
    v_mfma_f32_16x16x32_bf16 a[24:27], a[100:103], a[84:87], a[24:27]
    buffer_load_dwordx4 v[168:171], v2, s[16:19], s25 offen offset:0 sc1
    v_mfma_f32_16x16x32_bf16 a[28:31], a[104:107], a[84:87], a[28:31]
    buffer_load_dwordx4 v[136:139], v1, s[16:19], s24 offen offset:0 sc1
    v_mfma_f32_16x16x32_bf16 a[32:35], a[108:111], a[84:87], a[32:35]
    buffer_load_dwordx4 v[140:143], v1, s[16:19], s24 offen offset:1024 sc1
    v_mfma_f32_16x16x32_bf16 a[36:39], a[112:115], a[84:87], a[36:39]
    buffer_load_dwordx4 v[144:147], v1, s[16:19], s24 offen offset:2048 sc1
    v_mfma_f32_16x16x32_bf16 a[40:43], a[96:99], a[88:91], a[40:43]
    buffer_load_dwordx4 v[148:151], v1, s[16:19], s24 offen offset:3072 sc1
    v_mfma_f32_16x16x32_bf16 a[44:47], a[100:103], a[88:91], a[44:47]
    v_mfma_f32_16x16x32_bf16 a[48:51], a[104:107], a[88:91], a[48:51]
    v_mfma_f32_16x16x32_bf16 a[52:55], a[108:111], a[88:91], a[52:55]
    v_mfma_f32_16x16x32_bf16 a[56:59], a[112:115], a[88:91], a[56:59]
    v_mfma_f32_16x16x32_bf16 a[60:63], a[96:99], a[92:95], a[60:63]
    v_mfma_f32_16x16x32_bf16 a[64:67], a[100:103], a[92:95], a[64:67]
    v_mfma_f32_16x16x32_bf16 a[68:71], a[104:107], a[92:95], a[68:71]
    v_mfma_f32_16x16x32_bf16 a[72:75], a[108:111], a[92:95], a[72:75]
    v_mfma_f32_16x16x32_bf16 a[76:79], a[112:115], a[92:95], a[76:79]
    s_waitcnt vmcnt(36)
    v_mfma_f32_16x16x32_bf16 a[0:3], a[132:135], a[116:119], a[0:3]
    s_add_u32 s24, s52, 98304
    v_mfma_f32_16x16x32_bf16 a[4:7], a[136:139], a[116:119], a[4:7]
    s_add_u32 s25, s56, 122880
    v_mfma_f32_16x16x32_bf16 a[8:11], a[140:143], a[116:119], a[8:11]
    buffer_load_dwordx4 a[96:99], v1, s[16:19], s25 offen offset:0 sc1
    v_mfma_f32_16x16x32_bf16 a[12:15], a[144:147], a[116:119], a[12:15]
    buffer_load_dwordx4 a[100:103], v1, s[16:19], s25 offen offset:1024 sc1
    v_mfma_f32_16x16x32_bf16 a[16:19], a[148:151], a[116:119], a[16:19]
    buffer_load_dwordx4 a[104:107], v1, s[16:19], s25 offen offset:2048 sc1
    v_mfma_f32_16x16x32_bf16 a[20:23], a[132:135], a[120:123], a[20:23]
    buffer_load_dwordx4 a[108:111], v1, s[16:19], s25 offen offset:3072 sc1
    v_mfma_f32_16x16x32_bf16 a[24:27], a[136:139], a[120:123], a[24:27]
    buffer_load_dwordx4 a[112:115], v2, s[16:19], s25 offen offset:0 sc1
    v_mfma_f32_16x16x32_bf16 a[28:31], a[140:143], a[120:123], a[28:31]
    buffer_load_dwordx4 a[80:83], v1, s[16:19], s24 offen offset:0 sc1
    v_mfma_f32_16x16x32_bf16 a[32:35], a[144:147], a[120:123], a[32:35]
    buffer_load_dwordx4 a[84:87], v1, s[16:19], s24 offen offset:1024 sc1
    v_mfma_f32_16x16x32_bf16 a[36:39], a[148:151], a[120:123], a[36:39]
    buffer_load_dwordx4 a[88:91], v1, s[16:19], s24 offen offset:2048 sc1
    v_mfma_f32_16x16x32_bf16 a[40:43], a[132:135], a[124:127], a[40:43]
    buffer_load_dwordx4 a[92:95], v1, s[16:19], s24 offen offset:3072 sc1
    v_mfma_f32_16x16x32_bf16 a[44:47], a[136:139], a[124:127], a[44:47]
    v_mfma_f32_16x16x32_bf16 a[48:51], a[140:143], a[124:127], a[48:51]
    v_mfma_f32_16x16x32_bf16 a[52:55], a[144:147], a[124:127], a[52:55]
    v_mfma_f32_16x16x32_bf16 a[56:59], a[148:151], a[124:127], a[56:59]
    v_mfma_f32_16x16x32_bf16 a[60:63], a[132:135], a[128:131], a[60:63]
    v_mfma_f32_16x16x32_bf16 a[64:67], a[136:139], a[128:131], a[64:67]
    v_mfma_f32_16x16x32_bf16 a[68:71], a[140:143], a[128:131], a[68:71]
    v_mfma_f32_16x16x32_bf16 a[72:75], a[144:147], a[128:131], a[72:75]
    v_mfma_f32_16x16x32_bf16 a[76:79], a[148:151], a[128:131], a[76:79]
    s_waitcnt vmcnt(36)
    v_mfma_f32_16x16x32_bf16 a[0:3], v[44:47], v[28:31], a[0:3]
    buffer_load_dwordx4 a[244:247], off, s[16:19], s48 sc1
    v_mfma_f32_16x16x32_bf16 a[4:7], v[48:51], v[28:31], a[4:7]
    s_add_u32 s24, s52, 147456
    v_mfma_f32_16x16x32_bf16 a[8:11], v[52:55], v[28:31], a[8:11]
    s_add_u32 s25, s56, 184320
    v_mfma_f32_16x16x32_bf16 a[12:15], v[56:59], v[28:31], a[12:15]
    buffer_load_dwordx4 a[132:135], v1, s[16:19], s25 offen offset:0 sc1
    v_mfma_f32_16x16x32_bf16 a[16:19], v[60:63], v[28:31], a[16:19]
    buffer_load_dwordx4 a[136:139], v1, s[16:19], s25 offen offset:1024 sc1
    v_mfma_f32_16x16x32_bf16 a[20:23], v[44:47], v[32:35], a[20:23]
    buffer_load_dwordx4 a[140:143], v1, s[16:19], s25 offen offset:2048 sc1
    v_mfma_f32_16x16x32_bf16 a[24:27], v[48:51], v[32:35], a[24:27]
    buffer_load_dwordx4 a[144:147], v1, s[16:19], s25 offen offset:3072 sc1
    v_mfma_f32_16x16x32_bf16 a[28:31], v[52:55], v[32:35], a[28:31]
    buffer_load_dwordx4 a[148:151], v2, s[16:19], s25 offen offset:0 sc1
    v_mfma_f32_16x16x32_bf16 a[32:35], v[56:59], v[32:35], a[32:35]
    buffer_load_dwordx4 a[116:119], v1, s[16:19], s24 offen offset:0 sc1
    v_mfma_f32_16x16x32_bf16 a[36:39], v[60:63], v[32:35], a[36:39]
    buffer_load_dwordx4 a[120:123], v1, s[16:19], s24 offen offset:1024 sc1
    v_mfma_f32_16x16x32_bf16 a[40:43], v[44:47], v[36:39], a[40:43]
    buffer_load_dwordx4 a[124:127], v1, s[16:19], s24 offen offset:2048 sc1
    v_mfma_f32_16x16x32_bf16 a[44:47], v[48:51], v[36:39], a[44:47]
    buffer_load_dwordx4 a[128:131], v1, s[16:19], s24 offen offset:3072 sc1
    v_mfma_f32_16x16x32_bf16 a[48:51], v[52:55], v[36:39], a[48:51]
    v_mfma_f32_16x16x32_bf16 a[52:55], v[56:59], v[36:39], a[52:55]
    v_mfma_f32_16x16x32_bf16 a[56:59], v[60:63], v[36:39], a[56:59]
    v_mfma_f32_16x16x32_bf16 a[60:63], v[44:47], v[40:43], a[60:63]
    v_mfma_f32_16x16x32_bf16 a[64:67], v[48:51], v[40:43], a[64:67]
    v_mfma_f32_16x16x32_bf16 a[68:71], v[52:55], v[40:43], a[68:71]
    v_mfma_f32_16x16x32_bf16 a[72:75], v[56:59], v[40:43], a[72:75]
    v_mfma_f32_16x16x32_bf16 a[76:79], v[60:63], v[40:43], a[76:79]
    s_waitcnt vmcnt(37)
    v_mfma_f32_16x16x32_bf16 a[0:3], v[80:83], v[64:67], a[0:3]
    s_add_u32 s24, s53, 196608
    v_mfma_f32_16x16x32_bf16 a[4:7], v[84:87], v[64:67], a[4:7]
    s_add_u32 s25, s57, 245760
    v_mfma_f32_16x16x32_bf16 a[8:11], v[88:91], v[64:67], a[8:11]
    buffer_load_dwordx4 v[44:47], v1, s[16:19], s25 offen offset:0 sc1
    v_mfma_f32_16x16x32_bf16 a[12:15], v[92:95], v[64:67], a[12:15]
    buffer_load_dwordx4 v[48:51], v1, s[16:19], s25 offen offset:1024 sc1
    v_mfma_f32_16x16x32_bf16 a[16:19], v[96:99], v[64:67], a[16:19]
    buffer_load_dwordx4 v[52:55], v1, s[16:19], s25 offen offset:2048 sc1
    v_mfma_f32_16x16x32_bf16 a[20:23], v[80:83], v[68:71], a[20:23]
    buffer_load_dwordx4 v[56:59], v1, s[16:19], s25 offen offset:3072 sc1
    v_mfma_f32_16x16x32_bf16 a[24:27], v[84:87], v[68:71], a[24:27]
    buffer_load_dwordx4 v[60:63], v2, s[16:19], s25 offen offset:0 sc1
    v_mfma_f32_16x16x32_bf16 a[28:31], v[88:91], v[68:71], a[28:31]
    buffer_load_dwordx4 v[28:31], v1, s[16:19], s24 offen offset:0 sc1
    v_mfma_f32_16x16x32_bf16 a[32:35], v[92:95], v[68:71], a[32:35]
    buffer_load_dwordx4 v[32:35], v1, s[16:19], s24 offen offset:1024 sc1
    v_mfma_f32_16x16x32_bf16 a[36:39], v[96:99], v[68:71], a[36:39]
    buffer_load_dwordx4 v[36:39], v1, s[16:19], s24 offen offset:2048 sc1
    v_mfma_f32_16x16x32_bf16 a[40:43], v[80:83], v[72:75], a[40:43]
    buffer_load_dwordx4 v[40:43], v1, s[16:19], s24 offen offset:3072 sc1
    v_mfma_f32_16x16x32_bf16 a[44:47], v[84:87], v[72:75], a[44:47]
    v_mfma_f32_16x16x32_bf16 a[48:51], v[88:91], v[72:75], a[48:51]
    v_mfma_f32_16x16x32_bf16 a[52:55], v[92:95], v[72:75], a[52:55]
    v_mfma_f32_16x16x32_bf16 a[56:59], v[96:99], v[72:75], a[56:59]
    v_mfma_f32_16x16x32_bf16 a[60:63], v[80:83], v[76:79], a[60:63]
    v_mfma_f32_16x16x32_bf16 a[64:67], v[84:87], v[76:79], a[64:67]
    v_mfma_f32_16x16x32_bf16 a[68:71], v[88:91], v[76:79], a[68:71]
    v_mfma_f32_16x16x32_bf16 a[72:75], v[92:95], v[76:79], a[72:75]
    v_mfma_f32_16x16x32_bf16 a[76:79], v[96:99], v[76:79], a[76:79]
    s_waitcnt vmcnt(37)
    v_mfma_f32_16x16x32_bf16 a[0:3], v[116:119], v[100:103], a[0:3]
    s_add_u32 s24, s53, 212992
    v_mfma_f32_16x16x32_bf16 a[4:7], v[120:123], v[100:103], a[4:7]
    s_add_u32 s25, s57, 266240
    v_mfma_f32_16x16x32_bf16 a[8:11], v[124:127], v[100:103], a[8:11]
    s_cmp_lt_u32 s20, 2
    v_mfma_f32_16x16x32_bf16 a[12:15], v[128:131], v[100:103], a[12:15]
    s_cselect_b32 s24, s24, 2130706432
    v_mfma_f32_16x16x32_bf16 a[16:19], v[132:135], v[100:103], a[16:19]
    s_cselect_b32 s25, s25, 2130706432
    v_mfma_f32_16x16x32_bf16 a[20:23], v[116:119], v[104:107], a[20:23]
    buffer_load_dwordx4 v[80:83], v1, s[16:19], s25 offen offset:0 sc1
    v_mfma_f32_16x16x32_bf16 a[24:27], v[120:123], v[104:107], a[24:27]
    buffer_load_dwordx4 v[84:87], v1, s[16:19], s25 offen offset:1024 sc1
    v_mfma_f32_16x16x32_bf16 a[28:31], v[124:127], v[104:107], a[28:31]
    buffer_load_dwordx4 v[88:91], v1, s[16:19], s25 offen offset:2048 sc1
    v_mfma_f32_16x16x32_bf16 a[32:35], v[128:131], v[104:107], a[32:35]
    buffer_load_dwordx4 v[92:95], v1, s[16:19], s25 offen offset:3072 sc1
    v_mfma_f32_16x16x32_bf16 a[36:39], v[132:135], v[104:107], a[36:39]
    buffer_load_dwordx4 v[96:99], v2, s[16:19], s25 offen offset:0 sc1
    v_mfma_f32_16x16x32_bf16 a[40:43], v[116:119], v[108:111], a[40:43]
    buffer_load_dwordx4 v[64:67], v1, s[16:19], s24 offen offset:0 sc1
    v_mfma_f32_16x16x32_bf16 a[44:47], v[120:123], v[108:111], a[44:47]
    buffer_load_dwordx4 v[68:71], v1, s[16:19], s24 offen offset:1024 sc1
    v_mfma_f32_16x16x32_bf16 a[48:51], v[124:127], v[108:111], a[48:51]
    buffer_load_dwordx4 v[72:75], v1, s[16:19], s24 offen offset:2048 sc1
    v_mfma_f32_16x16x32_bf16 a[52:55], v[128:131], v[108:111], a[52:55]
    buffer_load_dwordx4 v[76:79], v1, s[16:19], s24 offen offset:3072 sc1
    v_mfma_f32_16x16x32_bf16 a[56:59], v[132:135], v[108:111], a[56:59]
    v_mfma_f32_16x16x32_bf16 a[60:63], v[116:119], v[112:115], a[60:63]
    v_mfma_f32_16x16x32_bf16 a[64:67], v[120:123], v[112:115], a[64:67]
    v_mfma_f32_16x16x32_bf16 a[68:71], v[124:127], v[112:115], a[68:71]
    v_mfma_f32_16x16x32_bf16 a[72:75], v[128:131], v[112:115], a[72:75]
    v_mfma_f32_16x16x32_bf16 a[76:79], v[132:135], v[112:115], a[76:79]
    s_waitcnt vmcnt(37)
    s_cmp_lg_u32 s20, 0
    s_cbranch_scc1 P2Ad_ok
    s_waitcnt vmcnt(27)
    s_mov_b32 s38, 0
    s_branch P2Ad_c
P2Ad_l:
    s_sleep 8
    buffer_load_dwordx4 a[244:247], off, s[16:19], s48 sc1
    s_add_u32 s38, s38, 1
    s_waitcnt vmcnt(0)
    s_cmp_ge_u32 s38, 0x20000
    s_cbranch_scc1 P2Ad_ok
P2Ad_c:
    v_accvgpr_read_b32 v10, a246
    s_nop 1
    v_readfirstlane_b32 s37, v10
    s_bfe_u32 s37, s37, 524288
    s_cmp_ge_u32 s37, 8
    s_cbranch_scc0 P2Ad_l
P2Ad_ok:
    s_barrier
    v_mfma_f32_16x16x32_bf16 a[0:3], v[152:155], v[136:139], a[0:3]
    s_add_u32 s24, s53, 221184
    v_mfma_f32_16x16x32_bf16 a[4:7], v[156:159], v[136:139], a[4:7]
    s_add_u32 s25, s57, 276480
    v_mfma_f32_16x16x32_bf16 a[8:11], v[160:163], v[136:139], a[8:11]
    buffer_load_dwordx4 v[116:119], v1, s[16:19], s25 offen offset:0 sc1
    v_mfma_f32_16x16x32_bf16 a[12:15], v[164:167], v[136:139], a[12:15]
    buffer_load_dwordx4 v[120:123], v1, s[16:19], s25 offen offset:1024 sc1
    v_mfma_f32_16x16x32_bf16 a[16:19], v[168:171], v[136:139], a[16:19]
    buffer_load_dwordx4 v[124:127], v1, s[16:19], s25 offen offset:2048 sc1
    v_mfma_f32_16x16x32_bf16 a[20:23], v[152:155], v[140:143], a[20:23]
    buffer_load_dwordx4 v[128:131], v1, s[16:19], s25 offen offset:3072 sc1
    v_mfma_f32_16x16x32_bf16 a[24:27], v[156:159], v[140:143], a[24:27]
    buffer_load_dwordx4 v[132:135], v2, s[16:19], s25 offen offset:0 sc1
    v_mfma_f32_16x16x32_bf16 a[28:31], v[160:163], v[140:143], a[28:31]
    buffer_load_dwordx4 v[100:103], v1, s[16:19], s24 offen offset:0 sc1
    v_mfma_f32_16x16x32_bf16 a[32:35], v[164:167], v[140:143], a[32:35]
    buffer_load_dwordx4 v[104:107], v1, s[16:19], s24 offen offset:1024 sc1
    v_mfma_f32_16x16x32_bf16 a[36:39], v[168:171], v[140:143], a[36:39]
    buffer_load_dwordx4 v[108:111], v1, s[16:19], s24 offen offset:2048 sc1
    v_mfma_f32_16x16x32_bf16 a[40:43], v[152:155], v[144:147], a[40:43]
    buffer_load_dwordx4 v[112:115], v1, s[16:19], s24 offen offset:3072 sc1
    v_mfma_f32_16x16x32_bf16 a[44:47], v[156:159], v[144:147], a[44:47]
    v_mfma_f32_16x16x32_bf16 a[48:51], v[160:163], v[144:147], a[48:51]
    v_mfma_f32_16x16x32_bf16 a[52:55], v[164:167], v[144:147], a[52:55]
    v_mfma_f32_16x16x32_bf16 a[56:59], v[168:171], v[144:147], a[56:59]
    v_mfma_f32_16x16x32_bf16 a[60:63], v[152:155], v[148:151], a[60:63]
    v_mfma_f32_16x16x32_bf16 a[64:67], v[156:159], v[148:151], a[64:67]
    v_mfma_f32_16x16x32_bf16 a[68:71], v[160:163], v[148:151], a[68:71]
    v_mfma_f32_16x16x32_bf16 a[72:75], v[164:167], v[148:151], a[72:75]
    v_mfma_f32_16x16x32_bf16 a[76:79], v[168:171], v[148:151], a[76:79]
    s_waitcnt vmcnt(37)
    v_mfma_f32_16x16x32_bf16 a[0:3], a[96:99], a[80:83], a[0:3]
    s_add_u32 s24, s53, 237568
    v_mfma_f32_16x16x32_bf16 a[4:7], a[100:103], a[80:83], a[4:7]
    s_add_u32 s25, s57, 296960
    v_mfma_f32_16x16x32_bf16 a[8:11], a[104:107], a[80:83], a[8:11]
    buffer_load_dwordx4 v[152:155], v1, s[16:19], s25 offen offset:0 sc1
    v_mfma_f32_16x16x32_bf16 a[12:15], a[108:111], a[80:83], a[12:15]
    buffer_load_dwordx4 v[156:159], v1, s[16:19], s25 offen offset:1024 sc1
    v_mfma_f32_16x16x32_bf16 a[16:19], a[112:115], a[80:83], a[16:19]
    buffer_load_dwordx4 v[160:163], v1, s[16:19], s25 offen offset:2048 sc1
    v_mfma_f32_16x16x32_bf16 a[20:23], a[96:99], a[84:87], a[20:23]
    buffer_load_dwordx4 v[164:167], v1, s[16:19], s25 offen offset:3072 sc1
    v_mfma_f32_16x16x32_bf16 a[24:27], a[100:103], a[84:87], a[24:27]
    buffer_load_dwordx4 v[168:171], v2, s[16:19], s25 offen offset:0 sc1
    v_mfma_f32_16x16x32_bf16 a[28:31], a[104:107], a[84:87], a[28:31]
    buffer_load_dwordx4 v[136:139], v1, s[16:19], s24 offen offset:0 sc1
    v_mfma_f32_16x16x32_bf16 a[32:35], a[108:111], a[84:87], a[32:35]
    buffer_load_dwordx4 v[140:143], v1, s[16:19], s24 offen offset:1024 sc1
    v_mfma_f32_16x16x32_bf16 a[36:39], a[112:115], a[84:87], a[36:39]
    buffer_load_dwordx4 v[144:147], v1, s[16:19], s24 offen offset:2048 sc1
    v_mfma_f32_16x16x32_bf16 a[40:43], a[96:99], a[88:91], a[40:43]
    buffer_load_dwordx4 v[148:151], v1, s[16:19], s24 offen offset:3072 sc1
    v_mfma_f32_16x16x32_bf16 a[44:47], a[100:103], a[88:91], a[44:47]
    v_mfma_f32_16x16x32_bf16 a[48:51], a[104:107], a[88:91], a[48:51]
    v_mfma_f32_16x16x32_bf16 a[52:55], a[108:111], a[88:91], a[52:55]
    v_mfma_f32_16x16x32_bf16 a[56:59], a[112:115], a[88:91], a[56:59]
    v_mfma_f32_16x16x32_bf16 a[60:63], a[96:99], a[92:95], a[60:63]
    v_mfma_f32_16x16x32_bf16 a[64:67], a[100:103], a[92:95], a[64:67]
    v_mfma_f32_16x16x32_bf16 a[68:71], a[104:107], a[92:95], a[68:71]
    v_mfma_f32_16x16x32_bf16 a[72:75], a[108:111], a[92:95], a[72:75]
    v_mfma_f32_16x16x32_bf16 a[76:79], a[112:115], a[92:95], a[76:79]
    s_waitcnt vmcnt(36)
    v_mfma_f32_16x16x32_bf16 a[0:3], a[132:135], a[116:119], a[0:3]
    s_add_u32 s24, s53, 253952
    v_mfma_f32_16x16x32_bf16 a[4:7], a[136:139], a[116:119], a[4:7]
    s_add_u32 s25, s57, 317440
    v_mfma_f32_16x16x32_bf16 a[8:11], a[140:143], a[116:119], a[8:11]
    buffer_load_dwordx4 a[96:99], v1, s[16:19], s25 offen offset:0 sc1
    v_mfma_f32_16x16x32_bf16 a[12:15], a[144:147], a[116:119], a[12:15]
    buffer_load_dwordx4 a[100:103], v1, s[16:19], s25 offen offset:1024 sc1
    v_mfma_f32_16x16x32_bf16 a[16:19], a[148:151], a[116:119], a[16:19]
    buffer_load_dwordx4 a[104:107], v1, s[16:19], s25 offen offset:2048 sc1
    v_mfma_f32_16x16x32_bf16 a[20:23], a[132:135], a[120:123], a[20:23]
    buffer_load_dwordx4 a[108:111], v1, s[16:19], s25 offen offset:3072 sc1
    v_mfma_f32_16x16x32_bf16 a[24:27], a[136:139], a[120:123], a[24:27]
    buffer_load_dwordx4 a[112:115], v2, s[16:19], s25 offen offset:0 sc1
    v_mfma_f32_16x16x32_bf16 a[28:31], a[140:143], a[120:123], a[28:31]
    buffer_load_dwordx4 a[80:83], v1, s[16:19], s24 offen offset:0 sc1
    v_mfma_f32_16x16x32_bf16 a[32:35], a[144:147], a[120:123], a[32:35]
    buffer_load_dwordx4 a[84:87], v1, s[16:19], s24 offen offset:1024 sc1
    v_mfma_f32_16x16x32_bf16 a[36:39], a[148:151], a[120:123], a[36:39]
    buffer_load_dwordx4 a[88:91], v1, s[16:19], s24 offen offset:2048 sc1
    v_mfma_f32_16x16x32_bf16 a[40:43], a[132:135], a[124:127], a[40:43]
    buffer_load_dwordx4 a[92:95], v1, s[16:19], s24 offen offset:3072 sc1
    v_mfma_f32_16x16x32_bf16 a[44:47], a[136:139], a[124:127], a[44:47]
    v_mfma_f32_16x16x32_bf16 a[48:51], a[140:143], a[124:127], a[48:51]
    v_mfma_f32_16x16x32_bf16 a[52:55], a[144:147], a[124:127], a[52:55]
    v_mfma_f32_16x16x32_bf16 a[56:59], a[148:151], a[124:127], a[56:59]
    v_mfma_f32_16x16x32_bf16 a[60:63], a[132:135], a[128:131], a[60:63]
    v_mfma_f32_16x16x32_bf16 a[64:67], a[136:139], a[128:131], a[64:67]
    v_mfma_f32_16x16x32_bf16 a[68:71], a[140:143], a[128:131], a[68:71]
    v_mfma_f32_16x16x32_bf16 a[72:75], a[144:147], a[128:131], a[72:75]
    v_mfma_f32_16x16x32_bf16 a[76:79], a[148:151], a[128:131], a[76:79]
    s_waitcnt vmcnt(36)
    v_mfma_f32_16x16x32_bf16 a[0:3], v[44:47], v[28:31], a[0:3]
    s_add_u32 s24, s53, 270336
    v_mfma_f32_16x16x32_bf16 a[4:7], v[48:51], v[28:31], a[4:7]
    s_add_u32 s25, s57, 337920
    v_mfma_f32_16x16x32_bf16 a[8:11], v[52:55], v[28:31], a[8:11]
    buffer_load_dwordx4 a[132:135], v1, s[16:19], s25 offen offset:0 sc1
    v_mfma_f32_16x16x32_bf16 a[12:15], v[56:59], v[28:31], a[12:15]
    buffer_load_dwordx4 a[136:139], v1, s[16:19], s25 offen offset:1024 sc1
    v_mfma_f32_16x16x32_bf16 a[16:19], v[60:63], v[28:31], a[16:19]
    buffer_load_dwordx4 a[140:143], v1, s[16:19], s25 offen offset:2048 sc1
    v_mfma_f32_16x16x32_bf16 a[20:23], v[44:47], v[32:35], a[20:23]
    buffer_load_dwordx4 a[144:147], v1, s[16:19], s25 offen offset:3072 sc1
    v_mfma_f32_16x16x32_bf16 a[24:27], v[48:51], v[32:35], a[24:27]
    buffer_load_dwordx4 a[148:151], v2, s[16:19], s25 offen offset:0 sc1
    v_mfma_f32_16x16x32_bf16 a[28:31], v[52:55], v[32:35], a[28:31]
    buffer_load_dwordx4 a[116:119], v1, s[16:19], s24 offen offset:0 sc1
    v_mfma_f32_16x16x32_bf16 a[32:35], v[56:59], v[32:35], a[32:35]
    buffer_load_dwordx4 a[120:123], v1, s[16:19], s24 offen offset:1024 sc1
    v_mfma_f32_16x16x32_bf16 a[36:39], v[60:63], v[32:35], a[36:39]
    buffer_load_dwordx4 a[124:127], v1, s[16:19], s24 offen offset:2048 sc1
    v_mfma_f32_16x16x32_bf16 a[40:43], v[44:47], v[36:39], a[40:43]
    buffer_load_dwordx4 a[128:131], v1, s[16:19], s24 offen offset:3072 sc1
    v_mfma_f32_16x16x32_bf16 a[44:47], v[48:51], v[36:39], a[44:47]
    v_mfma_f32_16x16x32_bf16 a[48:51], v[52:55], v[36:39], a[48:51]
    v_mfma_f32_16x16x32_bf16 a[52:55], v[56:59], v[36:39], a[52:55]
    v_mfma_f32_16x16x32_bf16 a[56:59], v[60:63], v[36:39], a[56:59]
    v_mfma_f32_16x16x32_bf16 a[60:63], v[44:47], v[40:43], a[60:63]
    v_mfma_f32_16x16x32_bf16 a[64:67], v[48:51], v[40:43], a[64:67]
    v_mfma_f32_16x16x32_bf16 a[68:71], v[52:55], v[40:43], a[68:71]
    v_mfma_f32_16x16x32_bf16 a[72:75], v[56:59], v[40:43], a[72:75]
    v_mfma_f32_16x16x32_bf16 a[76:79], v[60:63], v[40:43], a[76:79]
    s_waitcnt vmcnt(36)
    v_mfma_f32_16x16x32_bf16 a[0:3], v[80:83], v[64:67], a[0:3]
    s_add_u32 s24, s53, 286720
    v_mfma_f32_16x16x32_bf16 a[4:7], v[84:87], v[64:67], a[4:7]
    s_add_u32 s25, s57, 358400
    v_mfma_f32_16x16x32_bf16 a[8:11], v[88:91], v[64:67], a[8:11]
    buffer_load_dwordx4 v[44:47], v1, s[16:19], s25 offen offset:0 sc1
    v_mfma_f32_16x16x32_bf16 a[12:15], v[92:95], v[64:67], a[12:15]
    buffer_load_dwordx4 v[48:51], v1, s[16:19], s25 offen offset:1024 sc1
    v_mfma_f32_16x16x32_bf16 a[16:19], v[96:99], v[64:67], a[16:19]
    buffer_load_dwordx4 v[52:55], v1, s[16:19], s25 offen offset:2048 sc1
    v_mfma_f32_16x16x32_bf16 a[20:23], v[80:83], v[68:71], a[20:23]
    buffer_load_dwordx4 v[56:59], v1, s[16:19], s25 offen offset:3072 sc1
    v_mfma_f32_16x16x32_bf16 a[24:27], v[84:87], v[68:71], a[24:27]
    buffer_load_dwordx4 v[60:63], v2, s[16:19], s25 offen offset:0 sc1
    v_mfma_f32_16x16x32_bf16 a[28:31], v[88:91], v[68:71], a[28:31]
    buffer_load_dwordx4 v[28:31], v1, s[16:19], s24 offen offset:0 sc1
    v_mfma_f32_16x16x32_bf16 a[32:35], v[92:95], v[68:71], a[32:35]
    buffer_load_dwordx4 v[32:35], v1, s[16:19], s24 offen offset:1024 sc1
    v_mfma_f32_16x16x32_bf16 a[36:39], v[96:99], v[68:71], a[36:39]
    buffer_load_dwordx4 v[36:39], v1, s[16:19], s24 offen offset:2048 sc1
    v_mfma_f32_16x16x32_bf16 a[40:43], v[80:83], v[72:75], a[40:43]
    buffer_load_dwordx4 v[40:43], v1, s[16:19], s24 offen offset:3072 sc1
    v_mfma_f32_16x16x32_bf16 a[44:47], v[84:87], v[72:75], a[44:47]
    v_mfma_f32_16x16x32_bf16 a[48:51], v[88:91], v[72:75], a[48:51]
    v_mfma_f32_16x16x32_bf16 a[52:55], v[92:95], v[72:75], a[52:55]
    v_mfma_f32_16x16x32_bf16 a[56:59], v[96:99], v[72:75], a[56:59]
    v_mfma_f32_16x16x32_bf16 a[60:63], v[80:83], v[76:79], a[60:63]
    v_mfma_f32_16x16x32_bf16 a[64:67], v[84:87], v[76:79], a[64:67]
    v_mfma_f32_16x16x32_bf16 a[68:71], v[88:91], v[76:79], a[68:71]
    v_mfma_f32_16x16x32_bf16 a[72:75], v[92:95], v[76:79], a[72:75]
    v_mfma_f32_16x16x32_bf16 a[76:79], v[96:99], v[76:79], a[76:79]
    s_waitcnt vmcnt(36)
    v_mfma_f32_16x16x32_bf16 a[0:3], v[116:119], v[100:103], a[0:3]
    s_lshl_b32 s38, s23, 8
    s_add_u32 s38, s38, 19922944
    s_mul_i32 s39, s27, 160
    s_mul_i32 s40, s23, 81920
    s_add_u32 s40, s40, s39
    v_mfma_f32_16x16x32_bf16 a[4:7], v[120:123], v[100:103], a[4:7]
    v_add_u32 v10, 0, v0
    v_mul_u32_u24 v11, 3277, v10
    v_lshrrev_b32 v11, 16, v11
    v_mul_u32_u24 v12, 20, v11
    v_sub_u32 v12, v10, v12
    v_mfma_f32_16x16x32_bf16 a[8:11], v[124:127], v[100:103], a[8:11]
    v_bfe_u32 v13, v11, 1, 2
    v_xor_b32 v13, v13, v10
    v_lshlrev_b32 v176, 4, v13
    v_lshlrev_b32 v12, 3, v12
    v_mul_u32_u24 v13, 1280, v11
    v_mfma_f32_16x16x32_bf16 a[12:15], v[128:131], v[100:103], a[12:15]
    v_add_u32 v181, v13, v12
    v_lshlrev_b32 v11, 2, v11
    buffer_load_dword v186, v11, s[16:19], s38 offen offset:0 sc1
    buffer_load_dwordx2 v[192:193], v12, s[12:15], s39 offen offset:0
    v_add_u32 v10, 256, v0
    v_mfma_f32_16x16x32_bf16 a[16:19], v[132:135], v[100:103], a[16:19]
    v_mul_u32_u24 v11, 3277, v10
    v_lshrrev_b32 v11, 16, v11
    v_mul_u32_u24 v12, 20, v11
    v_sub_u32 v12, v10, v12
    v_bfe_u32 v13, v11, 1, 2
    v_mfma_f32_16x16x32_bf16 a[20:23], v[116:119], v[104:107], a[20:23]
    v_xor_b32 v13, v13, v10
    v_lshlrev_b32 v177, 4, v13
    v_lshlrev_b32 v12, 3, v12
    v_mul_u32_u24 v13, 1280, v11
    v_add_u32 v182, v13, v12
    v_mfma_f32_16x16x32_bf16 a[24:27], v[120:123], v[104:107], a[24:27]
    v_lshlrev_b32 v11, 2, v11
    buffer_load_dword v187, v11, s[16:19], s38 offen offset:0 sc1
    buffer_load_dwordx2 v[194:195], v12, s[12:15], s39 offen offset:0
    v_add_u32 v10, 512, v0
    v_mul_u32_u24 v11, 3277, v10
    v_mfma_f32_16x16x32_bf16 a[28:31], v[124:127], v[104:107], a[28:31]
    v_lshrrev_b32 v11, 16, v11
    v_mul_u32_u24 v12, 20, v11
    v_sub_u32 v12, v10, v12
    v_bfe_u32 v13, v11, 1, 2
    v_xor_b32 v13, v13, v10
    v_mfma_f32_16x16x32_bf16 a[32:35], v[128:131], v[104:107], a[32:35]
    v_lshlrev_b32 v178, 4, v13
    v_lshlrev_b32 v12, 3, v12
    v_mul_u32_u24 v13, 1280, v11
    v_add_u32 v183, v13, v12
    v_lshlrev_b32 v11, 2, v11
    v_mfma_f32_16x16x32_bf16 a[36:39], v[132:135], v[104:107], a[36:39]
    buffer_load_dword v188, v11, s[16:19], s38 offen offset:0 sc1
    buffer_load_dwordx2 v[196:197], v12, s[12:15], s39 offen offset:0
    v_add_u32 v10, 768, v0
    v_mul_u32_u24 v11, 3277, v10
    v_lshrrev_b32 v11, 16, v11
    v_mfma_f32_16x16x32_bf16 a[40:43], v[116:119], v[108:111], a[40:43]
    v_mul_u32_u24 v12, 20, v11
    v_sub_u32 v12, v10, v12
    v_bfe_u32 v13, v11, 1, 2
    v_xor_b32 v13, v13, v10
    v_lshlrev_b32 v179, 4, v13
    v_mfma_f32_16x16x32_bf16 a[44:47], v[120:123], v[108:111], a[44:47]
    v_lshlrev_b32 v12, 3, v12
    v_mul_u32_u24 v13, 1280, v11
    v_add_u32 v184, v13, v12
    v_lshlrev_b32 v11, 2, v11
    buffer_load_dword v189, v11, s[16:19], s38 offen offset:0 sc1
    v_mfma_f32_16x16x32_bf16 a[48:51], v[124:127], v[108:111], a[48:51]
    buffer_load_dwordx2 v[198:199], v12, s[12:15], s39 offen offset:0
    v_add_u32 v10, 1024, v0
    v_mul_u32_u24 v11, 3277, v10
    v_lshrrev_b32 v11, 16, v11
    v_mul_u32_u24 v12, 20, v11
    v_mfma_f32_16x16x32_bf16 a[52:55], v[128:131], v[108:111], a[52:55]
    v_sub_u32 v12, v10, v12
    v_bfe_u32 v13, v11, 1, 2
    v_xor_b32 v13, v13, v10
    v_lshlrev_b32 v180, 4, v13
    v_lshlrev_b32 v12, 3, v12
    v_mfma_f32_16x16x32_bf16 a[56:59], v[132:135], v[108:111], a[56:59]
    v_mul_u32_u24 v13, 1280, v11
    v_add_u32 v185, v13, v12
    v_lshlrev_b32 v11, 2, v11
    buffer_load_dword v190, v11, s[16:19], s38 offen offset:0 sc1
    buffer_load_dwordx2 v[200:201], v12, s[12:15], s39 offen offset:0
    v_mfma_f32_16x16x32_bf16 a[60:63], v[116:119], v[112:115], a[60:63]
    v_and_b32 v10, 15, v3
    v_lshrrev_b32 v11, 4, v3
    v_bfe_u32 v12, v10, 1, 2
    v_xor_b32 v11, v11, v12
    v_mul_u32_u24 v10, 320, v10
    v_mfma_f32_16x16x32_bf16 a[64:67], v[120:123], v[112:115], a[64:67]
    v_lshl_add_u32 v10, v11, 4, v10
    s_mul_i32 s37, s20, 20480
    v_add_u32 v19, s37, v10
    v_mfma_f32_16x16x32_bf16 a[68:71], v[124:127], v[112:115], a[68:71]
    v_mfma_f32_16x16x32_bf16 a[72:75], v[128:131], v[112:115], a[72:75]
    v_mfma_f32_16x16x32_bf16 a[76:79], v[132:135], v[112:115], a[76:79]
    s_waitcnt vmcnt(37)
    v_mfma_f32_16x16x32_bf16 a[0:3], v[152:155], v[136:139], a[0:3]
    v_mfma_f32_16x16x32_bf16 a[4:7], v[156:159], v[136:139], a[4:7]
    v_mfma_f32_16x16x32_bf16 a[8:11], v[160:163], v[136:139], a[8:11]
    v_mfma_f32_16x16x32_bf16 a[12:15], v[164:167], v[136:139], a[12:15]
    v_mfma_f32_16x16x32_bf16 a[16:19], v[168:171], v[136:139], a[16:19]
    v_mfma_f32_16x16x32_bf16 a[20:23], v[152:155], v[140:143], a[20:23]
    v_mfma_f32_16x16x32_bf16 a[24:27], v[156:159], v[140:143], a[24:27]
    v_mfma_f32_16x16x32_bf16 a[28:31], v[160:163], v[140:143], a[28:31]
    v_mfma_f32_16x16x32_bf16 a[32:35], v[164:167], v[140:143], a[32:35]
    v_mfma_f32_16x16x32_bf16 a[36:39], v[168:171], v[140:143], a[36:39]
    v_mfma_f32_16x16x32_bf16 a[40:43], v[152:155], v[144:147], a[40:43]
    v_mfma_f32_16x16x32_bf16 a[44:47], v[156:159], v[144:147], a[44:47]
    v_mfma_f32_16x16x32_bf16 a[48:51], v[160:163], v[144:147], a[48:51]
    v_mfma_f32_16x16x32_bf16 a[52:55], v[164:167], v[144:147], a[52:55]
    v_mfma_f32_16x16x32_bf16 a[56:59], v[168:171], v[144:147], a[56:59]
    v_mfma_f32_16x16x32_bf16 a[60:63], v[152:155], v[148:151], a[60:63]
    v_mfma_f32_16x16x32_bf16 a[64:67], v[156:159], v[148:151], a[64:67]
    v_mfma_f32_16x16x32_bf16 a[68:71], v[160:163], v[148:151], a[68:71]
    v_mfma_f32_16x16x32_bf16 a[72:75], v[164:167], v[148:151], a[72:75]
    v_mfma_f32_16x16x32_bf16 a[76:79], v[168:171], v[148:151], a[76:79]
    s_waitcnt vmcnt(28)
    v_mfma_f32_16x16x32_bf16 a[0:3], a[96:99], a[80:83], a[0:3]
    v_mfma_f32_16x16x32_bf16 a[4:7], a[100:103], a[80:83], a[4:7]
    v_mfma_f32_16x16x32_bf16 a[8:11], a[104:107], a[80:83], a[8:11]
    v_mfma_f32_16x16x32_bf16 a[12:15], a[108:111], a[80:83], a[12:15]
    v_mfma_f32_16x16x32_bf16 a[16:19], a[112:115], a[80:83], a[16:19]
    v_mfma_f32_16x16x32_bf16 a[20:23], a[96:99], a[84:87], a[20:23]
    v_mfma_f32_16x16x32_bf16 a[24:27], a[100:103], a[84:87], a[24:27]
    v_mfma_f32_16x16x32_bf16 a[28:31], a[104:107], a[84:87], a[28:31]
    v_mfma_f32_16x16x32_bf16 a[32:35], a[108:111], a[84:87], a[32:35]
    v_mfma_f32_16x16x32_bf16 a[36:39], a[112:115], a[84:87], a[36:39]
    v_mfma_f32_16x16x32_bf16 a[40:43], a[96:99], a[88:91], a[40:43]
    v_mfma_f32_16x16x32_bf16 a[44:47], a[100:103], a[88:91], a[44:47]
    v_mfma_f32_16x16x32_bf16 a[48:51], a[104:107], a[88:91], a[48:51]
    v_mfma_f32_16x16x32_bf16 a[52:55], a[108:111], a[88:91], a[52:55]
    v_mfma_f32_16x16x32_bf16 a[56:59], a[112:115], a[88:91], a[56:59]
    v_mfma_f32_16x16x32_bf16 a[60:63], a[96:99], a[92:95], a[60:63]
    v_mfma_f32_16x16x32_bf16 a[64:67], a[100:103], a[92:95], a[64:67]
    v_mfma_f32_16x16x32_bf16 a[68:71], a[104:107], a[92:95], a[68:71]
    v_mfma_f32_16x16x32_bf16 a[72:75], a[108:111], a[92:95], a[72:75]
    v_mfma_f32_16x16x32_bf16 a[76:79], a[112:115], a[92:95], a[76:79]
    s_waitcnt vmcnt(19)
    v_mfma_f32_16x16x32_bf16 a[0:3], a[132:135], a[116:119], a[0:3]
    v_mfma_f32_16x16x32_bf16 a[4:7], a[136:139], a[116:119], a[4:7]
    v_mfma_f32_16x16x32_bf16 a[8:11], a[140:143], a[116:119], a[8:11]
    v_mfma_f32_16x16x32_bf16 a[12:15], a[144:147], a[116:119], a[12:15]
    v_mfma_f32_16x16x32_bf16 a[16:19], a[148:151], a[116:119], a[16:19]
    v_mfma_f32_16x16x32_bf16 a[20:23], a[132:135], a[120:123], a[20:23]
    v_mfma_f32_16x16x32_bf16 a[24:27], a[136:139], a[120:123], a[24:27]
    v_mfma_f32_16x16x32_bf16 a[28:31], a[140:143], a[120:123], a[28:31]
    v_mfma_f32_16x16x32_bf16 a[32:35], a[144:147], a[120:123], a[32:35]
    v_mfma_f32_16x16x32_bf16 a[36:39], a[148:151], a[120:123], a[36:39]
    v_mfma_f32_16x16x32_bf16 a[40:43], a[132:135], a[124:127], a[40:43]
    v_mfma_f32_16x16x32_bf16 a[44:47], a[136:139], a[124:127], a[44:47]
    v_mfma_f32_16x16x32_bf16 a[48:51], a[140:143], a[124:127], a[48:51]
    v_mfma_f32_16x16x32_bf16 a[52:55], a[144:147], a[124:127], a[52:55]
    v_mfma_f32_16x16x32_bf16 a[56:59], a[148:151], a[124:127], a[56:59]
    v_mfma_f32_16x16x32_bf16 a[60:63], a[132:135], a[128:131], a[60:63]
    v_mfma_f32_16x16x32_bf16 a[64:67], a[136:139], a[128:131], a[64:67]
    v_mfma_f32_16x16x32_bf16 a[68:71], a[140:143], a[128:131], a[68:71]
    v_mfma_f32_16x16x32_bf16 a[72:75], a[144:147], a[128:131], a[72:75]
    v_mfma_f32_16x16x32_bf16 a[76:79], a[148:151], a[128:131], a[76:79]
    s_waitcnt vmcnt(10)
    v_mfma_f32_16x16x32_bf16 a[0:3], v[44:47], v[28:31], a[0:3]
    v_mfma_f32_16x16x32_bf16 a[4:7], v[48:51], v[28:31], a[4:7]
    v_mfma_f32_16x16x32_bf16 a[8:11], v[52:55], v[28:31], a[8:11]
    v_mfma_f32_16x16x32_bf16 a[12:15], v[56:59], v[28:31], a[12:15]
    v_mfma_f32_16x16x32_bf16 a[16:19], v[60:63], v[28:31], a[16:19]
    v_mfma_f32_16x16x32_bf16 a[20:23], v[44:47], v[32:35], a[20:23]
    v_mfma_f32_16x16x32_bf16 a[24:27], v[48:51], v[32:35], a[24:27]
    v_mfma_f32_16x16x32_bf16 a[28:31], v[52:55], v[32:35], a[28:31]
    v_mfma_f32_16x16x32_bf16 a[32:35], v[56:59], v[32:35], a[32:35]
    ds_write_b128 v19, a[0:3] offset:0
    v_mfma_f32_16x16x32_bf16 a[36:39], v[60:63], v[32:35], a[36:39]
    ds_write_b128 v19, a[4:7] offset:64
    v_mfma_f32_16x16x32_bf16 a[40:43], v[44:47], v[36:39], a[40:43]
    ds_write_b128 v19, a[8:11] offset:128
    v_mfma_f32_16x16x32_bf16 a[44:47], v[48:51], v[36:39], a[44:47]
    ds_write_b128 v19, a[12:15] offset:192
    v_mfma_f32_16x16x32_bf16 a[48:51], v[52:55], v[36:39], a[48:51]
    ds_write_b128 v19, a[16:19] offset:256
    v_mfma_f32_16x16x32_bf16 a[52:55], v[56:59], v[36:39], a[52:55]
    ds_write_b128 v19, a[20:23] offset:5120
    v_mfma_f32_16x16x32_bf16 a[56:59], v[60:63], v[36:39], a[56:59]
    ds_write_b128 v19, a[24:27] offset:5184
    v_mfma_f32_16x16x32_bf16 a[60:63], v[44:47], v[40:43], a[60:63]
    ds_write_b128 v19, a[28:31] offset:5248
    v_mfma_f32_16x16x32_bf16 a[64:67], v[48:51], v[40:43], a[64:67]
    ds_write_b128 v19, a[32:35] offset:5312
    v_mfma_f32_16x16x32_bf16 a[68:71], v[52:55], v[40:43], a[68:71]
    ds_write_b128 v19, a[36:39] offset:5376
    v_mfma_f32_16x16x32_bf16 a[72:75], v[56:59], v[40:43], a[72:75]
    ds_write_b128 v19, a[40:43] offset:10240
    v_mfma_f32_16x16x32_bf16 a[76:79], v[60:63], v[40:43], a[76:79]
    ds_write_b128 v19, a[44:47] offset:10304
    ds_write_b128 v19, a[48:51] offset:10368
    ds_write_b128 v19, a[52:55] offset:10432
    ds_write_b128 v19, a[56:59] offset:10496
    ds_write_b128 v19, a[60:63] offset:15360
    ds_write_b128 v19, a[64:67] offset:15424
    ds_write_b128 v19, a[68:71] offset:15488
    ds_write_b128 v19, a[72:75] offset:15552
    s_nop 1
    ds_write_b128 v19, a[76:79] offset:15616
    s_waitcnt vmcnt(0)
    v_sub_f32 v186, 1.0, v186
    v_sub_f32 v187, 1.0, v187
    v_sub_f32 v188, 1.0, v188
    v_sub_f32 v189, 1.0, v189
    v_sub_f32 v190, 1.0, v190
    s_waitcnt lgkmcnt(0)
    s_barrier
    ds_read_b128 v[28:31], v176 offset:0
    ds_read_b128 v[32:35], v176 offset:20480
    ds_read_b128 v[36:39], v176 offset:40960
    ds_read_b128 v[40:43], v176 offset:61440
    ds_read_b128 v[44:47], v177 offset:0
    ds_read_b128 v[48:51], v177 offset:20480
    ds_read_b128 v[52:55], v177 offset:40960
    ds_read_b128 v[56:59], v177 offset:61440
    ds_read_b128 v[60:63], v178 offset:0
    ds_read_b128 v[64:67], v178 offset:20480
    ds_read_b128 v[68:71], v178 offset:40960
    ds_read_b128 v[72:75], v178 offset:61440
    v_lshlrev_b32 v10, 16, v192
    v_and_b32 v11, 0xffff0000, v192
    v_lshlrev_b32 v12, 16, v193
    v_and_b32 v13, 0xffff0000, v193
    s_waitcnt lgkmcnt(8)
    ds_read_b128 v[76:79], v179 offset:0
    ds_read_b128 v[80:83], v179 offset:20480
    ds_read_b128 v[84:87], v179 offset:40960
    ds_read_b128 v[88:91], v179 offset:61440
    v_pk_add_f32 v[28:29], v[28:29], v[32:33]
    v_pk_add_f32 v[30:31], v[30:31], v[34:35]
    v_pk_add_f32 v[36:37], v[36:37], v[40:41]
    v_pk_add_f32 v[38:39], v[38:39], v[42:43]
    v_pk_add_f32 v[28:29], v[28:29], v[36:37]
    v_pk_add_f32 v[30:31], v[30:31], v[38:39]
    v_fmac_f32 v28, v10, v186
    v_fmac_f32 v29, v11, v186
    v_fmac_f32 v30, v12, v186
    v_fmac_f32 v31, v13, v186
    v_cvt_pk_bf16_f32 v28, v28, v29
    v_cvt_pk_bf16_f32 v29, v30, v31
    buffer_store_dwordx2 v[28:29], v181, s[8:11], s40 offen
    v_lshlrev_b32 v10, 16, v194
    v_and_b32 v11, 0xffff0000, v194
    v_lshlrev_b32 v12, 16, v195
    v_and_b32 v13, 0xffff0000, v195
    s_waitcnt lgkmcnt(8)
    ds_read_b128 v[92:95], v180 offset:0
    ds_read_b128 v[96:99], v180 offset:20480
    ds_read_b128 v[100:103], v180 offset:40960
    ds_read_b128 v[104:107], v180 offset:61440
    v_pk_add_f32 v[44:45], v[44:45], v[48:49]
    v_pk_add_f32 v[46:47], v[46:47], v[50:51]
    v_pk_add_f32 v[52:53], v[52:53], v[56:57]
    v_pk_add_f32 v[54:55], v[54:55], v[58:59]
    v_pk_add_f32 v[44:45], v[44:45], v[52:53]
    v_pk_add_f32 v[46:47], v[46:47], v[54:55]
    v_fmac_f32 v44, v10, v187
    v_fmac_f32 v45, v11, v187
    v_fmac_f32 v46, v12, v187
    v_fmac_f32 v47, v13, v187
    v_cvt_pk_bf16_f32 v44, v44, v45
    v_cvt_pk_bf16_f32 v45, v46, v47
    buffer_store_dwordx2 v[44:45], v182, s[8:11], s40 offen
    v_lshlrev_b32 v10, 16, v196
    v_and_b32 v11, 0xffff0000, v196
    v_lshlrev_b32 v12, 16, v197
    v_and_b32 v13, 0xffff0000, v197
    s_waitcnt lgkmcnt(8)
    v_pk_add_f32 v[60:61], v[60:61], v[64:65]
    v_pk_add_f32 v[62:63], v[62:63], v[66:67]
    v_pk_add_f32 v[68:69], v[68:69], v[72:73]
    v_pk_add_f32 v[70:71], v[70:71], v[74:75]
    v_pk_add_f32 v[60:61], v[60:61], v[68:69]
    v_pk_add_f32 v[62:63], v[62:63], v[70:71]
    v_fmac_f32 v60, v10, v188
    v_fmac_f32 v61, v11, v188
    v_fmac_f32 v62, v12, v188
    v_fmac_f32 v63, v13, v188
    v_cvt_pk_bf16_f32 v60, v60, v61
    v_cvt_pk_bf16_f32 v61, v62, v63
    buffer_store_dwordx2 v[60:61], v183, s[8:11], s40 offen
    v_lshlrev_b32 v10, 16, v198
    v_and_b32 v11, 0xffff0000, v198
    v_lshlrev_b32 v12, 16, v199
    v_and_b32 v13, 0xffff0000, v199
    s_waitcnt lgkmcnt(4)
    v_pk_add_f32 v[76:77], v[76:77], v[80:81]
    v_pk_add_f32 v[78:79], v[78:79], v[82:83]
    v_pk_add_f32 v[84:85], v[84:85], v[88:89]
    v_pk_add_f32 v[86:87], v[86:87], v[90:91]
    v_pk_add_f32 v[76:77], v[76:77], v[84:85]
    v_pk_add_f32 v[78:79], v[78:79], v[86:87]
    v_fmac_f32 v76, v10, v189
    v_fmac_f32 v77, v11, v189
    v_fmac_f32 v78, v12, v189
    v_fmac_f32 v79, v13, v189
    v_cvt_pk_bf16_f32 v76, v76, v77
    v_cvt_pk_bf16_f32 v77, v78, v79
    buffer_store_dwordx2 v[76:77], v184, s[8:11], s40 offen
    v_lshlrev_b32 v10, 16, v200
    v_and_b32 v11, 0xffff0000, v200
    v_lshlrev_b32 v12, 16, v201
    v_and_b32 v13, 0xffff0000, v201
    s_waitcnt lgkmcnt(0)
    v_pk_add_f32 v[92:93], v[92:93], v[96:97]
    v_pk_add_f32 v[94:95], v[94:95], v[98:99]
    v_pk_add_f32 v[100:101], v[100:101], v[104:105]
    v_pk_add_f32 v[102:103], v[102:103], v[106:107]
    v_pk_add_f32 v[92:93], v[92:93], v[100:101]
    v_pk_add_f32 v[94:95], v[94:95], v[102:103]
    v_fmac_f32 v92, v10, v190
    v_fmac_f32 v93, v11, v190
    v_fmac_f32 v94, v12, v190
    v_fmac_f32 v95, v13, v190
    v_cvt_pk_bf16_f32 v92, v92, v93
    v_cvt_pk_bf16_f32 v93, v94, v95
    buffer_store_dwordx2 v[92:93], v185, s[8:11], s40 offen
    s_endpgm
K1_kv:
    s_add_u32 s72, s26, s25
    s_and_b32 s72, s72, 7
    s_mov_b32 s71, 20447232
    s_cmp_eq_u32 s2, 127
    s_cselect_b32 s71, s71, 2130706432
    v_lshlrev_b32 v9, 5, v15
    v_mov_b32 v16, 0
    v_mov_b32 v17, 0
    v_mov_b32 v18, 0
    v_mov_b32 v19, 0
    buffer_store_dwordx4 v[16:19], v9, s[16:19], s71 offen sc1
    s_sub_u32 s71, s2, 96
    s_lshl_b32 s71, s71, 12
    s_add_u32 s71, s71, 17825792
    s_cmp_ge_u32 s2, 96
    s_cselect_b32 s71, s71, 2130706432
    v_lshlrev_b32 v9, 4, v15
    buffer_store_dwordx4 v[16:19], v9, s[16:19], s71 offen sc1
    s_mul_i32 s71, s26, 160
    s_mul_i32 s74, s24, 61440
    s_add_u32 s71, s71, s74
    s_add_u32 s71, s71, 1280
    v_add_u32 v9, 0, v3
    v_mul_u32_u24 v10, 3277, v9
    v_lshrrev_b32 v10, 16, v10
    v_mul_u32_u24 v16, 20, v10
    v_sub_u32 v9, v9, v16
    v_cmp_lt_u32 vcc, 9, v9
    v_mul_u32_u24 v10, 3840, v10
    v_lshl_add_u32 v10, v9, 4, v10
    v_add_u32 v16, 1120, v10
    v_cndmask_b32 v10, v10, v16, vcc
    v_add_u32 v4, s71, v10
    v_add_u32 v9, 64, v3
    v_mul_u32_u24 v10, 3277, v9
    v_lshrrev_b32 v10, 16, v10
    v_mul_u32_u24 v16, 20, v10
    v_sub_u32 v9, v9, v16
    v_cmp_lt_u32 vcc, 9, v9
    v_mul_u32_u24 v10, 3840, v10
    v_lshl_add_u32 v10, v9, 4, v10
    v_add_u32 v16, 1120, v10
    v_cndmask_b32 v10, v10, v16, vcc
    v_add_u32 v5, s71, v10
    v_subrev_u32 v5, 1024, v5
    v_add_u32 v9, 128, v3
    v_mul_u32_u24 v10, 3277, v9
    v_lshrrev_b32 v10, 16, v10
    v_mul_u32_u24 v16, 20, v10
    v_sub_u32 v9, v9, v16
    v_cmp_lt_u32 vcc, 9, v9
    v_mul_u32_u24 v10, 3840, v10
    v_lshl_add_u32 v10, v9, 4, v10
    v_add_u32 v16, 1120, v10
    v_cndmask_b32 v10, v10, v16, vcc
    v_add_u32 v6, s71, v10
    v_subrev_u32 v6, 2048, v6
    v_add_u32 v9, 192, v3
    v_mul_u32_u24 v10, 3277, v9
    v_lshrrev_b32 v10, 16, v10
    v_mul_u32_u24 v16, 20, v10
    v_sub_u32 v9, v9, v16
    v_cmp_lt_u32 vcc, 9, v9
    v_mul_u32_u24 v10, 3840, v10
    v_lshl_add_u32 v10, v9, 4, v10
    v_add_u32 v16, 1120, v10
    v_cndmask_b32 v10, v10, v16, vcc
    v_add_u32 v7, s71, v10
    v_subrev_u32 v7, 3072, v7
    v_add_u32 v9, 256, v3
    v_mul_u32_u24 v10, 3277, v9
    v_lshrrev_b32 v10, 16, v10
    v_mul_u32_u24 v16, 20, v10
    v_sub_u32 v9, v9, v16
    v_cmp_lt_u32 vcc, 9, v9
    v_mul_u32_u24 v10, 3840, v10
    v_lshl_add_u32 v10, v9, 4, v10
    v_add_u32 v16, 1120, v10
    v_cndmask_b32 v10, v10, v16, vcc
    v_add_u32 v8, s71, v10
    s_add_u32 m0, s27, 20480
    s_add_u32 s29, s40, 0
    buffer_load_dwordx4 v0, s[4:7], s29 offen lds
    s_add_u32 m0, s27, 21504
    s_add_u32 s29, s40, 10240
    buffer_load_dwordx4 v1, s[4:7], s29 offen lds
    s_add_u32 m0, s27, 22528
    s_add_u32 s29, s40, 20480
    buffer_load_dwordx4 v0, s[4:7], s29 offen lds
    s_add_u32 m0, s27, 23552
    s_add_u32 s29, s40, 30720
    buffer_load_dwordx4 v1, s[4:7], s29 offen lds
    s_add_u32 m0, s68, 40960
    s_nop 0
    buffer_load_dwordx4 v4, s[8:11], s50 offen offset:0 lds
    buffer_load_dwordx4 v5, s[8:11], s50 offen offset:1024 lds
    buffer_load_dwordx4 v6, s[8:11], s50 offen offset:2048 lds
    buffer_load_dwordx4 v7, s[8:11], s50 offen offset:3072 lds
    s_add_u32 m0, s68, 45056
    s_nop 0
    buffer_load_dwordx4 v8, s[8:11], s50 offen lds
    v_mov_b32 v16, 0x3f803f80
    v_mov_b32 v17, v16
    v_mov_b32 v18, v16
    v_mov_b32 v19, v16
    v_lshlrev_b32 v20, 4, v15
    ds_write_b128 v20, v[16:19] offset:4096
    v_mov_b32 v28, 0
    v_mov_b32 v29, 0
    v_mov_b32 v30, 0
    v_mov_b32 v31, 0
    ds_write_b128 v20, v[28:31] offset:8192
    v_and_b32 v21, 31, v3
    v_lshrrev_b32 v22, 5, v3
    v_bfe_u32 v23, v21, 1, 3
    v_xor_b32 v23, v23, v22
    v_lshlrev_b32 v23, 4, v23
    v_lshl_add_u32 v11, v21, 7, v23
    v_add_u32 v11, s27, v11
    v_lshrrev_b32 v23, 4, v3
    v_xor_b32 v23, v23, v3
    v_and_b32 v23, 1, v23
    v_cmp_eq_u32 vcc, 0, v23
    v_bfe_u32 v24, v3, 1, 1
    v_lshlrev_b32 v24, 12, v24
    v_mov_b32 v23, 0x2000
    v_cndmask_b32 v23, v23, v24, vcc
    v_lshl_add_u32 v14, v22, 4, v23
    v_add_u32 v14, s70, v14
    v_lshrrev_b32 v23, 4, v21
    v_lshlrev_b32 v23, 10, v23
    v_lshl_add_u32 v23, v22, 8, v23
    v_and_b32 v24, 15, v21
    v_lshl_add_u32 v23, v24, 4, v23
    s_and_b32 s71, s24, 1
    s_lshl_b32 s71, s71, 11
    v_add_u32 v23, s71, v23
    v_accvgpr_write_b32 a116, v23
    v_bfe_u32 v23, v21, 2, 1
    v_cmp_eq_u32 vcc, v23, v22
    v_and_b32 v24, 1, v21
    v_lshlrev_b32 v24, 4, v24
    v_mov_b32 v25, 0x3f80
    v_lshlrev_b32 v25, v24, v25
    v_cndmask_b32 v25, 0, v25, vcc
    v_lshrrev_b32 v24, 3, v21
    v_bfe_u32 v26, v21, 1, 1
    v_lshl_add_u32 v24, v24, 1, v26
    v_cmp_eq_u32 vcc, 0, v24
    s_nop 1
    v_cndmask_b32 v26, 0, v25, vcc
    v_accvgpr_write_b32 a84, v26
    v_cmp_eq_u32 vcc, 1, v24
    s_nop 1
    v_cndmask_b32 v26, 0, v25, vcc
    v_accvgpr_write_b32 a85, v26
    v_cmp_eq_u32 vcc, 2, v24
    s_nop 1
    v_cndmask_b32 v26, 0, v25, vcc
    v_accvgpr_write_b32 a86, v26
    v_cmp_eq_u32 vcc, 3, v24
    s_nop 1
    v_cndmask_b32 v26, 0, v25, vcc
    v_accvgpr_write_b32 a87, v26
    v_cmp_eq_u32 vcc, 4, v24
    s_nop 1
    v_cndmask_b32 v26, 0, v25, vcc
    v_accvgpr_write_b32 a88, v26
    v_cmp_eq_u32 vcc, 5, v24
    s_nop 1
    v_cndmask_b32 v26, 0, v25, vcc
    v_accvgpr_write_b32 a89, v26
    v_cmp_eq_u32 vcc, 6, v24
    s_nop 1
    v_cndmask_b32 v26, 0, v25, vcc
    v_accvgpr_write_b32 a90, v26
    v_cmp_eq_u32 vcc, 7, v24
    s_nop 1
    v_cndmask_b32 v26, 0, v25, vcc
    v_accvgpr_write_b32 a91, v26
    v_accvgpr_write_b32 a65, 0
    v_accvgpr_write_b32 a67, 0
    v_accvgpr_write_b32 a69, 0
    v_accvgpr_write_b32 a71, 0
    v_accvgpr_write_b32 a73, 0
    v_accvgpr_write_b32 a75, 0
    v_accvgpr_write_b32 a76, 0
    v_accvgpr_write_b32 a77, 0
    v_accvgpr_write_b32 a81, 0
    v_accvgpr_write_b32 a82, 0
    v_accvgpr_write_b32 a83, 0
    v_lshlrev_b32 v20, 1, v21
    v_accvgpr_write_b32 a117, v15
    s_mov_b32 s69, 2130706432
    s_cmp_ge_u32 s72, 5
    s_cbranch_scc1 K1_sD
    s_cmp_ge_u32 s72, 2
    s_cbranch_scc1 K1_sC
    v_mul_u32_u24 v9, 3840, v13
    v_add_u32 v9, v9, v12
    v_add_u32 v10, 0, v9
    v_accvgpr_write_b32 a112, v10
    v_add_u32 v10, 29696, v9
    v_accvgpr_write_b32 a113, v10
    v_add_u32 v10, 59392, v9
    v_accvgpr_write_b32 a114, v10
    v_add_u32 v10, 89088, v9
    v_accvgpr_write_b32 a115, v10
    s_mov_b32 s12, s78
    s_and_b32 s13, s79, 0xffff
    s_mov_b32 s14, 2457600
    s_mov_b32 s15, 0x20000
    s_mov_b32 s60, s50
    s_mov_b32 s61, s52
    s_mov_b32 s62, s54
    s_mov_b32 s63, s56
    s_mov_b32 s64, s58
    s_add_u32 s32, s72, 8
    s_lshl_b32 s32, s32, 7
    s_lshl_b32 s36, s32, 6
    s_lshl_b32 s71, s25, 1
    s_lshr_b32 s29, s24, 1
    s_add_u32 s71, s71, s29
    s_mul_i32 s71, s71, 81920
    s_add_u32 s36, s36, s71
    s_add_u32 s36, s36, 14680064
    s_branch K1_sE
K1_sC:
    v_mul_u32_u24 v9, 3456, v13
    v_add_u32 v9, v9, v12
    v_add_u32 v10, 0, v9
    v_accvgpr_write_b32 a112, v10
    v_add_u32 v10, 26624, v9
    v_accvgpr_write_b32 a113, v10
    v_add_u32 v10, 53248, v9
    v_accvgpr_write_b32 a114, v10
    v_add_u32 v10, 79872, v9
    v_accvgpr_write_b32 a115, v10
    s_add_u32 s32, s72, 22
    s_lshl_b32 s32, s32, 7
    s_lshl_b32 s36, s32, 6
    s_lshl_b32 s71, s25, 1
    s_lshr_b32 s29, s24, 1
    s_add_u32 s71, s71, s29
    s_mul_i32 s71, s71, 303104
    s_add_u32 s36, s36, s71
    s_add_u32 s36, s36, 0
    s_branch K1_sE
K1_sD:
    s_sub_u32 s71, s72, 5
    s_lshl_b32 s71, s71, 4
    s_add_u32 s71, s71, s25
    s_cmp_ge_u32 s71, 27
    s_cselect_b32 s12, s80, s88
    s_cselect_b32 s13, s81, s89
    s_mov_b32 s74, 2211840
    s_cselect_b32 s14, 819200, s74
    s_cselect_b32 s74, 27, 0
    s_and_b32 s13, s13, 0xffff
    s_sub_u32 s74, s71, s74
    s_mul_i32 s32, s74, 81920
    s_lshl_b32 s71, s71, 1
    s_and_b32 s74, s24, 1
    s_add_u32 s71, s71, s74
    s_mul_i32 s36, s71, 5120
    s_add_u32 s36, s36, 10485760
    s_cmp_ge_u32 s71, 74
    s_cselect_b32 s36, 2130706432, s36
    s_cselect_b32 s14, 0, s14
    v_lshrrev_b32 v9, 4, v3
    v_and_b32 v10, 15, v3
    v_lshlrev_b32 v12, 1, v9
    v_xor_b32 v10, v10, v12
    s_lshl_b32 s71, s24, 4
    v_add_u32 v9, s71, v9
    v_mul_u32_u24 v9, 1280, v9
    v_lshl_add_u32 v9, v10, 4, v9
    v_xor_b32 v10, 0, v9
    v_add_u32 v10, 0, v10
    v_accvgpr_write_b32 a112, v10
    v_xor_b32 v10, 128, v9
    v_add_u32 v10, 4096, v10
    v_accvgpr_write_b32 a113, v10
    v_xor_b32 v10, 0, v9
    v_add_u32 v10, 8192, v10
    v_accvgpr_write_b32 a114, v10
    v_xor_b32 v10, 128, v9
    v_add_u32 v10, 12288, v10
    v_accvgpr_write_b32 a115, v10
    s_movk_i32 s60, 0
    s_movk_i32 s61, 256
    s_movk_i32 s62, 512
    s_movk_i32 s63, 768
    s_movk_i32 s64, 1024
K1_sE:
    buffer_load_ushort a64, v20, s[20:23], s32 offen offset:0
    buffer_load_ushort a66, v20, s[20:23], s32 offen offset:64
    v_accvgpr_write_b32 a68, 0
    v_accvgpr_write_b32 a70, 0
    v_bfe_u32 v12, v3, 2, 2
    v_lshrrev_b32 v9, 5, v3
    v_lshl_add_u32 v9, v9, 3, v12
    v_mul_u32_u24 v9, 320, v9
    v_bfe_u32 v12, v3, 4, 1
    v_lshl_add_u32 v9, v12, 5, v9
    v_and_b32 v12, 3, v3
    v_lshl_add_u32 v9, v12, 3, v9
    s_add_u32 m0, s27, 61440
    s_add_u32 s29, s41, 0
    buffer_load_dwordx4 v0, s[4:7], s29 offen lds
    s_add_u32 m0, s27, 62464
    s_add_u32 s29, s41, 10240
    buffer_load_dwordx4 v1, s[4:7], s29 offen lds
    s_add_u32 m0, s27, 63488
    s_add_u32 s29, s41, 20480
    buffer_load_dwordx4 v0, s[4:7], s29 offen lds
    s_add_u32 m0, s27, 64512
    s_add_u32 s29, s41, 30720
    buffer_load_dwordx4 v1, s[4:7], s29 offen lds
    s_add_u32 m0, s68, 81920
    s_nop 0
    buffer_load_dwordx4 v4, s[8:11], s51 offen offset:0 lds
    buffer_load_dwordx4 v5, s[8:11], s51 offen offset:1024 lds
    buffer_load_dwordx4 v6, s[8:11], s51 offen offset:2048 lds
    buffer_load_dwordx4 v7, s[8:11], s51 offen offset:3072 lds
    s_add_u32 m0, s68, 86016
    s_nop 0
    buffer_load_dwordx4 v8, s[8:11], s51 offen lds
    s_cmp_ge_u32 s2, 96
    s_cselect_b32 s74, 0, 2130706432
    s_cmp_eq_u32 s24, 0
    s_cselect_b32 s74, s74, 2130706432
    s_sub_u32 s71, s72, 2
    s_cmp_lt_u32 s71, 3
    s_cselect_b64 vcc, 0, -1
    s_waitcnt vmcnt(11) lgkmcnt(0)
    s_barrier
    v_xor_b32 v12, 0, v11
    ds_read_b128 v[96:99], v12 offset:20480
    ds_read_b128 a[0:3], v14 offset:0
    ds_read_b64_tr_b16 a[4:5], v9 offset:40960
    ds_read_b64_tr_b16 a[6:7], v9 offset:42240
    ds_read_b64_tr_b16 a[8:9], v9 offset:41024
    ds_read_b64_tr_b16 a[10:11], v9 offset:42304
    ds_read_b64_tr_b16 a[12:13], v9 offset:41088
    ds_read_b64_tr_b16 a[14:15], v9 offset:42368
    ds_read_b64_tr_b16 a[16:17], v9 offset:41152
    ds_read_b64_tr_b16 a[18:19], v9 offset:42432
    s_waitcnt lgkmcnt(4)
    s_cbranch_vccnz K1_ns0
    v_mfma_f32_16x16x32_bf16 a[96:99], a[0:3], v[96:99], 0
    v_mfma_f32_4x4x4_16b_bf16 a[100:103], v[96:97], v[96:97], 0
    v_mfma_f32_4x4x4_16b_bf16 a[104:107], v[98:99], v[98:99], 0
K1_ns0:
    ds_read_b64_tr_b16 a[20:21], v9 offset:41216
    ds_read_b64_tr_b16 a[22:23], v9 offset:42496
    v_mov_b32 v10, 1
    s_mov_b64 exec, 1
    buffer_atomic_add v10, off, s[96:99], s74 sc1
    s_mov_b64 exec, -1
    s_add_u32 m0, s27, 102400
    s_add_u32 s29, s42, 0
    buffer_load_dwordx4 v0, s[4:7], s29 offen lds
    v_mfma_f32_32x32x16_bf16 v[16:31], v[96:99], a[4:7], 0
    v_xor_b32 v13, 32, v11
    ds_read_b128 v[100:103], v13 offset:20480
    ds_read_b128 a[24:27], v14 offset:32
    s_add_u32 m0, s27, 103424
    s_add_u32 s29, s42, 10240
    buffer_load_dwordx4 v1, s[4:7], s29 offen lds
    v_mfma_f32_32x32x16_bf16 v[32:47], v[96:99], a[8:11], 0
    ds_read_b64_tr_b16 a[28:29], v9 offset:46080
    ds_read_b64_tr_b16 a[30:31], v9 offset:47360
    s_add_u32 m0, s27, 104448
    s_add_u32 s29, s42, 20480
    buffer_load_dwordx4 v0, s[4:7], s29 offen lds
    s_waitcnt lgkmcnt(4)
    v_mfma_f32_32x32x16_bf16 v[48:63], v[96:99], a[12:15], 0
    ds_read_b64_tr_b16 a[32:33], v9 offset:46144
    ds_read_b64_tr_b16 a[34:35], v9 offset:47424
    s_add_u32 m0, s27, 105472
    s_add_u32 s29, s42, 30720
    buffer_load_dwordx4 v1, s[4:7], s29 offen lds
    v_mfma_f32_32x32x16_bf16 v[64:79], v[96:99], a[16:19], 0
    ds_read_b64_tr_b16 a[36:37], v9 offset:46208
    ds_read_b64_tr_b16 a[38:39], v9 offset:47488
    s_add_u32 m0, s68, 122880
    s_nop 0
    buffer_load_dwordx4 v4, s[8:11], s52 offen offset:0 lds
    v_mfma_f32_32x32x16_bf16 v[80:95], v[96:99], a[20:23], 0
    ds_read_b64_tr_b16 a[40:41], v9 offset:46272
    ds_read_b64_tr_b16 a[42:43], v9 offset:47552
    buffer_load_dwordx4 v5, s[8:11], s52 offen offset:1024 lds
    s_waitcnt lgkmcnt(4)
    s_cbranch_vccnz K1_ns1
    v_mfma_f32_16x16x32_bf16 a[96:99], a[24:27], v[100:103], a[96:99]
    v_mfma_f32_4x4x4_16b_bf16 a[100:103], v[100:101], v[100:101], a[100:103]
    v_mfma_f32_4x4x4_16b_bf16 a[104:107], v[102:103], v[102:103], a[104:107]
K1_ns1:
    ds_read_b64_tr_b16 a[44:45], v9 offset:46336
    ds_read_b64_tr_b16 a[46:47], v9 offset:47616
    buffer_load_dwordx4 v6, s[8:11], s52 offen offset:2048 lds
    v_mfma_f32_32x32x16_bf16 v[16:31], v[100:103], a[28:31], v[16:31]
    v_xor_b32 v12, 64, v11
    ds_read_b128 v[104:107], v12 offset:20480
    ds_read_b128 a[0:3], v14 offset:64
    buffer_load_dwordx4 v7, s[8:11], s52 offen offset:3072 lds
    v_mfma_f32_32x32x16_bf16 v[32:47], v[100:103], a[32:35], v[32:47]
    ds_read_b64_tr_b16 a[4:5], v9 offset:51200
    ds_read_b64_tr_b16 a[6:7], v9 offset:52480
    s_add_u32 m0, s68, 126976
    s_nop 0
    buffer_load_dwordx4 v8, s[8:11], s52 offen lds
    s_waitcnt lgkmcnt(4)
    v_mfma_f32_32x32x16_bf16 v[48:63], v[100:103], a[36:39], v[48:63]
    ds_read_b64_tr_b16 a[8:9], v9 offset:51264
    ds_read_b64_tr_b16 a[10:11], v9 offset:52544
    v_mfma_f32_32x32x16_bf16 v[64:79], v[100:103], a[40:43], v[64:79]
    ds_read_b64_tr_b16 a[12:13], v9 offset:51328
    ds_read_b64_tr_b16 a[14:15], v9 offset:52608
    v_mfma_f32_32x32x16_bf16 v[80:95], v[100:103], a[44:47], v[80:95]
    ds_read_b64_tr_b16 a[16:17], v9 offset:51392
    ds_read_b64_tr_b16 a[18:19], v9 offset:52672
    s_waitcnt lgkmcnt(4)
    s_cbranch_vccnz K1_ns2
    v_mfma_f32_16x16x32_bf16 a[96:99], a[0:3], v[104:107], a[96:99]
    v_mfma_f32_4x4x4_16b_bf16 a[100:103], v[104:105], v[104:105], a[100:103]
    v_mfma_f32_4x4x4_16b_bf16 a[104:107], v[106:107], v[106:107], a[104:107]
K1_ns2:
    ds_read_b64_tr_b16 a[20:21], v9 offset:51456
    ds_read_b64_tr_b16 a[22:23], v9 offset:52736
    v_mfma_f32_32x32x16_bf16 v[16:31], v[104:107], a[4:7], v[16:31]
    v_xor_b32 v13, 96, v11
    ds_read_b128 v[108:111], v13 offset:20480
    ds_read_b128 a[24:27], v14 offset:96
    v_mfma_f32_32x32x16_bf16 v[32:47], v[104:107], a[8:11], v[32:47]
    ds_read_b64_tr_b16 a[28:29], v9 offset:56320
    ds_read_b64_tr_b16 a[30:31], v9 offset:57600
    s_waitcnt lgkmcnt(4)
    v_mfma_f32_32x32x16_bf16 v[48:63], v[104:107], a[12:15], v[48:63]
    ds_read_b64_tr_b16 a[32:33], v9 offset:56384
    ds_read_b64_tr_b16 a[34:35], v9 offset:57664
    v_mfma_f32_32x32x16_bf16 v[64:79], v[104:107], a[16:19], v[64:79]
    ds_read_b64_tr_b16 a[36:37], v9 offset:56448
    ds_read_b64_tr_b16 a[38:39], v9 offset:57728
    v_mfma_f32_32x32x16_bf16 v[80:95], v[104:107], a[20:23], v[80:95]
    ds_read_b64_tr_b16 a[40:41], v9 offset:56512
    ds_read_b64_tr_b16 a[42:43], v9 offset:57792
    s_waitcnt lgkmcnt(4)
    s_cbranch_vccnz K1_ns3
    v_mfma_f32_16x16x32_bf16 a[96:99], a[24:27], v[108:111], a[96:99]
    v_mfma_f32_4x4x4_16b_bf16 a[100:103], v[108:109], v[108:109], a[100:103]
    v_mfma_f32_4x4x4_16b_bf16 a[104:107], v[110:111], v[110:111], a[104:107]
K1_ns3:
    ds_read_b64_tr_b16 a[44:45], v9 offset:56576
    ds_read_b64_tr_b16 a[46:47], v9 offset:57856
    v_mfma_f32_32x32x16_bf16 v[16:31], v[108:111], a[28:31], v[16:31]
    s_waitcnt vmcnt(10) lgkmcnt(0)
    s_barrier
    v_xor_b32 v12, 0, v11
    ds_read_b128 v[112:115], v12 offset:61440
    ds_read_b128 a[0:3], v14 offset:128
    s_add_u32 m0, s27, 143360
    s_add_u32 s29, s43, 0
    buffer_load_dwordx4 v0, s[4:7], s29 offen lds
    v_mfma_f32_32x32x16_bf16 v[32:47], v[108:111], a[32:35], v[32:47]
    v_add_u32 v9, 81920, v9
    ds_read_b64_tr_b16 a[4:5], v9 offset:0
    ds_read_b64_tr_b16 a[6:7], v9 offset:1280
    s_add_u32 m0, s27, 144384
    s_add_u32 s29, s43, 10240
    buffer_load_dwordx4 v1, s[4:7], s29 offen lds
    v_mfma_f32_32x32x16_bf16 v[48:63], v[108:111], a[36:39], v[48:63]
    ds_read_b64_tr_b16 a[8:9], v9 offset:64
    ds_read_b64_tr_b16 a[10:11], v9 offset:1344
    s_add_u32 m0, s27, 145408
    s_add_u32 s29, s43, 20480
    buffer_load_dwordx4 v0, s[4:7], s29 offen lds
    v_mfma_f32_32x32x16_bf16 v[64:79], v[108:111], a[40:43], v[64:79]
    ds_read_b64_tr_b16 a[12:13], v9 offset:128
    ds_read_b64_tr_b16 a[14:15], v9 offset:1408
    s_add_u32 m0, s27, 146432
    s_add_u32 s29, s43, 30720
    buffer_load_dwordx4 v1, s[4:7], s29 offen lds
    v_mfma_f32_32x32x16_bf16 v[80:95], v[108:111], a[44:47], v[80:95]
    ds_read_b64_tr_b16 a[16:17], v9 offset:192
    ds_read_b64_tr_b16 a[18:19], v9 offset:1472
    s_add_u32 m0, s68, 20480
    s_nop 0
    buffer_load_dwordx4 v4, s[8:11], s53 offen offset:0 lds
    s_waitcnt lgkmcnt(4)
    s_cbranch_vccnz K1_ns4
    v_mfma_f32_16x16x32_bf16 a[96:99], a[0:3], v[112:115], a[96:99]
    v_mfma_f32_4x4x4_16b_bf16 a[100:103], v[112:113], v[112:113], a[100:103]
    v_mfma_f32_4x4x4_16b_bf16 a[104:107], v[114:115], v[114:115], a[104:107]
K1_ns4:
    ds_read_b64_tr_b16 a[20:21], v9 offset:256
    ds_read_b64_tr_b16 a[22:23], v9 offset:1536
    buffer_load_dwordx4 v5, s[8:11], s53 offen offset:1024 lds
    v_mfma_f32_32x32x16_bf16 v[16:31], v[112:115], a[4:7], v[16:31]
    v_xor_b32 v13, 32, v11
    ds_read_b128 v[116:119], v13 offset:61440
    ds_read_b128 a[24:27], v14 offset:160
    buffer_load_dwordx4 v6, s[8:11], s53 offen offset:2048 lds
    v_mfma_f32_32x32x16_bf16 v[32:47], v[112:115], a[8:11], v[32:47]
    ds_read_b64_tr_b16 a[28:29], v9 offset:5120
    ds_read_b64_tr_b16 a[30:31], v9 offset:6400
    buffer_load_dwordx4 v7, s[8:11], s53 offen offset:3072 lds
    s_waitcnt lgkmcnt(4)
    v_mfma_f32_32x32x16_bf16 v[48:63], v[112:115], a[12:15], v[48:63]
    ds_read_b64_tr_b16 a[32:33], v9 offset:5184
    ds_read_b64_tr_b16 a[34:35], v9 offset:6464
    s_add_u32 m0, s68, 24576
    s_nop 0
    buffer_load_dwordx4 v8, s[8:11], s53 offen lds
    v_mfma_f32_32x32x16_bf16 v[64:79], v[112:115], a[16:19], v[64:79]
    ds_read_b64_tr_b16 a[36:37], v9 offset:5248
    ds_read_b64_tr_b16 a[38:39], v9 offset:6528
    v_mfma_f32_32x32x16_bf16 v[80:95], v[112:115], a[20:23], v[80:95]
    ds_read_b64_tr_b16 a[40:41], v9 offset:5312
    ds_read_b64_tr_b16 a[42:43], v9 offset:6592
    s_waitcnt lgkmcnt(4)
    s_cbranch_vccnz K1_ns5
    v_mfma_f32_16x16x32_bf16 a[96:99], a[24:27], v[116:119], a[96:99]
    v_mfma_f32_4x4x4_16b_bf16 a[100:103], v[116:117], v[116:117], a[100:103]
    v_mfma_f32_4x4x4_16b_bf16 a[104:107], v[118:119], v[118:119], a[104:107]
K1_ns5:
    ds_read_b64_tr_b16 a[44:45], v9 offset:5376
    ds_read_b64_tr_b16 a[46:47], v9 offset:6656
    v_mfma_f32_32x32x16_bf16 v[16:31], v[116:119], a[28:31], v[16:31]
    v_xor_b32 v12, 64, v11
    ds_read_b128 v[120:123], v12 offset:61440
    ds_read_b128 a[0:3], v14 offset:192
    v_mfma_f32_32x32x16_bf16 v[32:47], v[116:119], a[32:35], v[32:47]
    ds_read_b64_tr_b16 a[4:5], v9 offset:10240
    ds_read_b64_tr_b16 a[6:7], v9 offset:11520
    s_waitcnt lgkmcnt(4)
    v_mfma_f32_32x32x16_bf16 v[48:63], v[116:119], a[36:39], v[48:63]
    ds_read_b64_tr_b16 a[8:9], v9 offset:10304
    ds_read_b64_tr_b16 a[10:11], v9 offset:11584
    v_mfma_f32_32x32x16_bf16 v[64:79], v[116:119], a[40:43], v[64:79]
    ds_read_b64_tr_b16 a[12:13], v9 offset:10368
    ds_read_b64_tr_b16 a[14:15], v9 offset:11648
    v_mfma_f32_32x32x16_bf16 v[80:95], v[116:119], a[44:47], v[80:95]
    ds_read_b64_tr_b16 a[16:17], v9 offset:10432
    ds_read_b64_tr_b16 a[18:19], v9 offset:11712
    s_waitcnt lgkmcnt(4)
    s_cbranch_vccnz K1_ns6
    v_mfma_f32_16x16x32_bf16 a[96:99], a[0:3], v[120:123], a[96:99]
    v_mfma_f32_4x4x4_16b_bf16 a[100:103], v[120:121], v[120:121], a[100:103]
    v_mfma_f32_4x4x4_16b_bf16 a[104:107], v[122:123], v[122:123], a[104:107]
K1_ns6:
    ds_read_b64_tr_b16 a[20:21], v9 offset:10496
    ds_read_b64_tr_b16 a[22:23], v9 offset:11776
    v_mfma_f32_32x32x16_bf16 v[16:31], v[120:123], a[4:7], v[16:31]
    v_xor_b32 v13, 96, v11
    ds_read_b128 v[124:127], v13 offset:61440
    ds_read_b128 a[24:27], v14 offset:224
    v_mfma_f32_32x32x16_bf16 v[32:47], v[120:123], a[8:11], v[32:47]
    ds_read_b64_tr_b16 a[28:29], v9 offset:15360
    ds_read_b64_tr_b16 a[30:31], v9 offset:16640
    s_waitcnt lgkmcnt(4)
    v_mfma_f32_32x32x16_bf16 v[48:63], v[120:123], a[12:15], v[48:63]
    ds_read_b64_tr_b16 a[32:33], v9 offset:15424
    ds_read_b64_tr_b16 a[34:35], v9 offset:16704
    v_mfma_f32_32x32x16_bf16 v[64:79], v[120:123], a[16:19], v[64:79]
    ds_read_b64_tr_b16 a[36:37], v9 offset:15488
    ds_read_b64_tr_b16 a[38:39], v9 offset:16768
    v_mfma_f32_32x32x16_bf16 v[80:95], v[120:123], a[20:23], v[80:95]
    ds_read_b64_tr_b16 a[40:41], v9 offset:15552
    ds_read_b64_tr_b16 a[42:43], v9 offset:16832
    s_waitcnt lgkmcnt(4)
    s_cbranch_vccnz K1_ns7
    v_mfma_f32_16x16x32_bf16 a[96:99], a[24:27], v[124:127], a[96:99]
    v_mfma_f32_4x4x4_16b_bf16 a[100:103], v[124:125], v[124:125], a[100:103]
    v_mfma_f32_4x4x4_16b_bf16 a[104:107], v[126:127], v[126:127], a[104:107]
K1_ns7:
    ds_read_b64_tr_b16 a[44:45], v9 offset:15616
    ds_read_b64_tr_b16 a[46:47], v9 offset:16896
    v_mfma_f32_32x32x16_bf16 v[16:31], v[124:127], a[28:31], v[16:31]
    s_waitcnt vmcnt(9) lgkmcnt(0)
    s_barrier
    v_xor_b32 v12, 65536, v11
    ds_read_b128 v[128:131], v12 offset:36864
    ds_read_b128 a[0:3], v14 offset:256
    s_add_u32 m0, s27, 40960
    s_add_u32 s29, s44, 0
    buffer_load_dwordx4 v0, s[4:7], s29 offen lds
    v_mfma_f32_32x32x16_bf16 v[32:47], v[124:127], a[32:35], v[32:47]
    ds_read_b64_tr_b16 a[4:5], v9 offset:40960
    ds_read_b64_tr_b16 a[6:7], v9 offset:42240
    s_add_u32 m0, s27, 41984
    s_add_u32 s29, s44, 10240
    buffer_load_dwordx4 v1, s[4:7], s29 offen lds
    v_mfma_f32_32x32x16_bf16 v[48:63], v[124:127], a[36:39], v[48:63]
    ds_read_b64_tr_b16 a[8:9], v9 offset:41024
    ds_read_b64_tr_b16 a[10:11], v9 offset:42304
    s_add_u32 m0, s27, 43008
    s_add_u32 s29, s44, 20480
    buffer_load_dwordx4 v0, s[4:7], s29 offen lds
    v_mfma_f32_32x32x16_bf16 v[64:79], v[124:127], a[40:43], v[64:79]
    ds_read_b64_tr_b16 a[12:13], v9 offset:41088
    ds_read_b64_tr_b16 a[14:15], v9 offset:42368
    s_add_u32 m0, s27, 44032
    s_add_u32 s29, s44, 30720
    buffer_load_dwordx4 v1, s[4:7], s29 offen lds
    v_mfma_f32_32x32x16_bf16 v[80:95], v[124:127], a[44:47], v[80:95]
    ds_read_b64_tr_b16 a[16:17], v9 offset:41152
    ds_read_b64_tr_b16 a[18:19], v9 offset:42432
    s_add_u32 m0, s68, 61440
    s_nop 0
    buffer_load_dwordx4 v4, s[8:11], s54 offen offset:0 lds
    s_waitcnt lgkmcnt(4)
    s_cbranch_vccnz K1_ns8
    v_mfma_f32_16x16x32_bf16 a[96:99], a[0:3], v[128:131], a[96:99]
    v_mfma_f32_4x4x4_16b_bf16 a[100:103], v[128:129], v[128:129], a[100:103]
    v_mfma_f32_4x4x4_16b_bf16 a[104:107], v[130:131], v[130:131], a[104:107]
K1_ns8:
    ds_read_b64_tr_b16 a[20:21], v9 offset:41216
    ds_read_b64_tr_b16 a[22:23], v9 offset:42496
    buffer_load_dwordx4 v5, s[8:11], s54 offen offset:1024 lds
    v_mfma_f32_32x32x16_bf16 v[16:31], v[128:131], a[4:7], v[16:31]
    v_xor_b32 v13, 65568, v11
    ds_read_b128 v[132:135], v13 offset:36864
    ds_read_b128 a[24:27], v14 offset:288
    buffer_load_dwordx4 v6, s[8:11], s54 offen offset:2048 lds
    v_mfma_f32_32x32x16_bf16 v[32:47], v[128:131], a[8:11], v[32:47]
    ds_read_b64_tr_b16 a[28:29], v9 offset:46080
    ds_read_b64_tr_b16 a[30:31], v9 offset:47360
    buffer_load_dwordx4 v7, s[8:11], s54 offen offset:3072 lds
    s_waitcnt lgkmcnt(4)
    v_mfma_f32_32x32x16_bf16 v[48:63], v[128:131], a[12:15], v[48:63]
    ds_read_b64_tr_b16 a[32:33], v9 offset:46144
    ds_read_b64_tr_b16 a[34:35], v9 offset:47424
    s_add_u32 m0, s68, 65536
    s_nop 0
    buffer_load_dwordx4 v8, s[8:11], s54 offen lds
    v_mfma_f32_32x32x16_bf16 v[64:79], v[128:131], a[16:19], v[64:79]
    ds_read_b64_tr_b16 a[36:37], v9 offset:46208
    ds_read_b64_tr_b16 a[38:39], v9 offset:47488
    s_add_u32 m0, s27, 81920
    s_add_u32 s29, s45, 0
    buffer_load_dwordx4 v0, s[4:7], s29 offen lds
    v_mfma_f32_32x32x16_bf16 v[80:95], v[128:131], a[20:23], v[80:95]
    ds_read_b64_tr_b16 a[40:41], v9 offset:46272
    ds_read_b64_tr_b16 a[42:43], v9 offset:47552
    s_add_u32 m0, s27, 82944
    s_add_u32 s29, s45, 10240
    buffer_load_dwordx4 v1, s[4:7], s29 offen lds
    s_waitcnt lgkmcnt(4)
    s_cbranch_vccnz K1_ns9
    v_mfma_f32_16x16x32_bf16 a[96:99], a[24:27], v[132:135], a[96:99]
    v_mfma_f32_4x4x4_16b_bf16 a[100:103], v[132:133], v[132:133], a[100:103]
    v_mfma_f32_4x4x4_16b_bf16 a[104:107], v[134:135], v[134:135], a[104:107]
K1_ns9:
    ds_read_b64_tr_b16 a[44:45], v9 offset:46336
    ds_read_b64_tr_b16 a[46:47], v9 offset:47616
    s_add_u32 m0, s27, 83968
    s_add_u32 s29, s45, 20480
    buffer_load_dwordx4 v0, s[4:7], s29 offen lds
    v_mfma_f32_32x32x16_bf16 v[16:31], v[132:135], a[28:31], v[16:31]
    v_xor_b32 v12, 65600, v11
    ds_read_b128 v[136:139], v12 offset:36864
    ds_read_b128 a[0:3], v14 offset:320
    s_add_u32 m0, s27, 84992
    s_add_u32 s29, s45, 30720
    buffer_load_dwordx4 v1, s[4:7], s29 offen lds
    v_mfma_f32_32x32x16_bf16 v[32:47], v[132:135], a[32:35], v[32:47]
    ds_read_b64_tr_b16 a[4:5], v9 offset:51200
    ds_read_b64_tr_b16 a[6:7], v9 offset:52480
    s_waitcnt lgkmcnt(4)
    v_mfma_f32_32x32x16_bf16 v[48:63], v[132:135], a[36:39], v[48:63]
    ds_read_b64_tr_b16 a[8:9], v9 offset:51264
    ds_read_b64_tr_b16 a[10:11], v9 offset:52544
    v_mfma_f32_32x32x16_bf16 v[64:79], v[132:135], a[40:43], v[64:79]
    ds_read_b64_tr_b16 a[12:13], v9 offset:51328
    ds_read_b64_tr_b16 a[14:15], v9 offset:52608
    v_mfma_f32_32x32x16_bf16 v[80:95], v[132:135], a[44:47], v[80:95]
    ds_read_b64_tr_b16 a[16:17], v9 offset:51392
    ds_read_b64_tr_b16 a[18:19], v9 offset:52672
    s_waitcnt lgkmcnt(4)
    s_cbranch_vccnz K1_ns10
    v_mfma_f32_16x16x32_bf16 a[96:99], a[0:3], v[136:139], a[96:99]
    v_mfma_f32_4x4x4_16b_bf16 a[100:103], v[136:137], v[136:137], a[100:103]
    v_mfma_f32_4x4x4_16b_bf16 a[104:107], v[138:139], v[138:139], a[104:107]
K1_ns10:
    ds_read_b64_tr_b16 a[20:21], v9 offset:51456
    ds_read_b64_tr_b16 a[22:23], v9 offset:52736
    v_mfma_f32_32x32x16_bf16 v[16:31], v[136:139], a[4:7], v[16:31]
    v_xor_b32 v13, 65632, v11
    ds_read_b128 v[140:143], v13 offset:36864
    ds_read_b128 a[24:27], v14 offset:352
    v_mfma_f32_32x32x16_bf16 v[32:47], v[136:139], a[8:11], v[32:47]
    ds_read_b64_tr_b16 a[28:29], v9 offset:56320
    ds_read_b64_tr_b16 a[30:31], v9 offset:57600
    s_waitcnt lgkmcnt(4)
    v_mfma_f32_32x32x16_bf16 v[48:63], v[136:139], a[12:15], v[48:63]
    ds_read_b64_tr_b16 a[32:33], v9 offset:56384
    ds_read_b64_tr_b16 a[34:35], v9 offset:57664
    v_mfma_f32_32x32x16_bf16 v[64:79], v[136:139], a[16:19], v[64:79]
    ds_read_b64_tr_b16 a[36:37], v9 offset:56448
    ds_read_b64_tr_b16 a[38:39], v9 offset:57728
    v_mfma_f32_32x32x16_bf16 v[80:95], v[136:139], a[20:23], v[80:95]
    ds_read_b64_tr_b16 a[40:41], v9 offset:56512
    ds_read_b64_tr_b16 a[42:43], v9 offset:57792
    s_waitcnt lgkmcnt(4)
    s_cbranch_vccnz K1_ns11
    v_mfma_f32_16x16x32_bf16 a[96:99], a[24:27], v[140:143], a[96:99]
    v_mfma_f32_4x4x4_16b_bf16 a[100:103], v[140:141], v[140:141], a[100:103]
    v_mfma_f32_4x4x4_16b_bf16 a[104:107], v[142:143], v[142:143], a[104:107]
K1_ns11:
    ds_read_b64_tr_b16 a[44:45], v9 offset:56576
    ds_read_b64_tr_b16 a[46:47], v9 offset:57856
    v_mfma_f32_32x32x16_bf16 v[16:31], v[140:143], a[28:31], v[16:31]
    s_waitcnt vmcnt(13) lgkmcnt(0)
    s_barrier
    v_xor_b32 v12, 131072, v11
    ds_read_b128 v[144:147], v12 offset:12288
    ds_read_b128 a[0:3], v14 offset:384
    s_add_u32 m0, s68, 102400
    s_nop 0
    buffer_load_dwordx4 v4, s[8:11], s55 offen offset:0 lds
    v_mfma_f32_32x32x16_bf16 v[32:47], v[140:143], a[32:35], v[32:47]
    v_add_u32 v9, 4294905856, v9
    ds_read_b64_tr_b16 a[4:5], v9 offset:0
    ds_read_b64_tr_b16 a[6:7], v9 offset:1280
    buffer_load_dwordx4 v5, s[8:11], s55 offen offset:1024 lds
    v_mfma_f32_32x32x16_bf16 v[48:63], v[140:143], a[36:39], v[48:63]
    ds_read_b64_tr_b16 a[8:9], v9 offset:64
    ds_read_b64_tr_b16 a[10:11], v9 offset:1344
    buffer_load_dwordx4 v6, s[8:11], s55 offen offset:2048 lds
    v_mfma_f32_32x32x16_bf16 v[64:79], v[140:143], a[40:43], v[64:79]
    ds_read_b64_tr_b16 a[12:13], v9 offset:128
    ds_read_b64_tr_b16 a[14:15], v9 offset:1408
    buffer_load_dwordx4 v7, s[8:11], s55 offen offset:3072 lds
    v_mfma_f32_32x32x16_bf16 v[80:95], v[140:143], a[44:47], v[80:95]
    ds_read_b64_tr_b16 a[16:17], v9 offset:192
    ds_read_b64_tr_b16 a[18:19], v9 offset:1472
    s_add_u32 m0, s68, 106496
    s_nop 0
    buffer_load_dwordx4 v8, s[8:11], s55 offen lds
    s_waitcnt lgkmcnt(4)
    s_cbranch_vccnz K1_ns12
    v_mfma_f32_16x16x32_bf16 a[96:99], a[0:3], v[144:147], a[96:99]
    v_mfma_f32_4x4x4_16b_bf16 a[100:103], v[144:145], v[144:145], a[100:103]
    v_mfma_f32_4x4x4_16b_bf16 a[104:107], v[146:147], v[146:147], a[104:107]
K1_ns12:
    ds_read_b64_tr_b16 a[20:21], v9 offset:256
    ds_read_b64_tr_b16 a[22:23], v9 offset:1536
    s_add_u32 m0, s27, 122880
    s_add_u32 s29, s46, 0
    buffer_load_dwordx4 v0, s[4:7], s29 offen lds
    v_mfma_f32_32x32x16_bf16 v[16:31], v[144:147], a[4:7], v[16:31]
    v_xor_b32 v13, 131104, v11
    ds_read_b128 v[148:151], v13 offset:12288
    ds_read_b128 a[24:27], v14 offset:416
    s_add_u32 m0, s27, 123904
    s_add_u32 s29, s46, 10240
    buffer_load_dwordx4 v1, s[4:7], s29 offen lds
    v_mfma_f32_32x32x16_bf16 v[32:47], v[144:147], a[8:11], v[32:47]
    ds_read_b64_tr_b16 a[28:29], v9 offset:5120
    ds_read_b64_tr_b16 a[30:31], v9 offset:6400
    s_add_u32 m0, s27, 124928
    s_add_u32 s29, s46, 20480
    buffer_load_dwordx4 v0, s[4:7], s29 offen lds
    s_waitcnt lgkmcnt(4)
    v_mfma_f32_32x32x16_bf16 v[48:63], v[144:147], a[12:15], v[48:63]
    ds_read_b64_tr_b16 a[32:33], v9 offset:5184
    ds_read_b64_tr_b16 a[34:35], v9 offset:6464
    s_add_u32 m0, s27, 125952
    s_add_u32 s29, s46, 30720
    buffer_load_dwordx4 v1, s[4:7], s29 offen lds
    v_mfma_f32_32x32x16_bf16 v[64:79], v[144:147], a[16:19], v[64:79]
    ds_read_b64_tr_b16 a[36:37], v9 offset:5248
    ds_read_b64_tr_b16 a[38:39], v9 offset:6528
    v_mfma_f32_32x32x16_bf16 v[80:95], v[144:147], a[20:23], v[80:95]
    ds_read_b64_tr_b16 a[40:41], v9 offset:5312
    ds_read_b64_tr_b16 a[42:43], v9 offset:6592
    s_waitcnt lgkmcnt(4)
    s_cbranch_vccnz K1_ns13
    v_mfma_f32_16x16x32_bf16 a[96:99], a[24:27], v[148:151], a[96:99]
    v_mfma_f32_4x4x4_16b_bf16 a[100:103], v[148:149], v[148:149], a[100:103]
    v_mfma_f32_4x4x4_16b_bf16 a[104:107], v[150:151], v[150:151], a[104:107]
K1_ns13:
    ds_read_b64_tr_b16 a[44:45], v9 offset:5376
    ds_read_b64_tr_b16 a[46:47], v9 offset:6656
    v_mfma_f32_32x32x16_bf16 v[16:31], v[148:151], a[28:31], v[16:31]
    v_xor_b32 v12, 131136, v11
    ds_read_b128 v[152:155], v12 offset:12288
    ds_read_b128 a[0:3], v14 offset:448
    v_mfma_f32_32x32x16_bf16 v[32:47], v[148:151], a[32:35], v[32:47]
    ds_read_b64_tr_b16 a[4:5], v9 offset:10240
    ds_read_b64_tr_b16 a[6:7], v9 offset:11520
    s_waitcnt lgkmcnt(4)
    v_mfma_f32_32x32x16_bf16 v[48:63], v[148:151], a[36:39], v[48:63]
    ds_read_b64_tr_b16 a[8:9], v9 offset:10304
    ds_read_b64_tr_b16 a[10:11], v9 offset:11584
    v_mfma_f32_32x32x16_bf16 v[64:79], v[148:151], a[40:43], v[64:79]
    ds_read_b64_tr_b16 a[12:13], v9 offset:10368
    ds_read_b64_tr_b16 a[14:15], v9 offset:11648
    v_mfma_f32_32x32x16_bf16 v[80:95], v[148:151], a[44:47], v[80:95]
    ds_read_b64_tr_b16 a[16:17], v9 offset:10432
    ds_read_b64_tr_b16 a[18:19], v9 offset:11712
    s_waitcnt lgkmcnt(4)
    s_cbranch_vccnz K1_ns14
    v_mfma_f32_16x16x32_bf16 a[96:99], a[0:3], v[152:155], a[96:99]
    v_mfma_f32_4x4x4_16b_bf16 a[100:103], v[152:153], v[152:153], a[100:103]
    v_mfma_f32_4x4x4_16b_bf16 a[104:107], v[154:155], v[154:155], a[104:107]
K1_ns14:
    ds_read_b64_tr_b16 a[20:21], v9 offset:10496
    ds_read_b64_tr_b16 a[22:23], v9 offset:11776
    v_mfma_f32_32x32x16_bf16 v[16:31], v[152:155], a[4:7], v[16:31]
    v_xor_b32 v13, 131168, v11
    ds_read_b128 v[156:159], v13 offset:12288
    ds_read_b128 a[24:27], v14 offset:480
    v_mfma_f32_32x32x16_bf16 v[32:47], v[152:155], a[8:11], v[32:47]
    ds_read_b64_tr_b16 a[28:29], v9 offset:15360
    ds_read_b64_tr_b16 a[30:31], v9 offset:16640
    s_waitcnt lgkmcnt(4)
    v_mfma_f32_32x32x16_bf16 v[48:63], v[152:155], a[12:15], v[48:63]
    ds_read_b64_tr_b16 a[32:33], v9 offset:15424
    ds_read_b64_tr_b16 a[34:35], v9 offset:16704
    v_mfma_f32_32x32x16_bf16 v[64:79], v[152:155], a[16:19], v[64:79]
    ds_read_b64_tr_b16 a[36:37], v9 offset:15488
    ds_read_b64_tr_b16 a[38:39], v9 offset:16768
    v_mfma_f32_32x32x16_bf16 v[80:95], v[152:155], a[20:23], v[80:95]
    ds_read_b64_tr_b16 a[40:41], v9 offset:15552
    ds_read_b64_tr_b16 a[42:43], v9 offset:16832
    s_waitcnt lgkmcnt(4)
    s_cbranch_vccnz K1_ns15
    v_mfma_f32_16x16x32_bf16 a[96:99], a[24:27], v[156:159], a[96:99]
    v_mfma_f32_4x4x4_16b_bf16 a[100:103], v[156:157], v[156:157], a[100:103]
    v_mfma_f32_4x4x4_16b_bf16 a[104:107], v[158:159], v[158:159], a[104:107]
K1_ns15:
    ds_read_b64_tr_b16 a[44:45], v9 offset:15616
    ds_read_b64_tr_b16 a[46:47], v9 offset:16896
    v_mfma_f32_32x32x16_bf16 v[16:31], v[156:159], a[28:31], v[16:31]
    s_waitcnt vmcnt(13) lgkmcnt(0)
    s_barrier
    v_xor_b32 v12, 0, v11
    ds_read_b128 v[160:163], v12 offset:40960
    ds_read_b128 a[0:3], v14 offset:512
    s_add_u32 m0, s68, 143360
    s_nop 0
    buffer_load_dwordx4 v4, s[8:11], s56 offen offset:0 lds
    v_mfma_f32_32x32x16_bf16 v[32:47], v[156:159], a[32:35], v[32:47]
    ds_read_b64_tr_b16 a[4:5], v9 offset:40960
    ds_read_b64_tr_b16 a[6:7], v9 offset:42240
    buffer_load_dwordx4 v5, s[8:11], s56 offen offset:1024 lds
    v_mfma_f32_32x32x16_bf16 v[48:63], v[156:159], a[36:39], v[48:63]
    ds_read_b64_tr_b16 a[8:9], v9 offset:41024
    ds_read_b64_tr_b16 a[10:11], v9 offset:42304
    buffer_load_dwordx4 v6, s[8:11], s56 offen offset:2048 lds
    v_mfma_f32_32x32x16_bf16 v[64:79], v[156:159], a[40:43], v[64:79]
    ds_read_b64_tr_b16 a[12:13], v9 offset:41088
    ds_read_b64_tr_b16 a[14:15], v9 offset:42368
    buffer_load_dwordx4 v7, s[8:11], s56 offen offset:3072 lds
    v_mfma_f32_32x32x16_bf16 v[80:95], v[156:159], a[44:47], v[80:95]
    ds_read_b64_tr_b16 a[16:17], v9 offset:41152
    ds_read_b64_tr_b16 a[18:19], v9 offset:42432
    s_add_u32 m0, s68, 147456
    s_nop 0
    buffer_load_dwordx4 v8, s[8:11], s56 offen lds
    s_waitcnt lgkmcnt(4)
    s_cbranch_vccnz K1_ns16
    v_mfma_f32_16x16x32_bf16 a[96:99], a[0:3], v[160:163], a[96:99]
    v_mfma_f32_4x4x4_16b_bf16 a[100:103], v[160:161], v[160:161], a[100:103]
    v_mfma_f32_4x4x4_16b_bf16 a[104:107], v[162:163], v[162:163], a[104:107]
K1_ns16:
    ds_read_b64_tr_b16 a[20:21], v9 offset:41216
    ds_read_b64_tr_b16 a[22:23], v9 offset:42496
    s_add_u32 m0, s27, 20480
    s_add_u32 s29, s47, 0
    buffer_load_dwordx4 v0, s[4:7], s29 offen lds
    v_mfma_f32_32x32x16_bf16 v[16:31], v[160:163], a[4:7], v[16:31]
    v_xor_b32 v13, 32, v11
    ds_read_b128 v[164:167], v13 offset:40960
    ds_read_b128 a[24:27], v14 offset:544
    s_add_u32 m0, s27, 21504
    s_add_u32 s29, s47, 10240
    buffer_load_dwordx4 v1, s[4:7], s29 offen lds
    v_mfma_f32_32x32x16_bf16 v[32:47], v[160:163], a[8:11], v[32:47]
    ds_read_b64_tr_b16 a[28:29], v9 offset:46080
    ds_read_b64_tr_b16 a[30:31], v9 offset:47360
    s_add_u32 m0, s27, 22528
    s_add_u32 s29, s47, 20480
    buffer_load_dwordx4 v0, s[4:7], s29 offen lds
    s_waitcnt lgkmcnt(4)
    v_mfma_f32_32x32x16_bf16 v[48:63], v[160:163], a[12:15], v[48:63]
    ds_read_b64_tr_b16 a[32:33], v9 offset:46144
    ds_read_b64_tr_b16 a[34:35], v9 offset:47424
    s_add_u32 m0, s27, 23552
    s_add_u32 s29, s47, 30720
    buffer_load_dwordx4 v1, s[4:7], s29 offen lds
    v_mfma_f32_32x32x16_bf16 v[64:79], v[160:163], a[16:19], v[64:79]
    ds_read_b64_tr_b16 a[36:37], v9 offset:46208
    ds_read_b64_tr_b16 a[38:39], v9 offset:47488
    v_mfma_f32_32x32x16_bf16 v[80:95], v[160:163], a[20:23], v[80:95]
    ds_read_b64_tr_b16 a[40:41], v9 offset:46272
    ds_read_b64_tr_b16 a[42:43], v9 offset:47552
    s_waitcnt lgkmcnt(4)
    s_cbranch_vccnz K1_ns17
    v_mfma_f32_16x16x32_bf16 a[96:99], a[24:27], v[164:167], a[96:99]
    v_mfma_f32_4x4x4_16b_bf16 a[100:103], v[164:165], v[164:165], a[100:103]
    v_mfma_f32_4x4x4_16b_bf16 a[104:107], v[166:167], v[166:167], a[104:107]
K1_ns17:
    ds_read_b64_tr_b16 a[44:45], v9 offset:46336
    ds_read_b64_tr_b16 a[46:47], v9 offset:47616
    v_mfma_f32_32x32x16_bf16 v[16:31], v[164:167], a[28:31], v[16:31]
    v_xor_b32 v12, 64, v11
    ds_read_b128 v[168:171], v12 offset:40960
    ds_read_b128 a[0:3], v14 offset:576
    v_mfma_f32_32x32x16_bf16 v[32:47], v[164:167], a[32:35], v[32:47]
    ds_read_b64_tr_b16 a[4:5], v9 offset:51200
    ds_read_b64_tr_b16 a[6:7], v9 offset:52480
    s_waitcnt lgkmcnt(4)
    v_mfma_f32_32x32x16_bf16 v[48:63], v[164:167], a[36:39], v[48:63]
    ds_read_b64_tr_b16 a[8:9], v9 offset:51264
    ds_read_b64_tr_b16 a[10:11], v9 offset:52544
    v_mfma_f32_32x32x16_bf16 v[64:79], v[164:167], a[40:43], v[64:79]
    ds_read_b64_tr_b16 a[12:13], v9 offset:51328
    ds_read_b64_tr_b16 a[14:15], v9 offset:52608
    v_mfma_f32_32x32x16_bf16 v[80:95], v[164:167], a[44:47], v[80:95]
    ds_read_b64_tr_b16 a[16:17], v9 offset:51392
    ds_read_b64_tr_b16 a[18:19], v9 offset:52672
    s_waitcnt lgkmcnt(4)
    s_cbranch_vccnz K1_ns18
    v_mfma_f32_16x16x32_bf16 a[96:99], a[0:3], v[168:171], a[96:99]
    v_mfma_f32_4x4x4_16b_bf16 a[100:103], v[168:169], v[168:169], a[100:103]
    v_mfma_f32_4x4x4_16b_bf16 a[104:107], v[170:171], v[170:171], a[104:107]
K1_ns18:
    ds_read_b64_tr_b16 a[20:21], v9 offset:51456
    ds_read_b64_tr_b16 a[22:23], v9 offset:52736
    v_mfma_f32_32x32x16_bf16 v[16:31], v[168:171], a[4:7], v[16:31]
    v_xor_b32 v13, 96, v11
    ds_read_b128 v[172:175], v13 offset:40960
    ds_read_b128 a[24:27], v14 offset:608
    v_mfma_f32_32x32x16_bf16 v[32:47], v[168:171], a[8:11], v[32:47]
    ds_read_b64_tr_b16 a[28:29], v9 offset:56320
    ds_read_b64_tr_b16 a[30:31], v9 offset:57600
    s_waitcnt lgkmcnt(4)
    v_mfma_f32_32x32x16_bf16 v[48:63], v[168:171], a[12:15], v[48:63]
    ds_read_b64_tr_b16 a[32:33], v9 offset:56384
    ds_read_b64_tr_b16 a[34:35], v9 offset:57664
    v_mfma_f32_32x32x16_bf16 v[64:79], v[168:171], a[16:19], v[64:79]
    ds_read_b64_tr_b16 a[36:37], v9 offset:56448
    ds_read_b64_tr_b16 a[38:39], v9 offset:57728
    v_mfma_f32_32x32x16_bf16 v[80:95], v[168:171], a[20:23], v[80:95]
    ds_read_b64_tr_b16 a[40:41], v9 offset:56512
    ds_read_b64_tr_b16 a[42:43], v9 offset:57792
    s_waitcnt lgkmcnt(4)
    s_cbranch_vccnz K1_ns19
    v_mfma_f32_16x16x32_bf16 a[96:99], a[24:27], v[172:175], a[96:99]
    v_mfma_f32_4x4x4_16b_bf16 a[100:103], v[172:173], v[172:173], a[100:103]
    v_mfma_f32_4x4x4_16b_bf16 a[104:107], v[174:175], v[174:175], a[104:107]
K1_ns19:
    ds_read_b64_tr_b16 a[44:45], v9 offset:56576
    ds_read_b64_tr_b16 a[46:47], v9 offset:57856
    v_mfma_f32_32x32x16_bf16 v[16:31], v[172:175], a[28:31], v[16:31]
    s_waitcnt vmcnt(13) lgkmcnt(0)
    s_barrier
    v_xor_b32 v12, 65536, v11
    ds_read_b128 v[176:179], v12 offset:16384
    ds_read_b128 a[0:3], v14 offset:640
    s_add_u32 m0, s68, 40960
    s_nop 0
    buffer_load_dwordx4 v4, s[8:11], s57 offen offset:0 lds
    v_mfma_f32_32x32x16_bf16 v[32:47], v[172:175], a[32:35], v[32:47]
    v_add_u32 v9, 81920, v9
    ds_read_b64_tr_b16 a[4:5], v9 offset:0
    ds_read_b64_tr_b16 a[6:7], v9 offset:1280
    buffer_load_dwordx4 v5, s[8:11], s57 offen offset:1024 lds
    v_mfma_f32_32x32x16_bf16 v[48:63], v[172:175], a[36:39], v[48:63]
    ds_read_b64_tr_b16 a[8:9], v9 offset:64
    ds_read_b64_tr_b16 a[10:11], v9 offset:1344
    buffer_load_dwordx4 v6, s[8:11], s57 offen offset:2048 lds
    v_mfma_f32_32x32x16_bf16 v[64:79], v[172:175], a[40:43], v[64:79]
    ds_read_b64_tr_b16 a[12:13], v9 offset:128
    ds_read_b64_tr_b16 a[14:15], v9 offset:1408
    buffer_load_dwordx4 v7, s[8:11], s57 offen offset:3072 lds
    v_mfma_f32_32x32x16_bf16 v[80:95], v[172:175], a[44:47], v[80:95]
    ds_read_b64_tr_b16 a[16:17], v9 offset:192
    ds_read_b64_tr_b16 a[18:19], v9 offset:1472
    s_add_u32 m0, s68, 45056
    s_nop 0
    buffer_load_dwordx4 v8, s[8:11], s57 offen lds
    s_waitcnt lgkmcnt(4)
    s_cbranch_vccnz K1_ns20
    v_mfma_f32_16x16x32_bf16 a[96:99], a[0:3], v[176:179], a[96:99]
    v_mfma_f32_4x4x4_16b_bf16 a[100:103], v[176:177], v[176:177], a[100:103]
    v_mfma_f32_4x4x4_16b_bf16 a[104:107], v[178:179], v[178:179], a[104:107]
K1_ns20:
    ds_read_b64_tr_b16 a[20:21], v9 offset:256
    ds_read_b64_tr_b16 a[22:23], v9 offset:1536
    s_add_u32 m0, s27, 61440
    s_add_u32 s29, s48, 0
    buffer_load_dwordx4 v0, s[4:7], s29 offen lds
    v_mfma_f32_32x32x16_bf16 v[16:31], v[176:179], a[4:7], v[16:31]
    v_xor_b32 v13, 65568, v11
    ds_read_b128 v[180:183], v13 offset:16384
    ds_read_b128 a[24:27], v14 offset:672
    s_add_u32 m0, s27, 62464
    s_add_u32 s29, s48, 10240
    buffer_load_dwordx4 v1, s[4:7], s29 offen lds
    v_mfma_f32_32x32x16_bf16 v[32:47], v[176:179], a[8:11], v[32:47]
    ds_read_b64_tr_b16 a[28:29], v9 offset:5120
    ds_read_b64_tr_b16 a[30:31], v9 offset:6400
    s_add_u32 m0, s27, 63488
    s_add_u32 s29, s48, 20480
    buffer_load_dwordx4 v0, s[4:7], s29 offen lds
    s_waitcnt lgkmcnt(4)
    v_mfma_f32_32x32x16_bf16 v[48:63], v[176:179], a[12:15], v[48:63]
    ds_read_b64_tr_b16 a[32:33], v9 offset:5184
    ds_read_b64_tr_b16 a[34:35], v9 offset:6464
    s_add_u32 m0, s27, 64512
    s_add_u32 s29, s48, 30720
    buffer_load_dwordx4 v1, s[4:7], s29 offen lds
    v_mfma_f32_32x32x16_bf16 v[64:79], v[176:179], a[16:19], v[64:79]
    ds_read_b64_tr_b16 a[36:37], v9 offset:5248
    ds_read_b64_tr_b16 a[38:39], v9 offset:6528
    v_mfma_f32_32x32x16_bf16 v[80:95], v[176:179], a[20:23], v[80:95]
    ds_read_b64_tr_b16 a[40:41], v9 offset:5312
    ds_read_b64_tr_b16 a[42:43], v9 offset:6592
    s_waitcnt lgkmcnt(4)
    s_cbranch_vccnz K1_ns21
    v_mfma_f32_16x16x32_bf16 a[96:99], a[24:27], v[180:183], a[96:99]
    v_mfma_f32_4x4x4_16b_bf16 a[100:103], v[180:181], v[180:181], a[100:103]
    v_mfma_f32_4x4x4_16b_bf16 a[104:107], v[182:183], v[182:183], a[104:107]
K1_ns21:
    ds_read_b64_tr_b16 a[44:45], v9 offset:5376
    ds_read_b64_tr_b16 a[46:47], v9 offset:6656
    v_mfma_f32_32x32x16_bf16 v[16:31], v[180:183], a[28:31], v[16:31]
    v_xor_b32 v12, 65600, v11
    ds_read_b128 v[184:187], v12 offset:16384
    ds_read_b128 a[0:3], v14 offset:704
    v_mfma_f32_32x32x16_bf16 v[32:47], v[180:183], a[32:35], v[32:47]
    ds_read_b64_tr_b16 a[4:5], v9 offset:10240
    ds_read_b64_tr_b16 a[6:7], v9 offset:11520
    s_waitcnt lgkmcnt(4)
    v_mfma_f32_32x32x16_bf16 v[48:63], v[180:183], a[36:39], v[48:63]
    ds_read_b64_tr_b16 a[8:9], v9 offset:10304
    ds_read_b64_tr_b16 a[10:11], v9 offset:11584
    v_mfma_f32_32x32x16_bf16 v[64:79], v[180:183], a[40:43], v[64:79]
    ds_read_b64_tr_b16 a[12:13], v9 offset:10368
    ds_read_b64_tr_b16 a[14:15], v9 offset:11648
    v_mfma_f32_32x32x16_bf16 v[80:95], v[180:183], a[44:47], v[80:95]
    ds_read_b64_tr_b16 a[16:17], v9 offset:10432
    ds_read_b64_tr_b16 a[18:19], v9 offset:11712
    s_waitcnt lgkmcnt(4)
    s_cbranch_vccnz K1_ns22
    v_mfma_f32_16x16x32_bf16 a[96:99], a[0:3], v[184:187], a[96:99]
    v_mfma_f32_4x4x4_16b_bf16 a[100:103], v[184:185], v[184:185], a[100:103]
    v_mfma_f32_4x4x4_16b_bf16 a[104:107], v[186:187], v[186:187], a[104:107]
K1_ns22:
    ds_read_b64_tr_b16 a[20:21], v9 offset:10496
    ds_read_b64_tr_b16 a[22:23], v9 offset:11776
    v_mfma_f32_32x32x16_bf16 v[16:31], v[184:187], a[4:7], v[16:31]
    v_xor_b32 v13, 65632, v11
    ds_read_b128 v[188:191], v13 offset:16384
    ds_read_b128 a[24:27], v14 offset:736
    v_mfma_f32_32x32x16_bf16 v[32:47], v[184:187], a[8:11], v[32:47]
    ds_read_b64_tr_b16 a[28:29], v9 offset:15360
    ds_read_b64_tr_b16 a[30:31], v9 offset:16640
    s_waitcnt lgkmcnt(4)
    v_mfma_f32_32x32x16_bf16 v[48:63], v[184:187], a[12:15], v[48:63]
    ds_read_b64_tr_b16 a[32:33], v9 offset:15424
    ds_read_b64_tr_b16 a[34:35], v9 offset:16704
    v_mfma_f32_32x32x16_bf16 v[64:79], v[184:187], a[16:19], v[64:79]
    ds_read_b64_tr_b16 a[36:37], v9 offset:15488
    ds_read_b64_tr_b16 a[38:39], v9 offset:16768
    v_mfma_f32_32x32x16_bf16 v[80:95], v[184:187], a[20:23], v[80:95]
    ds_read_b64_tr_b16 a[40:41], v9 offset:15552
    ds_read_b64_tr_b16 a[42:43], v9 offset:16832
    s_waitcnt lgkmcnt(4)
    s_cbranch_vccnz K1_ns23
    v_mfma_f32_16x16x32_bf16 a[96:99], a[24:27], v[188:191], a[96:99]
    v_mfma_f32_4x4x4_16b_bf16 a[100:103], v[188:189], v[188:189], a[100:103]
    v_mfma_f32_4x4x4_16b_bf16 a[104:107], v[190:191], v[190:191], a[104:107]
K1_ns23:
    ds_read_b64_tr_b16 a[44:45], v9 offset:15616
    ds_read_b64_tr_b16 a[46:47], v9 offset:16896
    v_mfma_f32_32x32x16_bf16 v[16:31], v[188:191], a[28:31], v[16:31]
    s_waitcnt vmcnt(13) lgkmcnt(0)
    s_barrier
    v_xor_b32 v12, 65536, v11
    ds_read_b128 v[192:195], v12 offset:57344
    ds_read_b128 a[0:3], v14 offset:768
    s_add_u32 m0, s68, 81920
    s_nop 0
    buffer_load_dwordx4 v4, s[8:11], s58 offen offset:0 lds
    v_mfma_f32_32x32x16_bf16 v[32:47], v[188:191], a[32:35], v[32:47]
    ds_read_b64_tr_b16 a[4:5], v9 offset:40960
    ds_read_b64_tr_b16 a[6:7], v9 offset:42240
    buffer_load_dwordx4 v5, s[8:11], s58 offen offset:1024 lds
    v_mfma_f32_32x32x16_bf16 v[48:63], v[188:191], a[36:39], v[48:63]
    ds_read_b64_tr_b16 a[8:9], v9 offset:41024
    ds_read_b64_tr_b16 a[10:11], v9 offset:42304
    buffer_load_dwordx4 v6, s[8:11], s58 offen offset:2048 lds
    v_mfma_f32_32x32x16_bf16 v[64:79], v[188:191], a[40:43], v[64:79]
    ds_read_b64_tr_b16 a[12:13], v9 offset:41088
    ds_read_b64_tr_b16 a[14:15], v9 offset:42368
    buffer_load_dwordx4 v7, s[8:11], s58 offen offset:3072 lds
    v_mfma_f32_32x32x16_bf16 v[80:95], v[188:191], a[44:47], v[80:95]
    ds_read_b64_tr_b16 a[16:17], v9 offset:41152
    ds_read_b64_tr_b16 a[18:19], v9 offset:42432
    s_add_u32 m0, s68, 86016
    s_nop 0
    buffer_load_dwordx4 v8, s[8:11], s58 offen lds
    s_waitcnt lgkmcnt(4)
    s_cbranch_vccnz K1_ns24
    v_mfma_f32_16x16x32_bf16 a[96:99], a[0:3], v[192:195], a[96:99]
    v_mfma_f32_4x4x4_16b_bf16 a[100:103], v[192:193], v[192:193], a[100:103]
    v_mfma_f32_4x4x4_16b_bf16 a[104:107], v[194:195], v[194:195], a[104:107]
K1_ns24:
    ds_read_b64_tr_b16 a[20:21], v9 offset:41216
    ds_read_b64_tr_b16 a[22:23], v9 offset:42496
    s_add_u32 m0, s27, 102400
    s_add_u32 s29, s49, 0
    buffer_load_dwordx4 v0, s[4:7], s29 offen lds
    v_mfma_f32_32x32x16_bf16 v[16:31], v[192:195], a[4:7], v[16:31]
    v_xor_b32 v13, 65568, v11
    ds_read_b128 v[196:199], v13 offset:57344
    ds_read_b128 a[24:27], v14 offset:800
    s_add_u32 m0, s27, 103424
    s_add_u32 s29, s49, 10240
    buffer_load_dwordx4 v1, s[4:7], s29 offen lds
    v_mfma_f32_32x32x16_bf16 v[32:47], v[192:195], a[8:11], v[32:47]
    ds_read_b64_tr_b16 a[28:29], v9 offset:46080
    ds_read_b64_tr_b16 a[30:31], v9 offset:47360
    s_add_u32 m0, s27, 104448
    s_add_u32 s29, s49, 20480
    buffer_load_dwordx4 v0, s[4:7], s29 offen lds
    s_waitcnt lgkmcnt(4)
    v_mfma_f32_32x32x16_bf16 v[48:63], v[192:195], a[12:15], v[48:63]
    ds_read_b64_tr_b16 a[32:33], v9 offset:46144
    ds_read_b64_tr_b16 a[34:35], v9 offset:47424
    s_add_u32 m0, s27, 105472
    s_add_u32 s29, s49, 30720
    buffer_load_dwordx4 v1, s[4:7], s29 offen lds
    v_mfma_f32_32x32x16_bf16 v[64:79], v[192:195], a[16:19], v[64:79]
    ds_read_b64_tr_b16 a[36:37], v9 offset:46208
    ds_read_b64_tr_b16 a[38:39], v9 offset:47488
    v_mfma_f32_32x32x16_bf16 v[80:95], v[192:195], a[20:23], v[80:95]
    ds_read_b64_tr_b16 a[40:41], v9 offset:46272
    ds_read_b64_tr_b16 a[42:43], v9 offset:47552
    s_waitcnt lgkmcnt(4)
    s_cbranch_vccnz K1_ns25
    v_mfma_f32_16x16x32_bf16 a[96:99], a[24:27], v[196:199], a[96:99]
    v_mfma_f32_4x4x4_16b_bf16 a[100:103], v[196:197], v[196:197], a[100:103]
    v_mfma_f32_4x4x4_16b_bf16 a[104:107], v[198:199], v[198:199], a[104:107]
K1_ns25:
    ds_read_b64_tr_b16 a[44:45], v9 offset:46336
    ds_read_b64_tr_b16 a[46:47], v9 offset:47616
    v_mfma_f32_32x32x16_bf16 v[16:31], v[196:199], a[28:31], v[16:31]
    v_xor_b32 v12, 65600, v11
    ds_read_b128 v[200:203], v12 offset:57344
    ds_read_b128 a[0:3], v14 offset:832
    v_mfma_f32_32x32x16_bf16 v[32:47], v[196:199], a[32:35], v[32:47]
    ds_read_b64_tr_b16 a[4:5], v9 offset:51200
    ds_read_b64_tr_b16 a[6:7], v9 offset:52480
    s_waitcnt lgkmcnt(4)
    v_mfma_f32_32x32x16_bf16 v[48:63], v[196:199], a[36:39], v[48:63]
    ds_read_b64_tr_b16 a[8:9], v9 offset:51264
    ds_read_b64_tr_b16 a[10:11], v9 offset:52544
    v_mfma_f32_32x32x16_bf16 v[64:79], v[196:199], a[40:43], v[64:79]
    ds_read_b64_tr_b16 a[12:13], v9 offset:51328
    ds_read_b64_tr_b16 a[14:15], v9 offset:52608
    v_mfma_f32_32x32x16_bf16 v[80:95], v[196:199], a[44:47], v[80:95]
    ds_read_b64_tr_b16 a[16:17], v9 offset:51392
    ds_read_b64_tr_b16 a[18:19], v9 offset:52672
    s_waitcnt lgkmcnt(4)
    s_cbranch_vccnz K1_ns26
    v_mfma_f32_16x16x32_bf16 a[96:99], a[0:3], v[200:203], a[96:99]
    v_mfma_f32_4x4x4_16b_bf16 a[100:103], v[200:201], v[200:201], a[100:103]
    v_mfma_f32_4x4x4_16b_bf16 a[104:107], v[202:203], v[202:203], a[104:107]
K1_ns26:
    ds_read_b64_tr_b16 a[20:21], v9 offset:51456
    ds_read_b64_tr_b16 a[22:23], v9 offset:52736
    v_mfma_f32_32x32x16_bf16 v[16:31], v[200:203], a[4:7], v[16:31]
    v_xor_b32 v13, 65632, v11
    ds_read_b128 v[204:207], v13 offset:57344
    ds_read_b128 a[24:27], v14 offset:864
    v_mfma_f32_32x32x16_bf16 v[32:47], v[200:203], a[8:11], v[32:47]
    ds_read_b64_tr_b16 a[28:29], v9 offset:56320
    ds_read_b64_tr_b16 a[30:31], v9 offset:57600
    s_waitcnt lgkmcnt(4)
    v_mfma_f32_32x32x16_bf16 v[48:63], v[200:203], a[12:15], v[48:63]
    ds_read_b64_tr_b16 a[32:33], v9 offset:56384
    ds_read_b64_tr_b16 a[34:35], v9 offset:57664
    v_mfma_f32_32x32x16_bf16 v[64:79], v[200:203], a[16:19], v[64:79]
    ds_read_b64_tr_b16 a[36:37], v9 offset:56448
    ds_read_b64_tr_b16 a[38:39], v9 offset:57728
    v_mfma_f32_32x32x16_bf16 v[80:95], v[200:203], a[20:23], v[80:95]
    ds_read_b64_tr_b16 a[40:41], v9 offset:56512
    ds_read_b64_tr_b16 a[42:43], v9 offset:57792
    s_waitcnt lgkmcnt(4)
    s_cbranch_vccnz K1_ns27
    v_mfma_f32_16x16x32_bf16 a[96:99], a[24:27], v[204:207], a[96:99]
    v_mfma_f32_4x4x4_16b_bf16 a[100:103], v[204:205], v[204:205], a[100:103]
    v_mfma_f32_4x4x4_16b_bf16 a[104:107], v[206:207], v[206:207], a[104:107]
K1_ns27:
    ds_read_b64_tr_b16 a[44:45], v9 offset:56576
    ds_read_b64_tr_b16 a[46:47], v9 offset:57856
    v_mfma_f32_32x32x16_bf16 v[16:31], v[204:207], a[28:31], v[16:31]
    s_waitcnt vmcnt(13) lgkmcnt(0)
    s_barrier
    v_xor_b32 v12, 0, v11
    ds_read_b128 v[208:211], v12 offset:20480
    ds_read_b128 a[0:3], v14 offset:896
    s_add_u32 m0, s68, 122880
    s_nop 0
    buffer_load_dwordx4 v4, s[8:11], s59 offen offset:0 lds
    v_mfma_f32_32x32x16_bf16 v[32:47], v[204:207], a[32:35], v[32:47]
    v_add_u32 v9, 4294905856, v9
    ds_read_b64_tr_b16 a[4:5], v9 offset:0
    ds_read_b64_tr_b16 a[6:7], v9 offset:1280
    buffer_load_dwordx4 v5, s[8:11], s59 offen offset:1024 lds
    v_mfma_f32_32x32x16_bf16 v[48:63], v[204:207], a[36:39], v[48:63]
    ds_read_b64_tr_b16 a[8:9], v9 offset:64
    ds_read_b64_tr_b16 a[10:11], v9 offset:1344
    buffer_load_dwordx4 v6, s[8:11], s59 offen offset:2048 lds
    v_mfma_f32_32x32x16_bf16 v[64:79], v[204:207], a[40:43], v[64:79]
    ds_read_b64_tr_b16 a[12:13], v9 offset:128
    ds_read_b64_tr_b16 a[14:15], v9 offset:1408
    buffer_load_dwordx4 v7, s[8:11], s59 offen offset:3072 lds
    v_mfma_f32_32x32x16_bf16 v[80:95], v[204:207], a[44:47], v[80:95]
    ds_read_b64_tr_b16 a[16:17], v9 offset:192
    ds_read_b64_tr_b16 a[18:19], v9 offset:1472
    s_add_u32 m0, s68, 126976
    s_nop 0
    buffer_load_dwordx4 v8, s[8:11], s59 offen lds
    s_waitcnt lgkmcnt(4)
    s_cbranch_vccnz K1_ns28
    v_mfma_f32_16x16x32_bf16 a[96:99], a[0:3], v[208:211], a[96:99]
    v_mfma_f32_4x4x4_16b_bf16 a[100:103], v[208:209], v[208:209], a[100:103]
    v_mfma_f32_4x4x4_16b_bf16 a[104:107], v[210:211], v[210:211], a[104:107]
K1_ns28:
    ds_read_b64_tr_b16 a[20:21], v9 offset:256
    ds_read_b64_tr_b16 a[22:23], v9 offset:1536
    v_accvgpr_read_b32 v4, a112
    v_accvgpr_read_b32 v5, a113
    v_accvgpr_read_b32 v6, a114
    v_accvgpr_read_b32 v7, a115
    s_add_u32 m0, s27, 143360
    s_add_u32 s30, s60, s32
    buffer_load_dwordx4 v4, s[12:15], s30 offen offset:0 lds
    v_mfma_f32_32x32x16_bf16 v[16:31], v[208:211], a[4:7], v[16:31]
    v_xor_b32 v13, 32, v11
    ds_read_b128 v[212:215], v13 offset:20480
    ds_read_b128 a[24:27], v14 offset:928
    buffer_load_dwordx4 v5, s[12:15], s30 offen offset:1024 lds
    v_mfma_f32_32x32x16_bf16 v[32:47], v[208:211], a[8:11], v[32:47]
    ds_read_b64_tr_b16 a[28:29], v9 offset:5120
    ds_read_b64_tr_b16 a[30:31], v9 offset:6400
    buffer_load_dwordx4 v6, s[12:15], s30 offen offset:2048 lds
    s_waitcnt lgkmcnt(4)
    v_mfma_f32_32x32x16_bf16 v[48:63], v[208:211], a[12:15], v[48:63]
    ds_read_b64_tr_b16 a[32:33], v9 offset:5184
    ds_read_b64_tr_b16 a[34:35], v9 offset:6464
    buffer_load_dwordx4 v7, s[12:15], s30 offen offset:3072 lds
    v_mfma_f32_32x32x16_bf16 v[64:79], v[208:211], a[16:19], v[64:79]
    ds_read_b64_tr_b16 a[36:37], v9 offset:5248
    ds_read_b64_tr_b16 a[38:39], v9 offset:6528
    v_mfma_f32_32x32x16_bf16 v[80:95], v[208:211], a[20:23], v[80:95]
    ds_read_b64_tr_b16 a[40:41], v9 offset:5312
    ds_read_b64_tr_b16 a[42:43], v9 offset:6592
    s_waitcnt lgkmcnt(4)
    s_cbranch_vccnz K1_ns29
    v_mfma_f32_16x16x32_bf16 a[96:99], a[24:27], v[212:215], a[96:99]
    v_mfma_f32_4x4x4_16b_bf16 a[100:103], v[212:213], v[212:213], a[100:103]
    v_mfma_f32_4x4x4_16b_bf16 a[104:107], v[214:215], v[214:215], a[104:107]
K1_ns29:
    ds_read_b64_tr_b16 a[44:45], v9 offset:5376
    ds_read_b64_tr_b16 a[46:47], v9 offset:6656
    v_mfma_f32_32x32x16_bf16 v[16:31], v[212:215], a[28:31], v[16:31]
    v_xor_b32 v12, 64, v11
    ds_read_b128 v[216:219], v12 offset:20480
    ds_read_b128 a[0:3], v14 offset:960
    v_mfma_f32_32x32x16_bf16 v[32:47], v[212:215], a[32:35], v[32:47]
    ds_read_b64_tr_b16 a[4:5], v9 offset:10240
    ds_read_b64_tr_b16 a[6:7], v9 offset:11520
    s_waitcnt lgkmcnt(4)
    v_mfma_f32_32x32x16_bf16 v[48:63], v[212:215], a[36:39], v[48:63]
    ds_read_b64_tr_b16 a[8:9], v9 offset:10304
    ds_read_b64_tr_b16 a[10:11], v9 offset:11584
    v_mfma_f32_32x32x16_bf16 v[64:79], v[212:215], a[40:43], v[64:79]
    ds_read_b64_tr_b16 a[12:13], v9 offset:10368
    ds_read_b64_tr_b16 a[14:15], v9 offset:11648
    v_mfma_f32_32x32x16_bf16 v[80:95], v[212:215], a[44:47], v[80:95]
    ds_read_b64_tr_b16 a[16:17], v9 offset:10432
    ds_read_b64_tr_b16 a[18:19], v9 offset:11712
    s_waitcnt lgkmcnt(4)
    s_cbranch_vccnz K1_ns30
    v_mfma_f32_16x16x32_bf16 a[96:99], a[0:3], v[216:219], a[96:99]
    v_mfma_f32_4x4x4_16b_bf16 a[100:103], v[216:217], v[216:217], a[100:103]
    v_mfma_f32_4x4x4_16b_bf16 a[104:107], v[218:219], v[218:219], a[104:107]
K1_ns30:
    ds_read_b64_tr_b16 a[20:21], v9 offset:10496
    ds_read_b64_tr_b16 a[22:23], v9 offset:11776
    v_mfma_f32_32x32x16_bf16 v[16:31], v[216:219], a[4:7], v[16:31]
    v_xor_b32 v13, 96, v11
    ds_read_b128 v[220:223], v13 offset:20480
    ds_read_b128 a[24:27], v14 offset:992
    v_mfma_f32_32x32x16_bf16 v[32:47], v[216:219], a[8:11], v[32:47]
    ds_read_b64_tr_b16 a[28:29], v9 offset:15360
    ds_read_b64_tr_b16 a[30:31], v9 offset:16640
    s_waitcnt lgkmcnt(4)
    v_mfma_f32_32x32x16_bf16 v[48:63], v[216:219], a[12:15], v[48:63]
    ds_read_b64_tr_b16 a[32:33], v9 offset:15424
    ds_read_b64_tr_b16 a[34:35], v9 offset:16704
    v_mfma_f32_32x32x16_bf16 v[64:79], v[216:219], a[16:19], v[64:79]
    ds_read_b64_tr_b16 a[36:37], v9 offset:15488
    ds_read_b64_tr_b16 a[38:39], v9 offset:16768
    v_mfma_f32_32x32x16_bf16 v[80:95], v[216:219], a[20:23], v[80:95]
    ds_read_b64_tr_b16 a[40:41], v9 offset:15552
    ds_read_b64_tr_b16 a[42:43], v9 offset:16832
    s_waitcnt lgkmcnt(4)
    s_cbranch_vccnz K1_ns31
    v_mfma_f32_16x16x32_bf16 a[96:99], a[24:27], v[220:223], a[96:99]
    v_mfma_f32_4x4x4_16b_bf16 a[100:103], v[220:221], v[220:221], a[100:103]
    v_mfma_f32_4x4x4_16b_bf16 a[104:107], v[222:223], v[222:223], a[104:107]
K1_ns31:
    ds_read_b64_tr_b16 a[44:45], v9 offset:15616
    ds_read_b64_tr_b16 a[46:47], v9 offset:16896
    v_mfma_f32_32x32x16_bf16 v[16:31], v[220:223], a[28:31], v[16:31]
    s_waitcnt vmcnt(13) lgkmcnt(0)
    s_barrier
    v_xor_b32 v12, 0, v11
    ds_read_b128 v[224:227], v12 offset:61440
    ds_read_b128 a[0:3], v14 offset:1024
    s_add_u32 m0, s27, 20480
    s_add_u32 s30, s61, s32
    buffer_load_dwordx4 v4, s[12:15], s30 offen offset:0 lds
    v_mfma_f32_32x32x16_bf16 v[32:47], v[220:223], a[32:35], v[32:47]
    ds_read_b64_tr_b16 a[4:5], v9 offset:40960
    ds_read_b64_tr_b16 a[6:7], v9 offset:42240
    buffer_load_dwordx4 v5, s[12:15], s30 offen offset:1024 lds
    v_mfma_f32_32x32x16_bf16 v[48:63], v[220:223], a[36:39], v[48:63]
    ds_read_b64_tr_b16 a[8:9], v9 offset:41024
    ds_read_b64_tr_b16 a[10:11], v9 offset:42304
    buffer_load_dwordx4 v6, s[12:15], s30 offen offset:2048 lds
    v_mfma_f32_32x32x16_bf16 v[64:79], v[220:223], a[40:43], v[64:79]
    ds_read_b64_tr_b16 a[12:13], v9 offset:41088
    ds_read_b64_tr_b16 a[14:15], v9 offset:42368
    buffer_load_dwordx4 v7, s[12:15], s30 offen offset:3072 lds
    v_mfma_f32_32x32x16_bf16 v[80:95], v[220:223], a[44:47], v[80:95]
    ds_read_b64_tr_b16 a[16:17], v9 offset:41152
    ds_read_b64_tr_b16 a[18:19], v9 offset:42432
    s_add_u32 m0, s27, 40960
    s_add_u32 s30, s62, s32
    buffer_load_dwordx4 v4, s[12:15], s30 offen offset:0 lds
    s_waitcnt lgkmcnt(4)
    s_cbranch_vccnz K1_ns32
    v_mfma_f32_16x16x32_bf16 a[96:99], a[0:3], v[224:227], a[96:99]
    v_mfma_f32_4x4x4_16b_bf16 a[100:103], v[224:225], v[224:225], a[100:103]
    v_mfma_f32_4x4x4_16b_bf16 a[104:107], v[226:227], v[226:227], a[104:107]
K1_ns32:
    ds_read_b64_tr_b16 a[20:21], v9 offset:41216
    ds_read_b64_tr_b16 a[22:23], v9 offset:42496
    buffer_load_dwordx4 v5, s[12:15], s30 offen offset:1024 lds
    v_mfma_f32_32x32x16_bf16 v[16:31], v[224:227], a[4:7], v[16:31]
    v_xor_b32 v13, 32, v11
    ds_read_b128 v[228:231], v13 offset:61440
    ds_read_b128 a[24:27], v14 offset:1056
    buffer_load_dwordx4 v6, s[12:15], s30 offen offset:2048 lds
    v_mfma_f32_32x32x16_bf16 v[32:47], v[224:227], a[8:11], v[32:47]
    ds_read_b64_tr_b16 a[28:29], v9 offset:46080
    ds_read_b64_tr_b16 a[30:31], v9 offset:47360
    buffer_load_dwordx4 v7, s[12:15], s30 offen offset:3072 lds
    s_waitcnt lgkmcnt(4)
    v_mfma_f32_32x32x16_bf16 v[48:63], v[224:227], a[12:15], v[48:63]
    ds_read_b64_tr_b16 a[32:33], v9 offset:46144
    ds_read_b64_tr_b16 a[34:35], v9 offset:47424
    v_mfma_f32_32x32x16_bf16 v[64:79], v[224:227], a[16:19], v[64:79]
    ds_read_b64_tr_b16 a[36:37], v9 offset:46208
    ds_read_b64_tr_b16 a[38:39], v9 offset:47488
    v_mfma_f32_32x32x16_bf16 v[80:95], v[224:227], a[20:23], v[80:95]
    ds_read_b64_tr_b16 a[40:41], v9 offset:46272
    ds_read_b64_tr_b16 a[42:43], v9 offset:47552
    s_waitcnt lgkmcnt(4)
    s_cbranch_vccnz K1_ns33
    v_mfma_f32_16x16x32_bf16 a[96:99], a[24:27], v[228:231], a[96:99]
    v_mfma_f32_4x4x4_16b_bf16 a[100:103], v[228:229], v[228:229], a[100:103]
    v_mfma_f32_4x4x4_16b_bf16 a[104:107], v[230:231], v[230:231], a[104:107]
K1_ns33:
    ds_read_b64_tr_b16 a[44:45], v9 offset:46336
    ds_read_b64_tr_b16 a[46:47], v9 offset:47616
    v_mfma_f32_32x32x16_bf16 v[16:31], v[228:231], a[28:31], v[16:31]
    v_xor_b32 v12, 64, v11
    ds_read_b128 v[232:235], v12 offset:61440
    ds_read_b128 a[0:3], v14 offset:1088
    v_mfma_f32_32x32x16_bf16 v[32:47], v[228:231], a[32:35], v[32:47]
    ds_read_b64_tr_b16 a[4:5], v9 offset:51200
    ds_read_b64_tr_b16 a[6:7], v9 offset:52480
    s_waitcnt lgkmcnt(4)
    v_mfma_f32_32x32x16_bf16 v[48:63], v[228:231], a[36:39], v[48:63]
    ds_read_b64_tr_b16 a[8:9], v9 offset:51264
    ds_read_b64_tr_b16 a[10:11], v9 offset:52544
    v_mfma_f32_32x32x16_bf16 v[64:79], v[228:231], a[40:43], v[64:79]
    ds_read_b64_tr_b16 a[12:13], v9 offset:51328
    ds_read_b64_tr_b16 a[14:15], v9 offset:52608
    v_mfma_f32_32x32x16_bf16 v[80:95], v[228:231], a[44:47], v[80:95]
    ds_read_b64_tr_b16 a[16:17], v9 offset:51392
    ds_read_b64_tr_b16 a[18:19], v9 offset:52672
    s_waitcnt lgkmcnt(4)
    s_cbranch_vccnz K1_ns34
    v_mfma_f32_16x16x32_bf16 a[96:99], a[0:3], v[232:235], a[96:99]
    v_mfma_f32_4x4x4_16b_bf16 a[100:103], v[232:233], v[232:233], a[100:103]
    v_mfma_f32_4x4x4_16b_bf16 a[104:107], v[234:235], v[234:235], a[104:107]
K1_ns34:
    ds_read_b64_tr_b16 a[20:21], v9 offset:51456
    ds_read_b64_tr_b16 a[22:23], v9 offset:52736
    v_mfma_f32_32x32x16_bf16 v[16:31], v[232:235], a[4:7], v[16:31]
    v_xor_b32 v13, 96, v11
    ds_read_b128 v[236:239], v13 offset:61440
    ds_read_b128 a[24:27], v14 offset:1120
    v_mfma_f32_32x32x16_bf16 v[32:47], v[232:235], a[8:11], v[32:47]
    ds_read_b64_tr_b16 a[28:29], v9 offset:56320
    ds_read_b64_tr_b16 a[30:31], v9 offset:57600
    s_waitcnt lgkmcnt(4)
    v_mfma_f32_32x32x16_bf16 v[48:63], v[232:235], a[12:15], v[48:63]
    ds_read_b64_tr_b16 a[32:33], v9 offset:56384
    ds_read_b64_tr_b16 a[34:35], v9 offset:57664
    v_mfma_f32_32x32x16_bf16 v[64:79], v[232:235], a[16:19], v[64:79]
    ds_read_b64_tr_b16 a[36:37], v9 offset:56448
    ds_read_b64_tr_b16 a[38:39], v9 offset:57728
    v_mfma_f32_32x32x16_bf16 v[80:95], v[232:235], a[20:23], v[80:95]
    ds_read_b64_tr_b16 a[40:41], v9 offset:56512
    ds_read_b64_tr_b16 a[42:43], v9 offset:57792
    s_waitcnt lgkmcnt(4)
    s_cbranch_vccnz K1_ns35
    v_mfma_f32_16x16x32_bf16 a[96:99], a[24:27], v[236:239], a[96:99]
    v_mfma_f32_4x4x4_16b_bf16 a[100:103], v[236:237], v[236:237], a[100:103]
    v_mfma_f32_4x4x4_16b_bf16 a[104:107], v[238:239], v[238:239], a[104:107]
K1_ns35:
    ds_read_b64_tr_b16 a[44:45], v9 offset:56576
    ds_read_b64_tr_b16 a[46:47], v9 offset:57856
    v_mfma_f32_32x32x16_bf16 v[16:31], v[236:239], a[28:31], v[16:31]
    s_waitcnt vmcnt(12) lgkmcnt(0)
    s_barrier
    v_xor_b32 v12, 65536, v11
    ds_read_b128 v[240:243], v12 offset:36864
    ds_read_b128 a[0:3], v14 offset:1152
    s_add_u32 m0, s27, 61440
    s_add_u32 s30, s63, s32
    buffer_load_dwordx4 v4, s[12:15], s30 offen offset:0 lds
    v_mfma_f32_32x32x16_bf16 v[32:47], v[236:239], a[32:35], v[32:47]
    v_add_u32 v9, 81920, v9
    ds_read_b64_tr_b16 a[4:5], v9 offset:0
    ds_read_b64_tr_b16 a[6:7], v9 offset:1280
    buffer_load_dwordx4 v5, s[12:15], s30 offen offset:1024 lds
    v_mfma_f32_32x32x16_bf16 v[48:63], v[236:239], a[36:39], v[48:63]
    ds_read_b64_tr_b16 a[8:9], v9 offset:64
    ds_read_b64_tr_b16 a[10:11], v9 offset:1344
    buffer_load_dwordx4 v6, s[12:15], s30 offen offset:2048 lds
    v_mfma_f32_32x32x16_bf16 v[64:79], v[236:239], a[40:43], v[64:79]
    ds_read_b64_tr_b16 a[12:13], v9 offset:128
    ds_read_b64_tr_b16 a[14:15], v9 offset:1408
    buffer_load_dwordx4 v7, s[12:15], s30 offen offset:3072 lds
    v_mfma_f32_32x32x16_bf16 v[80:95], v[236:239], a[44:47], v[80:95]
    ds_read_b64_tr_b16 a[16:17], v9 offset:192
    ds_read_b64_tr_b16 a[18:19], v9 offset:1472
    s_waitcnt lgkmcnt(4)
    s_cbranch_vccnz K1_ns36
    v_mfma_f32_16x16x32_bf16 a[96:99], a[0:3], v[240:243], a[96:99]
    v_mfma_f32_4x4x4_16b_bf16 a[100:103], v[240:241], v[240:241], a[100:103]
    v_mfma_f32_4x4x4_16b_bf16 a[104:107], v[242:243], v[242:243], a[104:107]
K1_ns36:
    ds_read_b64_tr_b16 a[20:21], v9 offset:256
    ds_read_b64_tr_b16 a[22:23], v9 offset:1536
    v_mfma_f32_32x32x16_bf16 v[16:31], v[240:243], a[4:7], v[16:31]
    v_xor_b32 v13, 65568, v11
    ds_read_b128 v[244:247], v13 offset:36864
    ds_read_b128 a[24:27], v14 offset:1184
    v_mfma_f32_32x32x16_bf16 v[32:47], v[240:243], a[8:11], v[32:47]
    ds_read_b64_tr_b16 a[28:29], v9 offset:5120
    ds_read_b64_tr_b16 a[30:31], v9 offset:6400
    s_waitcnt lgkmcnt(4)
    v_mfma_f32_32x32x16_bf16 v[48:63], v[240:243], a[12:15], v[48:63]
    ds_read_b64_tr_b16 a[32:33], v9 offset:5184
    ds_read_b64_tr_b16 a[34:35], v9 offset:6464
    v_mfma_f32_32x32x16_bf16 v[64:79], v[240:243], a[16:19], v[64:79]
    ds_read_b64_tr_b16 a[36:37], v9 offset:5248
    ds_read_b64_tr_b16 a[38:39], v9 offset:6528
    v_mfma_f32_32x32x16_bf16 v[80:95], v[240:243], a[20:23], v[80:95]
    ds_read_b64_tr_b16 a[40:41], v9 offset:5312
    ds_read_b64_tr_b16 a[42:43], v9 offset:6592
    s_waitcnt lgkmcnt(4)
    s_cbranch_vccnz K1_ns37
    v_mfma_f32_16x16x32_bf16 a[96:99], a[24:27], v[244:247], a[96:99]
    v_mfma_f32_4x4x4_16b_bf16 a[100:103], v[244:245], v[244:245], a[100:103]
    v_mfma_f32_4x4x4_16b_bf16 a[104:107], v[246:247], v[246:247], a[104:107]
K1_ns37:
    ds_read_b64_tr_b16 a[44:45], v9 offset:5376
    ds_read_b64_tr_b16 a[46:47], v9 offset:6656
    v_mfma_f32_32x32x16_bf16 v[16:31], v[244:247], a[28:31], v[16:31]
    v_xor_b32 v12, 65600, v11
    ds_read_b128 v[248:251], v12 offset:36864
    ds_read_b128 a[0:3], v14 offset:1216
    v_mfma_f32_32x32x16_bf16 v[32:47], v[244:247], a[32:35], v[32:47]
    ds_read_b64_tr_b16 a[4:5], v9 offset:10240
    ds_read_b64_tr_b16 a[6:7], v9 offset:11520
    s_waitcnt lgkmcnt(4)
    v_mfma_f32_32x32x16_bf16 v[48:63], v[244:247], a[36:39], v[48:63]
    ds_read_b64_tr_b16 a[8:9], v9 offset:10304
    ds_read_b64_tr_b16 a[10:11], v9 offset:11584
    v_mfma_f32_32x32x16_bf16 v[64:79], v[244:247], a[40:43], v[64:79]
    ds_read_b64_tr_b16 a[12:13], v9 offset:10368
    ds_read_b64_tr_b16 a[14:15], v9 offset:11648
    v_mfma_f32_32x32x16_bf16 v[80:95], v[244:247], a[44:47], v[80:95]
    ds_read_b64_tr_b16 a[16:17], v9 offset:10432
    ds_read_b64_tr_b16 a[18:19], v9 offset:11712
    s_waitcnt lgkmcnt(4)
    s_cbranch_vccnz K1_ns38
    v_mfma_f32_16x16x32_bf16 a[96:99], a[0:3], v[248:251], a[96:99]
    v_mfma_f32_4x4x4_16b_bf16 a[100:103], v[248:249], v[248:249], a[100:103]
    v_mfma_f32_4x4x4_16b_bf16 a[104:107], v[250:251], v[250:251], a[104:107]
K1_ns38:
    ds_read_b64_tr_b16 a[20:21], v9 offset:10496
    ds_read_b64_tr_b16 a[22:23], v9 offset:11776
    v_mfma_f32_32x32x16_bf16 v[16:31], v[248:251], a[4:7], v[16:31]
    v_xor_b32 v13, 65632, v11
    ds_read_b128 v[252:255], v13 offset:36864
    ds_read_b128 a[24:27], v14 offset:1248
    v_mfma_f32_32x32x16_bf16 v[32:47], v[248:251], a[8:11], v[32:47]
    ds_read_b64_tr_b16 a[28:29], v9 offset:15360
    ds_read_b64_tr_b16 a[30:31], v9 offset:16640
    s_waitcnt lgkmcnt(4)
    v_mfma_f32_32x32x16_bf16 v[48:63], v[248:251], a[12:15], v[48:63]
    ds_read_b64_tr_b16 a[32:33], v9 offset:15424
    ds_read_b64_tr_b16 a[34:35], v9 offset:16704
    v_mfma_f32_32x32x16_bf16 v[64:79], v[248:251], a[16:19], v[64:79]
    ds_read_b64_tr_b16 a[36:37], v9 offset:15488
    ds_read_b64_tr_b16 a[38:39], v9 offset:16768
    v_mfma_f32_32x32x16_bf16 v[80:95], v[248:251], a[20:23], v[80:95]
    ds_read_b64_tr_b16 a[40:41], v9 offset:15552
    ds_read_b64_tr_b16 a[42:43], v9 offset:16832
    s_waitcnt lgkmcnt(4)
    s_cbranch_vccnz K1_ns39
    v_mfma_f32_16x16x32_bf16 a[96:99], a[24:27], v[252:255], a[96:99]
    v_mfma_f32_4x4x4_16b_bf16 a[100:103], v[252:253], v[252:253], a[100:103]
    v_mfma_f32_4x4x4_16b_bf16 a[104:107], v[254:255], v[254:255], a[104:107]
K1_ns39:
    ds_read_b64_tr_b16 a[44:45], v9 offset:15616
    ds_read_b64_tr_b16 a[46:47], v9 offset:16896
    v_mfma_f32_32x32x16_bf16 v[16:31], v[252:255], a[28:31], v[16:31]
    v_mfma_f32_32x32x16_bf16 v[32:47], v[252:255], a[32:35], v[32:47]
    s_waitcnt lgkmcnt(0)
    v_mfma_f32_32x32x16_bf16 v[48:63], v[252:255], a[36:39], v[48:63]
    v_mfma_f32_32x32x16_bf16 v[64:79], v[252:255], a[40:43], v[64:79]
    v_mfma_f32_32x32x16_bf16 v[80:95], v[252:255], a[44:47], v[80:95]
    buffer_load_dwordx4 a[244:247], off, s[96:99], 0 sc1
    s_barrier
    s_add_u32 m0, s27, 126976
    s_add_u32 s30, s64, s32
    buffer_load_dwordx4 v4, s[12:15], s30 offen offset:0 lds
    buffer_load_dwordx4 v5, s[12:15], s30 offen offset:1024 lds
    buffer_load_dwordx4 v6, s[12:15], s30 offen offset:2048 lds
    buffer_load_dwordx4 v7, s[12:15], s30 offen offset:3072 lds
    v_and_b32 v9, 31, v3
    v_lshrrev_b32 v10, 5, v3
    v_cmp_lt_u32 vcc, 15, v9
    v_mul_u32_u24 v0, 272, v9
    v_lshl_add_u32 v0, v10, 4, v0
    s_lshl_b32 s71, s24, 6
    s_add_u32 s71, s71, 81920
    v_add_u32 v8, s71, v0
    s_nop 3
    s_cmp_ge_u32 s72, 2
    s_cbranch_scc1 K1_CD
    v_accvgpr_write_b32 a80, 0
    v_accvgpr_write_b32 a64, 0
    v_accvgpr_write_b32 a66, 0
    v_mbcnt_lo_u32_b32 v12, -1, 0
    v_mbcnt_hi_u32_b32 v12, -1, v12
    v_bfe_u32 v13, v12, 2, 2
    v_lshrrev_b32 v9, 5, v12
    v_lshl_add_u32 v9, v9, 3, v13
    v_lshlrev_b32 v9, 7, v9
    v_bfe_u32 v13, v12, 3, 1
    v_lshl_add_u32 v9, v13, 6, v9
    v_bfe_u32 v13, v12, 4, 1
    v_lshl_add_u32 v9, v13, 5, v9
    v_and_b32 v13, 3, v12
    v_lshl_add_u32 v9, v13, 3, v9
    v_xor_b32 v10, 64, v9
    s_waitcnt vmcnt(17)
    s_barrier
    v_add_u32 v9, 143360, v9
    ds_read_b64_tr_b16 a[0:1], v9 offset:0
    ds_read_b64_tr_b16 a[2:3], v9 offset:512
    v_add_u32 v10, 143360, v10
    ds_read_b64_tr_b16 a[4:5], v10 offset:0
    ds_read_b64_tr_b16 a[6:7], v10 offset:512
    ds_read_b64_tr_b16 a[8:9], v9 offset:2048
    ds_read_b64_tr_b16 a[10:11], v9 offset:2560
    ds_read_b64_tr_b16 a[12:13], v10 offset:2048
    ds_read_b64_tr_b16 a[14:15], v10 offset:2560
    ds_read_b64_tr_b16 a[16:17], v9 offset:4096
    ds_read_b64_tr_b16 a[18:19], v9 offset:4608
    s_waitcnt lgkmcnt(6)
    v_mfma_f32_32x32x16_bf16 a[128:143], a[64:67], a[80:83], 0
    ds_read_b64_tr_b16 a[20:21], v10 offset:4096
    ds_read_b64_tr_b16 a[22:23], v10 offset:4608
    v_mfma_f32_32x32x16_bf16 a[144:159], a[66:69], a[80:83], 0
    ds_read_b64_tr_b16 a[24:25], v9 offset:6144
    ds_read_b64_tr_b16 a[26:27], v9 offset:6656
    v_mfma_f32_32x32x16_bf16 a[128:143], a[0:3], v[96:99], a[128:143]
    ds_read_b64_tr_b16 a[28:29], v10 offset:6144
    ds_read_b64_tr_b16 a[30:31], v10 offset:6656
    v_mul_f32_e64 v11, v16, s66
    v_mul_f32_e64 v12, v17, s66
    v_mul_f32_e64 v13, v18, s66
    v_mul_f32_e64 v14, v19, s66
    v_mfma_f32_32x32x16_bf16 a[144:159], a[4:7], v[96:99], a[144:159]
    ds_read_b64_tr_b16 a[32:33], v9 offset:8192
    ds_read_b64_tr_b16 a[34:35], v9 offset:8704
    v_exp_f32_e64 v11, v11 clamp
    v_exp_f32_e64 v12, v12 clamp
    v_exp_f32_e64 v13, v13 clamp
    v_exp_f32_e64 v14, v14 clamp
    s_waitcnt lgkmcnt(6)
    v_mfma_f32_32x32x16_bf16 a[128:143], a[8:11], v[100:103], a[128:143]
    ds_read_b64_tr_b16 a[36:37], v10 offset:8192
    ds_read_b64_tr_b16 a[38:39], v10 offset:8704
    v_max_f32_e64 v16, v16, 0
    v_max_f32_e64 v17, v17, 0
    v_max_f32_e64 v18, v18, 0
    v_max_f32_e64 v19, v19, 0
    v_mfma_f32_32x32x16_bf16 a[144:159], a[12:15], v[100:103], a[144:159]
    ds_read_b64_tr_b16 a[40:41], v9 offset:10240
    ds_read_b64_tr_b16 a[42:43], v9 offset:10752
    v_add_f32_e64 v11, v11, s67
    v_add_f32_e64 v12, v12, s67
    v_add_f32_e64 v13, v13, s67
    v_add_f32_e64 v14, v14, s67
    v_mfma_f32_32x32x16_bf16 a[128:143], a[16:19], v[104:107], a[128:143]
    ds_read_b64_tr_b16 a[44:45], v10 offset:10240
    ds_read_b64_tr_b16 a[46:47], v10 offset:10752
    v_add_f32_e64 v16, v16, v11
    v_add_f32_e64 v17, v17, v12
    v_add_f32_e64 v18, v18, v13
    v_add_f32_e64 v19, v19, v14
    v_mfma_f32_32x32x16_bf16 a[144:159], a[20:23], v[104:107], a[144:159]
    ds_read_b64_tr_b16 a[0:1], v9 offset:12288
    ds_read_b64_tr_b16 a[2:3], v9 offset:12800
    v_cvt_pk_bf16_f32 v16, v16, v17
    v_cvt_pk_bf16_f32 v17, v18, v19
    v_mul_f32_e64 v11, v20, s66
    v_mul_f32_e64 v12, v21, s66
    s_waitcnt lgkmcnt(6)
    v_mfma_f32_32x32x16_bf16 a[128:143], a[24:27], v[108:111], a[128:143]
    ds_read_b64_tr_b16 a[4:5], v10 offset:12288
    ds_read_b64_tr_b16 a[6:7], v10 offset:12800
    v_mul_f32_e64 v13, v22, s66
    v_mul_f32_e64 v14, v23, s66
    v_exp_f32_e64 v11, v11 clamp
    v_exp_f32_e64 v12, v12 clamp
    v_mfma_f32_32x32x16_bf16 a[144:159], a[28:31], v[108:111], a[144:159]
    ds_read_b64_tr_b16 a[8:9], v9 offset:14336
    ds_read_b64_tr_b16 a[10:11], v9 offset:14848
    v_exp_f32_e64 v13, v13 clamp
    v_exp_f32_e64 v14, v14 clamp
    v_max_f32_e64 v20, v20, 0
    v_max_f32_e64 v21, v21, 0
    v_mfma_f32_32x32x16_bf16 a[128:143], a[32:35], v[112:115], a[128:143]
    ds_read_b64_tr_b16 a[12:13], v10 offset:14336
    ds_read_b64_tr_b16 a[14:15], v10 offset:14848
    v_max_f32_e64 v22, v22, 0
    v_max_f32_e64 v23, v23, 0
    v_add_f32_e64 v11, v11, s67
    v_add_f32_e64 v12, v12, s67
    v_mfma_f32_32x32x16_bf16 a[144:159], a[36:39], v[112:115], a[144:159]
    s_waitcnt vmcnt(13)
    s_barrier
    v_add_u32 v9, 4294844416, v9
    ds_read_b64_tr_b16 a[16:17], v9 offset:0
    ds_read_b64_tr_b16 a[18:19], v9 offset:512
    v_add_f32_e64 v13, v13, s67
    v_add_f32_e64 v14, v14, s67
    v_add_f32_e64 v20, v20, v11
    v_add_f32_e64 v21, v21, v12
    s_waitcnt lgkmcnt(6)
    v_mfma_f32_32x32x16_bf16 a[128:143], a[40:43], v[116:119], a[128:143]
    v_add_u32 v10, 4294844416, v10
    ds_read_b64_tr_b16 a[20:21], v10 offset:0
    ds_read_b64_tr_b16 a[22:23], v10 offset:512
    v_add_f32_e64 v22, v22, v13
    v_add_f32_e64 v23, v23, v14
    v_cvt_pk_bf16_f32 v18, v20, v21
    v_cvt_pk_bf16_f32 v19, v22, v23
    v_mfma_f32_32x32x16_bf16 a[144:159], a[44:47], v[116:119], a[144:159]
    ds_read_b64_tr_b16 a[24:25], v9 offset:2048
    ds_read_b64_tr_b16 a[26:27], v9 offset:2560
    ds_write_b128 v8, v[16:19] offset:0
    v_mul_f32_e64 v11, v24, s66
    v_mul_f32_e64 v12, v25, s66
    v_mul_f32_e64 v13, v26, s66
    v_mfma_f32_32x32x16_bf16 a[128:143], a[0:3], v[120:123], a[128:143]
    ds_read_b64_tr_b16 a[28:29], v10 offset:2048
    ds_read_b64_tr_b16 a[30:31], v10 offset:2560
    v_mul_f32_e64 v14, v27, s66
    v_exp_f32_e64 v11, v11 clamp
    v_exp_f32_e64 v12, v12 clamp
    v_exp_f32_e64 v13, v13 clamp
    v_mfma_f32_32x32x16_bf16 a[144:159], a[4:7], v[120:123], a[144:159]
    ds_read_b64_tr_b16 a[32:33], v9 offset:4096
    ds_read_b64_tr_b16 a[34:35], v9 offset:4608
    v_exp_f32_e64 v14, v14 clamp
    v_max_f32_e64 v24, v24, 0
    v_max_f32_e64 v25, v25, 0
    v_max_f32_e64 v26, v26, 0
    s_waitcnt lgkmcnt(7)
    v_mfma_f32_32x32x16_bf16 a[128:143], a[8:11], v[124:127], a[128:143]
    ds_read_b64_tr_b16 a[36:37], v10 offset:4096
    ds_read_b64_tr_b16 a[38:39], v10 offset:4608
    v_max_f32_e64 v27, v27, 0
    v_add_f32_e64 v11, v11, s67
    v_add_f32_e64 v12, v12, s67
    v_add_f32_e64 v13, v13, s67
    v_mfma_f32_32x32x16_bf16 a[144:159], a[12:15], v[124:127], a[144:159]
    ds_read_b64_tr_b16 a[40:41], v9 offset:6144
    ds_read_b64_tr_b16 a[42:43], v9 offset:6656
    v_add_f32_e64 v14, v14, s67
    v_add_f32_e64 v24, v24, v11
    v_add_f32_e64 v25, v25, v12
    v_add_f32_e64 v26, v26, v13
    v_mfma_f32_32x32x16_bf16 a[128:143], a[16:19], v[128:131], a[128:143]
    ds_read_b64_tr_b16 a[44:45], v10 offset:6144
    ds_read_b64_tr_b16 a[46:47], v10 offset:6656
    v_add_f32_e64 v27, v27, v14
    v_cvt_pk_bf16_f32 v20, v24, v25
    v_cvt_pk_bf16_f32 v21, v26, v27
    v_mul_f32_e64 v11, v28, s66
    v_mfma_f32_32x32x16_bf16 a[144:159], a[20:23], v[128:131], a[144:159]
    ds_read_b64_tr_b16 a[0:1], v9 offset:8192
    ds_read_b64_tr_b16 a[2:3], v9 offset:8704
    v_mul_f32_e64 v12, v29, s66
    v_mul_f32_e64 v13, v30, s66
    v_mul_f32_e64 v14, v31, s66
    v_exp_f32_e64 v11, v11 clamp
    s_waitcnt lgkmcnt(6)
    v_mfma_f32_32x32x16_bf16 a[128:143], a[24:27], v[132:135], a[128:143]
    ds_read_b64_tr_b16 a[4:5], v10 offset:8192
    ds_read_b64_tr_b16 a[6:7], v10 offset:8704
    v_exp_f32_e64 v12, v12 clamp
    v_exp_f32_e64 v13, v13 clamp
    v_exp_f32_e64 v14, v14 clamp
    v_max_f32_e64 v28, v28, 0
    v_mfma_f32_32x32x16_bf16 a[144:159], a[28:31], v[132:135], a[144:159]
    ds_read_b64_tr_b16 a[8:9], v9 offset:10240
    ds_read_b64_tr_b16 a[10:11], v9 offset:10752
    v_max_f32_e64 v29, v29, 0
    v_max_f32_e64 v30, v30, 0
    v_max_f32_e64 v31, v31, 0
    v_add_f32_e64 v11, v11, s67
    v_mfma_f32_32x32x16_bf16 a[128:143], a[32:35], v[136:139], a[128:143]
    ds_read_b64_tr_b16 a[12:13], v10 offset:10240
    ds_read_b64_tr_b16 a[14:15], v10 offset:10752
    v_add_f32_e64 v12, v12, s67
    v_add_f32_e64 v13, v13, s67
    v_add_f32_e64 v14, v14, s67
    v_add_f32_e64 v28, v28, v11
    v_mfma_f32_32x32x16_bf16 a[144:159], a[36:39], v[136:139], a[144:159]
    ds_read_b64_tr_b16 a[16:17], v9 offset:12288
    ds_read_b64_tr_b16 a[18:19], v9 offset:12800
    v_add_f32_e64 v29, v29, v12
    v_add_f32_e64 v30, v30, v13
    v_add_f32_e64 v31, v31, v14
    v_cvt_pk_bf16_f32 v22, v28, v29
    s_waitcnt lgkmcnt(6)
    v_mfma_f32_32x32x16_bf16 a[128:143], a[40:43], v[140:143], a[128:143]
    ds_read_b64_tr_b16 a[20:21], v10 offset:12288
    ds_read_b64_tr_b16 a[22:23], v10 offset:12800
    v_cvt_pk_bf16_f32 v23, v30, v31
    ds_write_b128 v8, v[20:23] offset:32
    v_mul_f32_e64 v11, v32, s66
    v_mul_f32_e64 v12, v33, s66
    v_mfma_f32_32x32x16_bf16 a[144:159], a[44:47], v[140:143], a[144:159]
    ds_read_b64_tr_b16 a[24:25], v9 offset:14336
    ds_read_b64_tr_b16 a[26:27], v9 offset:14848
    v_mul_f32_e64 v13, v34, s66
    v_mul_f32_e64 v14, v35, s66
    v_exp_f32_e64 v11, v11 clamp
    v_exp_f32_e64 v12, v12 clamp
    v_mfma_f32_32x32x16_bf16 a[128:143], a[0:3], v[144:147], a[128:143]
    ds_read_b64_tr_b16 a[28:29], v10 offset:14336
    ds_read_b64_tr_b16 a[30:31], v10 offset:14848
    v_exp_f32_e64 v13, v13 clamp
    v_exp_f32_e64 v14, v14 clamp
    v_max_f32_e64 v32, v32, 0
    v_max_f32_e64 v33, v33, 0
    v_mfma_f32_32x32x16_bf16 a[144:159], a[4:7], v[144:147], a[144:159]
    s_waitcnt vmcnt(9)
    s_barrier
    ds_read_b64_tr_b16 a[32:33], v9 offset:20480
    ds_read_b64_tr_b16 a[34:35], v9 offset:20992
    v_max_f32_e64 v34, v34, 0
    v_max_f32_e64 v35, v35, 0
    v_add_f32_e64 v11, v11, s67
    v_add_f32_e64 v12, v12, s67
    s_waitcnt lgkmcnt(7)
    v_mfma_f32_32x32x16_bf16 a[128:143], a[8:11], v[148:151], a[128:143]
    ds_read_b64_tr_b16 a[36:37], v10 offset:20480
    ds_read_b64_tr_b16 a[38:39], v10 offset:20992
    v_add_f32_e64 v13, v13, s67
    v_add_f32_e64 v14, v14, s67
    v_add_f32_e64 v32, v32, v11
    v_add_f32_e64 v33, v33, v12
    v_mfma_f32_32x32x16_bf16 a[144:159], a[12:15], v[148:151], a[144:159]
    ds_read_b64_tr_b16 a[40:41], v9 offset:22528
    ds_read_b64_tr_b16 a[42:43], v9 offset:23040
    v_add_f32_e64 v34, v34, v13
    v_add_f32_e64 v35, v35, v14
    v_cvt_pk_bf16_f32 v32, v32, v33
    v_cvt_pk_bf16_f32 v33, v34, v35
    v_mfma_f32_32x32x16_bf16 a[128:143], a[16:19], v[152:155], a[128:143]
    ds_read_b64_tr_b16 a[44:45], v10 offset:22528
    ds_read_b64_tr_b16 a[46:47], v10 offset:23040
    v_mul_f32_e64 v11, v36, s66
    v_mul_f32_e64 v12, v37, s66
    v_mul_f32_e64 v13, v38, s66
    v_mul_f32_e64 v14, v39, s66
    v_mfma_f32_32x32x16_bf16 a[144:159], a[20:23], v[152:155], a[144:159]
    ds_read_b64_tr_b16 a[0:1], v9 offset:24576
    ds_read_b64_tr_b16 a[2:3], v9 offset:25088
    v_exp_f32_e64 v11, v11 clamp
    v_exp_f32_e64 v12, v12 clamp
    v_exp_f32_e64 v13, v13 clamp
    v_exp_f32_e64 v14, v14 clamp
    s_waitcnt lgkmcnt(6)
    v_mfma_f32_32x32x16_bf16 a[128:143], a[24:27], v[156:159], a[128:143]
    ds_read_b64_tr_b16 a[4:5], v10 offset:24576
    ds_read_b64_tr_b16 a[6:7], v10 offset:25088
    v_max_f32_e64 v36, v36, 0
    v_max_f32_e64 v37, v37, 0
    v_max_f32_e64 v38, v38, 0
    v_max_f32_e64 v39, v39, 0
    v_mfma_f32_32x32x16_bf16 a[144:159], a[28:31], v[156:159], a[144:159]
    ds_read_b64_tr_b16 a[8:9], v9 offset:26624
    ds_read_b64_tr_b16 a[10:11], v9 offset:27136
    v_add_f32_e64 v11, v11, s67
    v_add_f32_e64 v12, v12, s67
    v_add_f32_e64 v13, v13, s67
    v_add_f32_e64 v14, v14, s67
    v_mfma_f32_32x32x16_bf16 a[128:143], a[32:35], v[160:163], a[128:143]
    ds_read_b64_tr_b16 a[12:13], v10 offset:26624
    ds_read_b64_tr_b16 a[14:15], v10 offset:27136
    v_add_f32_e64 v36, v36, v11
    v_add_f32_e64 v37, v37, v12
    v_add_f32_e64 v38, v38, v13
    v_add_f32_e64 v39, v39, v14
    v_mfma_f32_32x32x16_bf16 a[144:159], a[36:39], v[160:163], a[144:159]
    ds_read_b64_tr_b16 a[16:17], v9 offset:28672
    ds_read_b64_tr_b16 a[18:19], v9 offset:29184
    v_cvt_pk_bf16_f32 v34, v36, v37
    v_cvt_pk_bf16_f32 v35, v38, v39
    ds_write_b128 v8, v[32:35] offset:8704
    v_mul_f32_e64 v11, v40, s66
    s_waitcnt lgkmcnt(7)
    v_mfma_f32_32x32x16_bf16 a[128:143], a[40:43], v[164:167], a[128:143]
    ds_read_b64_tr_b16 a[20:21], v10 offset:28672
    ds_read_b64_tr_b16 a[22:23], v10 offset:29184
    v_mul_f32_e64 v12, v41, s66
    v_mul_f32_e64 v13, v42, s66
    v_mul_f32_e64 v14, v43, s66
    v_exp_f32_e64 v11, v11 clamp
    v_mfma_f32_32x32x16_bf16 a[144:159], a[44:47], v[164:167], a[144:159]
    ds_read_b64_tr_b16 a[24:25], v9 offset:30720
    ds_read_b64_tr_b16 a[26:27], v9 offset:31232
    v_exp_f32_e64 v12, v12 clamp
    v_exp_f32_e64 v13, v13 clamp
    v_exp_f32_e64 v14, v14 clamp
    v_max_f32_e64 v40, v40, 0
    v_mfma_f32_32x32x16_bf16 a[128:143], a[0:3], v[168:171], a[128:143]
    ds_read_b64_tr_b16 a[28:29], v10 offset:30720
    ds_read_b64_tr_b16 a[30:31], v10 offset:31232
    v_max_f32_e64 v41, v41, 0
    v_max_f32_e64 v42, v42, 0
    v_max_f32_e64 v43, v43, 0
    v_add_f32_e64 v11, v11, s67
    v_mfma_f32_32x32x16_bf16 a[144:159], a[4:7], v[168:171], a[144:159]
    ds_read_b64_tr_b16 a[32:33], v9 offset:32768
    ds_read_b64_tr_b16 a[34:35], v9 offset:33280
    v_add_f32_e64 v12, v12, s67
    v_add_f32_e64 v13, v13, s67
    v_add_f32_e64 v14, v14, s67
    v_add_f32_e64 v40, v40, v11
    s_waitcnt lgkmcnt(6)
    v_mfma_f32_32x32x16_bf16 a[128:143], a[8:11], v[172:175], a[128:143]
    ds_read_b64_tr_b16 a[36:37], v10 offset:32768
    ds_read_b64_tr_b16 a[38:39], v10 offset:33280
    v_add_f32_e64 v41, v41, v12
    v_add_f32_e64 v42, v42, v13
    v_add_f32_e64 v43, v43, v14
    v_cvt_pk_bf16_f32 v36, v40, v41
    v_mfma_f32_32x32x16_bf16 a[144:159], a[12:15], v[172:175], a[144:159]
    ds_read_b64_tr_b16 a[40:41], v9 offset:34816
    ds_read_b64_tr_b16 a[42:43], v9 offset:35328
    v_cvt_pk_bf16_f32 v37, v42, v43
    v_mul_f32_e64 v11, v44, s66
    v_mul_f32_e64 v12, v45, s66
    v_mul_f32_e64 v13, v46, s66
    v_mfma_f32_32x32x16_bf16 a[128:143], a[16:19], v[176:179], a[128:143]
    ds_read_b64_tr_b16 a[44:45], v10 offset:34816
    ds_read_b64_tr_b16 a[46:47], v10 offset:35328
    v_mul_f32_e64 v14, v47, s66
    v_exp_f32_e64 v11, v11 clamp
    v_exp_f32_e64 v12, v12 clamp
    v_exp_f32_e64 v13, v13 clamp
    v_mfma_f32_32x32x16_bf16 a[144:159], a[20:23], v[176:179], a[144:159]
    s_waitcnt vmcnt(5)
    s_barrier
    ds_read_b64_tr_b16 a[0:1], v9 offset:40960
    ds_read_b64_tr_b16 a[2:3], v9 offset:41472
    v_exp_f32_e64 v14, v14 clamp
    v_max_f32_e64 v44, v44, 0
    v_max_f32_e64 v45, v45, 0
    v_max_f32_e64 v46, v46, 0
    s_waitcnt lgkmcnt(6)
    v_mfma_f32_32x32x16_bf16 a[128:143], a[24:27], v[180:183], a[128:143]
    ds_read_b64_tr_b16 a[4:5], v10 offset:40960
    ds_read_b64_tr_b16 a[6:7], v10 offset:41472
    v_max_f32_e64 v47, v47, 0
    v_add_f32_e64 v11, v11, s67
    v_add_f32_e64 v12, v12, s67
    v_add_f32_e64 v13, v13, s67
    v_mfma_f32_32x32x16_bf16 a[144:159], a[28:31], v[180:183], a[144:159]
    ds_read_b64_tr_b16 a[8:9], v9 offset:43008
    ds_read_b64_tr_b16 a[10:11], v9 offset:43520
    v_add_f32_e64 v14, v14, s67
    v_add_f32_e64 v44, v44, v11
    v_add_f32_e64 v45, v45, v12
    v_add_f32_e64 v46, v46, v13
    v_mfma_f32_32x32x16_bf16 a[128:143], a[32:35], v[184:187], a[128:143]
    ds_read_b64_tr_b16 a[12:13], v10 offset:43008
    ds_read_b64_tr_b16 a[14:15], v10 offset:43520
    v_add_f32_e64 v47, v47, v14
    v_cvt_pk_bf16_f32 v38, v44, v45
    v_cvt_pk_bf16_f32 v39, v46, v47
    ds_write_b128 v8, v[36:39] offset:8736
    v_mfma_f32_32x32x16_bf16 a[144:159], a[36:39], v[184:187], a[144:159]
    ds_read_b64_tr_b16 a[16:17], v9 offset:45056
    ds_read_b64_tr_b16 a[18:19], v9 offset:45568
    v_mul_f32_e64 v11, v48, s66
    v_mul_f32_e64 v12, v49, s66
    v_mul_f32_e64 v13, v50, s66
    v_mul_f32_e64 v14, v51, s66
    s_waitcnt lgkmcnt(7)
    v_mfma_f32_32x32x16_bf16 a[128:143], a[40:43], v[188:191], a[128:143]
    ds_read_b64_tr_b16 a[20:21], v10 offset:45056
    ds_read_b64_tr_b16 a[22:23], v10 offset:45568
    v_exp_f32_e64 v11, v11 clamp
    v_exp_f32_e64 v12, v12 clamp
    v_exp_f32_e64 v13, v13 clamp
    v_exp_f32_e64 v14, v14 clamp
    v_mfma_f32_32x32x16_bf16 a[144:159], a[44:47], v[188:191], a[144:159]
    ds_read_b64_tr_b16 a[24:25], v9 offset:47104
    ds_read_b64_tr_b16 a[26:27], v9 offset:47616
    v_add_f32_e64 v11, v11, s67
    v_add_f32_e64 v12, v12, s67
    v_add_f32_e64 v13, v13, s67
    v_add_f32_e64 v14, v14, s67
    v_mfma_f32_32x32x16_bf16 a[128:143], a[0:3], v[192:195], a[128:143]
    ds_read_b64_tr_b16 a[28:29], v10 offset:47104
    ds_read_b64_tr_b16 a[30:31], v10 offset:47616
    v_max_f32_e64 v15, v48, 0
    v_add_f32_e64 v11, v15, v11
    v_max_f32_e64 v15, v49, 0
    v_add_f32_e64 v12, v15, v12
    v_mfma_f32_32x32x16_bf16 a[144:159], a[4:7], v[192:195], a[144:159]
    ds_read_b64_tr_b16 a[32:33], v9 offset:49152
    ds_read_b64_tr_b16 a[34:35], v9 offset:49664
    v_max_f32_e64 v15, v50, 0
    v_add_f32_e64 v13, v15, v13
    v_max_f32_e64 v15, v51, 0
    v_add_f32_e64 v14, v15, v14
    s_waitcnt lgkmcnt(6)
    v_mfma_f32_32x32x16_bf16 a[128:143], a[8:11], v[196:199], a[128:143]
    ds_read_b64_tr_b16 a[36:37], v10 offset:49152
    ds_read_b64_tr_b16 a[38:39], v10 offset:49664
    v_cndmask_b32_e64 v48, v11, v48, vcc
    v_cndmask_b32_e64 v49, v12, v49, vcc
    v_cndmask_b32_e64 v50, v13, v50, vcc
    v_cndmask_b32_e64 v51, v14, v51, vcc
    v_mfma_f32_32x32x16_bf16 a[144:159], a[12:15], v[196:199], a[144:159]
    ds_read_b64_tr_b16 a[40:41], v9 offset:51200
    ds_read_b64_tr_b16 a[42:43], v9 offset:51712
    v_cvt_pk_bf16_f32 v48, v48, v49
    v_cvt_pk_bf16_f32 v49, v50, v51
    v_mul_f32_e64 v11, v52, s66
    v_mul_f32_e64 v12, v53, s66
    v_mfma_f32_32x32x16_bf16 a[128:143], a[16:19], v[200:203], a[128:143]
    ds_read_b64_tr_b16 a[44:45], v10 offset:51200
    ds_read_b64_tr_b16 a[46:47], v10 offset:51712
    v_mul_f32_e64 v13, v54, s66
    v_mul_f32_e64 v14, v55, s66
    v_exp_f32_e64 v11, v11 clamp
    v_exp_f32_e64 v12, v12 clamp
    v_mfma_f32_32x32x16_bf16 a[144:159], a[20:23], v[200:203], a[144:159]
    ds_read_b64_tr_b16 a[0:1], v9 offset:53248
    ds_read_b64_tr_b16 a[2:3], v9 offset:53760
    v_exp_f32_e64 v13, v13 clamp
    v_exp_f32_e64 v14, v14 clamp
    v_add_f32_e64 v11, v11, s67
    v_add_f32_e64 v12, v12, s67
    s_waitcnt lgkmcnt(6)
    v_mfma_f32_32x32x16_bf16 a[128:143], a[24:27], v[204:207], a[128:143]
    ds_read_b64_tr_b16 a[4:5], v10 offset:53248
    ds_read_b64_tr_b16 a[6:7], v10 offset:53760
    v_add_f32_e64 v13, v13, s67
    v_add_f32_e64 v14, v14, s67
    v_max_f32_e64 v15, v52, 0
    v_add_f32_e64 v11, v15, v11
    v_mfma_f32_32x32x16_bf16 a[144:159], a[28:31], v[204:207], a[144:159]
    ds_read_b64_tr_b16 a[8:9], v9 offset:55296
    ds_read_b64_tr_b16 a[10:11], v9 offset:55808
    v_max_f32_e64 v15, v53, 0
    v_add_f32_e64 v12, v15, v12
    v_max_f32_e64 v15, v54, 0
    v_add_f32_e64 v13, v15, v13
    v_mfma_f32_32x32x16_bf16 a[128:143], a[32:35], v[208:211], a[128:143]
    ds_read_b64_tr_b16 a[12:13], v10 offset:55296
    ds_read_b64_tr_b16 a[14:15], v10 offset:55808
    v_max_f32_e64 v15, v55, 0
    v_add_f32_e64 v14, v15, v14
    v_cndmask_b32_e64 v52, v11, v52, vcc
    v_cndmask_b32_e64 v53, v12, v53, vcc
    v_mfma_f32_32x32x16_bf16 a[144:159], a[36:39], v[208:211], a[144:159]
    s_waitcnt vmcnt(0)
    s_barrier
    v_add_u32 v9, 106496, v9
    ds_read_b64_tr_b16 a[16:17], v9 offset:0
    ds_read_b64_tr_b16 a[18:19], v9 offset:512
    v_cndmask_b32_e64 v54, v13, v54, vcc
    v_cndmask_b32_e64 v55, v14, v55, vcc
    v_cvt_pk_bf16_f32 v50, v52, v53
    v_cvt_pk_bf16_f32 v51, v54, v55
    s_waitcnt lgkmcnt(6)
    v_mfma_f32_32x32x16_bf16 a[128:143], a[40:43], v[212:215], a[128:143]
    v_add_u32 v10, 106496, v10
    ds_read_b64_tr_b16 a[20:21], v10 offset:0
    ds_read_b64_tr_b16 a[22:23], v10 offset:512
    ds_write_b128 v8, v[48:51] offset:17408
    v_mul_f32_e64 v11, v56, s66
    v_mul_f32_e64 v12, v57, s66
    v_mul_f32_e64 v13, v58, s66
    v_mfma_f32_32x32x16_bf16 a[144:159], a[44:47], v[212:215], a[144:159]
    ds_read_b64_tr_b16 a[24:25], v9 offset:2048
    ds_read_b64_tr_b16 a[26:27], v9 offset:2560
    v_mul_f32_e64 v14, v59, s66
    v_exp_f32_e64 v11, v11 clamp
    v_exp_f32_e64 v12, v12 clamp
    v_exp_f32_e64 v13, v13 clamp
    v_mfma_f32_32x32x16_bf16 a[128:143], a[0:3], v[216:219], a[128:143]
    ds_read_b64_tr_b16 a[28:29], v10 offset:2048
    ds_read_b64_tr_b16 a[30:31], v10 offset:2560
    v_exp_f32_e64 v14, v14 clamp
    v_add_f32_e64 v11, v11, s67
    v_add_f32_e64 v12, v12, s67
    v_add_f32_e64 v13, v13, s67
    v_mfma_f32_32x32x16_bf16 a[144:159], a[4:7], v[216:219], a[144:159]
    ds_read_b64_tr_b16 a[32:33], v9 offset:4096
    ds_read_b64_tr_b16 a[34:35], v9 offset:4608
    v_add_f32_e64 v14, v14, s67
    v_max_f32_e64 v15, v56, 0
    v_add_f32_e64 v11, v15, v11
    v_max_f32_e64 v15, v57, 0
    s_waitcnt lgkmcnt(7)
    v_mfma_f32_32x32x16_bf16 a[128:143], a[8:11], v[220:223], a[128:143]
    ds_read_b64_tr_b16 a[36:37], v10 offset:4096
    ds_read_b64_tr_b16 a[38:39], v10 offset:4608
    v_add_f32_e64 v12, v15, v12
    v_max_f32_e64 v15, v58, 0
    v_add_f32_e64 v13, v15, v13
    v_max_f32_e64 v15, v59, 0
    v_mfma_f32_32x32x16_bf16 a[144:159], a[12:15], v[220:223], a[144:159]
    ds_read_b64_tr_b16 a[40:41], v9 offset:6144
    ds_read_b64_tr_b16 a[42:43], v9 offset:6656
    v_add_f32_e64 v14, v15, v14
    v_cndmask_b32_e64 v56, v11, v56, vcc
    v_cndmask_b32_e64 v57, v12, v57, vcc
    v_cndmask_b32_e64 v58, v13, v58, vcc
    v_mfma_f32_32x32x16_bf16 a[128:143], a[16:19], v[224:227], a[128:143]
    ds_read_b64_tr_b16 a[44:45], v10 offset:6144
    ds_read_b64_tr_b16 a[46:47], v10 offset:6656
    v_cndmask_b32_e64 v59, v14, v59, vcc
    v_cvt_pk_bf16_f32 v52, v56, v57
    v_cvt_pk_bf16_f32 v53, v58, v59
    v_mul_f32_e64 v11, v60, s66
    v_mfma_f32_32x32x16_bf16 a[144:159], a[20:23], v[224:227], a[144:159]
    ds_read_b64_tr_b16 a[0:1], v9 offset:8192
    ds_read_b64_tr_b16 a[2:3], v9 offset:8704
    v_mul_f32_e64 v12, v61, s66
    v_mul_f32_e64 v13, v62, s66
    v_mul_f32_e64 v14, v63, s66
    v_exp_f32_e64 v11, v11 clamp
    s_waitcnt lgkmcnt(6)
    v_mfma_f32_32x32x16_bf16 a[128:143], a[24:27], v[228:231], a[128:143]
    ds_read_b64_tr_b16 a[4:5], v10 offset:8192
    ds_read_b64_tr_b16 a[6:7], v10 offset:8704
    v_exp_f32_e64 v12, v12 clamp
    v_exp_f32_e64 v13, v13 clamp
    v_exp_f32_e64 v14, v14 clamp
    v_add_f32_e64 v11, v11, s67
    v_mfma_f32_32x32x16_bf16 a[144:159], a[28:31], v[228:231], a[144:159]
    ds_read_b64_tr_b16 a[8:9], v9 offset:10240
    ds_read_b64_tr_b16 a[10:11], v9 offset:10752
    v_add_f32_e64 v12, v12, s67
    v_add_f32_e64 v13, v13, s67
    v_add_f32_e64 v14, v14, s67
    v_max_f32_e64 v15, v60, 0
    v_mfma_f32_32x32x16_bf16 a[128:143], a[32:35], v[232:235], a[128:143]
    ds_read_b64_tr_b16 a[12:13], v10 offset:10240
    ds_read_b64_tr_b16 a[14:15], v10 offset:10752
    v_add_f32_e64 v11, v15, v11
    v_max_f32_e64 v15, v61, 0
    v_add_f32_e64 v12, v15, v12
    v_max_f32_e64 v15, v62, 0
    v_mfma_f32_32x32x16_bf16 a[144:159], a[36:39], v[232:235], a[144:159]
    ds_read_b64_tr_b16 a[16:17], v9 offset:12288
    ds_read_b64_tr_b16 a[18:19], v9 offset:12800
    v_add_f32_e64 v13, v15, v13
    v_max_f32_e64 v15, v63, 0
    v_add_f32_e64 v14, v15, v14
    v_cndmask_b32_e64 v60, v11, v60, vcc
    s_waitcnt lgkmcnt(6)
    v_mfma_f32_32x32x16_bf16 a[128:143], a[40:43], v[236:239], a[128:143]
    ds_read_b64_tr_b16 a[20:21], v10 offset:12288
    ds_read_b64_tr_b16 a[22:23], v10 offset:12800
    v_cndmask_b32_e64 v61, v12, v61, vcc
    v_cndmask_b32_e64 v62, v13, v62, vcc
    v_cndmask_b32_e64 v63, v14, v63, vcc
    v_cvt_pk_bf16_f32 v54, v60, v61
    v_mfma_f32_32x32x16_bf16 a[144:159], a[44:47], v[236:239], a[144:159]
    ds_read_b64_tr_b16 a[24:25], v9 offset:14336
    ds_read_b64_tr_b16 a[26:27], v9 offset:14848
    v_cvt_pk_bf16_f32 v55, v62, v63
    ds_write_b128 v8, v[52:55] offset:17440
    v_cvt_pk_bf16_f32 v64, v64, v65
    v_cvt_pk_bf16_f32 v65, v66, v67
    v_mfma_f32_32x32x16_bf16 a[128:143], a[0:3], v[240:243], a[128:143]
    ds_read_b64_tr_b16 a[28:29], v10 offset:14336
    ds_read_b64_tr_b16 a[30:31], v10 offset:14848
    v_cvt_pk_bf16_f32 v66, v68, v69
    v_cvt_pk_bf16_f32 v67, v70, v71
    ds_write_b128 v8, v[64:67] offset:26112
    v_mfma_f32_32x32x16_bf16 a[144:159], a[4:7], v[240:243], a[144:159]
    v_cvt_pk_bf16_f32 v68, v72, v73
    v_cvt_pk_bf16_f32 v69, v74, v75
    v_cvt_pk_bf16_f32 v70, v76, v77
    s_waitcnt lgkmcnt(6)
    v_mfma_f32_32x32x16_bf16 a[128:143], a[8:11], v[244:247], a[128:143]
    v_cvt_pk_bf16_f32 v71, v78, v79
    ds_write_b128 v8, v[68:71] offset:26144
    v_cvt_pk_bf16_f32 v80, v80, v81
    v_mfma_f32_32x32x16_bf16 a[144:159], a[12:15], v[244:247], a[144:159]
    v_cvt_pk_bf16_f32 v81, v82, v83
    v_cvt_pk_bf16_f32 v82, v84, v85
    v_cvt_pk_bf16_f32 v83, v86, v87
    v_mfma_f32_32x32x16_bf16 a[128:143], a[16:19], v[248:251], a[128:143]
    ds_write_b128 v8, v[80:83] offset:34816
    v_cvt_pk_bf16_f32 v84, v88, v89
    v_cvt_pk_bf16_f32 v85, v90, v91
    v_mfma_f32_32x32x16_bf16 a[144:159], a[20:23], v[248:251], a[144:159]
    v_cvt_pk_bf16_f32 v86, v92, v93
    v_cvt_pk_bf16_f32 v87, v94, v95
    ds_write_b128 v8, v[84:87] offset:34848
    s_waitcnt lgkmcnt(4)
    v_mfma_f32_32x32x16_bf16 a[128:143], a[24:27], v[252:255], a[128:143]
    v_mfma_f32_32x32x16_bf16 a[144:159], a[28:31], v[252:255], a[144:159]
    v_and_b32 v9, 31, v3
    v_lshrrev_b32 v10, 5, v3
    s_mul_i32 s71, s24, 5440
    s_add_u32 s71, s71, 81920
    v_add_u32 v0, s71, v0
    v_add_u32 v1, 21760, v0
    v_lshlrev_b32 v8, 4, v10
    v_add_u32 v8, 4096, v8
    v_cmp_lt_u32 vcc, 19, v9
    v_lshlrev_b32 v11, 2, v9
    v_lshlrev_b32 v12, 7, v10
    v_cndmask_b32 v1, v1, v8, vcc
    v_add_u32 v11, v11, v12
    v_mov_b32 v13, 2130706432
    v_cmp_lt_u32 vcc, 20, v9
    s_lshl_b32 s71, s26, 2
    s_add_u32 s71, s71, s24
    v_cndmask_b32 v11, v11, v13, vcc
    v_cmp_lt_u32 vcc, 31, v3
    s_nop 1
    v_cndmask_b32 v12, v11, v13, vcc
    s_lshl_b32 s71, s71, 12
    s_add_u32 s71, s71, 17825792
    s_mov_b32 s75, 0
    s_branch K1_pKB_c
K1_pKB_l:
    s_sleep 8
    buffer_load_dwordx4 a[244:247], off, s[96:99], 0 sc1
    s_add_u32 s75, s75, 1
    s_waitcnt vmcnt(0)
    s_cmp_ge_u32 s75, 0x20000
    s_cbranch_scc1 K1_pKB_ok
K1_pKB_c:
    v_accvgpr_read_b32 v15, a244
    s_nop 1
    v_readfirstlane_b32 s74, v15
    s_bfe_u32 s74, s74, 524288
    s_cmp_ge_u32 s74, 32
    s_cbranch_scc0 K1_pKB_l
K1_pKB_ok:
    s_waitcnt lgkmcnt(0)
    s_barrier
    ds_read_b128 v[16:19], v0 offset:0
    ds_read_b128 v[20:23], v1 offset:0
    ds_read_b128 v[24:27], v0 offset:32
    ds_read_b128 v[28:31], v1 offset:32
    ds_read_b128 v[32:35], v0 offset:64
    ds_read_b128 v[36:39], v1 offset:64
    ds_read_b128 v[40:43], v0 offset:96
    ds_read_b128 v[44:47], v1 offset:96
    ds_read_b128 v[48:51], v0 offset:128
    ds_read_b128 v[52:55], v1 offset:128
    ds_read_b128 v[56:59], v0 offset:160
    ds_read_b128 v[60:63], v1 offset:160
    ds_read_b128 v[64:67], v0 offset:192
    ds_read_b128 v[68:71], v1 offset:192
    ds_read_b128 v[72:75], v0 offset:224
    ds_read_b128 v[76:79], v1 offset:224
    s_waitcnt lgkmcnt(14)
    v_mfma_f32_32x32x16_bf16 v[80:95], v[16:19], v[20:23], 0
    s_waitcnt lgkmcnt(12)
    v_mfma_f32_32x32x16_bf16 v[80:95], v[24:27], v[28:31], v[80:95]
    s_waitcnt lgkmcnt(10)
    v_mfma_f32_32x32x16_bf16 v[80:95], v[32:35], v[36:39], v[80:95]
    s_waitcnt lgkmcnt(8)
    v_mfma_f32_32x32x16_bf16 v[80:95], v[40:43], v[44:47], v[80:95]
    s_waitcnt lgkmcnt(6)
    v_mfma_f32_32x32x16_bf16 v[80:95], v[48:51], v[52:55], v[80:95]
    s_waitcnt lgkmcnt(4)
    v_mfma_f32_32x32x16_bf16 v[80:95], v[56:59], v[60:63], v[80:95]
    s_waitcnt lgkmcnt(2)
    v_mfma_f32_32x32x16_bf16 v[80:95], v[64:67], v[68:71], v[80:95]
    s_waitcnt lgkmcnt(0)
    v_mfma_f32_32x32x16_bf16 v[80:95], v[72:75], v[76:79], v[80:95]
    s_nop 7
    s_nop 7
    buffer_atomic_add_f32 v80, v11, s[16:19], s71 offen offset:0 sc1
    buffer_atomic_add_f32 v81, v11, s[16:19], s71 offen offset:256 sc1
    buffer_atomic_add_f32 v82, v11, s[16:19], s71 offen offset:512 sc1
    buffer_atomic_add_f32 v83, v11, s[16:19], s71 offen offset:768 sc1
    buffer_atomic_add_f32 v84, v11, s[16:19], s71 offen offset:1024 sc1
    buffer_atomic_add_f32 v85, v11, s[16:19], s71 offen offset:1280 sc1
    buffer_atomic_add_f32 v86, v11, s[16:19], s71 offen offset:1536 sc1
    buffer_atomic_add_f32 v87, v11, s[16:19], s71 offen offset:1792 sc1
    buffer_atomic_add_f32 v88, v12, s[16:19], s71 offen offset:2048 sc1
    buffer_atomic_add_f32 v89, v12, s[16:19], s71 offen offset:2304 sc1
    buffer_atomic_add_f32 v90, v12, s[16:19], s71 offen offset:2560 sc1
    buffer_atomic_add_f32 v91, v12, s[16:19], s71 offen offset:2816 sc1
    v_accvgpr_read_b32 v0, a116
    v_accvgpr_read_b32 v16, a128
    v_accvgpr_read_b32 v17, a129
    v_accvgpr_read_b32 v18, a130
    v_accvgpr_read_b32 v19, a131
    v_accvgpr_read_b32 v20, a132
    v_accvgpr_read_b32 v21, a133
    v_accvgpr_read_b32 v22, a134
    v_accvgpr_read_b32 v23, a135
    v_accvgpr_read_b32 v24, a136
    v_accvgpr_read_b32 v25, a137
    v_accvgpr_read_b32 v26, a138
    v_accvgpr_read_b32 v27, a139
    v_accvgpr_read_b32 v28, a140
    v_accvgpr_read_b32 v29, a141
    v_accvgpr_read_b32 v30, a142
    v_accvgpr_read_b32 v31, a143
    v_accvgpr_read_b32 v32, a144
    v_accvgpr_read_b32 v33, a145
    v_accvgpr_read_b32 v34, a146
    v_accvgpr_read_b32 v35, a147
    v_accvgpr_read_b32 v36, a148
    v_accvgpr_read_b32 v37, a149
    v_accvgpr_read_b32 v38, a150
    v_accvgpr_read_b32 v39, a151
    v_accvgpr_read_b32 v40, a152
    v_accvgpr_read_b32 v41, a153
    v_accvgpr_read_b32 v42, a154
    v_accvgpr_read_b32 v43, a155
    v_accvgpr_read_b32 v44, a156
    v_accvgpr_read_b32 v45, a157
    v_accvgpr_read_b32 v46, a158
    v_accvgpr_read_b32 v47, a159
    v_add_u32 v8, 0x1000, v0
    v_mul_f32_e64 v11, v16, s66
    v_mul_f32_e64 v12, v17, s66
    v_mul_f32_e64 v13, v18, s66
    v_mul_f32_e64 v14, v19, s66
    v_exp_f32_e64 v11, v11 clamp
    v_exp_f32_e64 v12, v12 clamp
    v_exp_f32_e64 v13, v13 clamp
    v_exp_f32_e64 v14, v14 clamp
    v_max_f32_e64 v16, v16, 0
    v_max_f32_e64 v17, v17, 0
    v_max_f32_e64 v18, v18, 0
    v_max_f32_e64 v19, v19, 0
    v_add_f32_e64 v11, v11, s67
    v_add_f32_e64 v12, v12, s67
    v_add_f32_e64 v13, v13, s67
    v_add_f32_e64 v14, v14, s67
    v_add_f32_e64 v16, v16, v11
    v_add_f32_e64 v17, v17, v12
    v_add_f32_e64 v18, v18, v13
    v_add_f32_e64 v19, v19, v14
    v_cvt_pk_bf16_f32 v16, v16, v17
    v_cvt_pk_bf16_f32 v17, v18, v19
    v_mul_f32_e64 v11, v20, s66
    v_mul_f32_e64 v12, v21, s66
    v_mul_f32_e64 v13, v22, s66
    v_mul_f32_e64 v14, v23, s66
    v_exp_f32_e64 v11, v11 clamp
    v_exp_f32_e64 v12, v12 clamp
    v_exp_f32_e64 v13, v13 clamp
    v_exp_f32_e64 v14, v14 clamp
    v_max_f32_e64 v20, v20, 0
    v_max_f32_e64 v21, v21, 0
    v_max_f32_e64 v22, v22, 0
    v_max_f32_e64 v23, v23, 0
    v_add_f32_e64 v11, v11, s67
    v_add_f32_e64 v12, v12, s67
    v_add_f32_e64 v13, v13, s67
    v_add_f32_e64 v14, v14, s67
    v_add_f32_e64 v20, v20, v11
    v_add_f32_e64 v21, v21, v12
    v_add_f32_e64 v22, v22, v13
    v_add_f32_e64 v23, v23, v14
    v_cvt_pk_bf16_f32 v18, v20, v21
    v_cvt_pk_bf16_f32 v19, v22, v23
    buffer_store_dwordx4 v[16:19], v0, s[16:19], s36 offen offset:0 sc1
    v_mul_f32_e64 v11, v24, s66
    v_mul_f32_e64 v12, v25, s66
    v_mul_f32_e64 v13, v26, s66
    v_mul_f32_e64 v14, v27, s66
    v_exp_f32_e64 v11, v11 clamp
    v_exp_f32_e64 v12, v12 clamp
    v_exp_f32_e64 v13, v13 clamp
    v_exp_f32_e64 v14, v14 clamp
    v_max_f32_e64 v24, v24, 0
    v_max_f32_e64 v25, v25, 0
    v_max_f32_e64 v26, v26, 0
    v_max_f32_e64 v27, v27, 0
    v_add_f32_e64 v11, v11, s67
    v_add_f32_e64 v12, v12, s67
    v_add_f32_e64 v13, v13, s67
    v_add_f32_e64 v14, v14, s67
    v_add_f32_e64 v24, v24, v11
    v_add_f32_e64 v25, v25, v12
    v_add_f32_e64 v26, v26, v13
    v_add_f32_e64 v27, v27, v14
    v_cvt_pk_bf16_f32 v20, v24, v25
    v_cvt_pk_bf16_f32 v21, v26, v27
    v_mul_f32_e64 v11, v28, s66
    v_mul_f32_e64 v12, v29, s66
    v_mul_f32_e64 v13, v30, s66
    v_mul_f32_e64 v14, v31, s66
    v_exp_f32_e64 v11, v11 clamp
    v_exp_f32_e64 v12, v12 clamp
    v_exp_f32_e64 v13, v13 clamp
    v_exp_f32_e64 v14, v14 clamp
    v_max_f32_e64 v28, v28, 0
    v_max_f32_e64 v29, v29, 0
    v_max_f32_e64 v30, v30, 0
    v_max_f32_e64 v31, v31, 0
    v_add_f32_e64 v11, v11, s67
    v_add_f32_e64 v12, v12, s67
    v_add_f32_e64 v13, v13, s67
    v_add_f32_e64 v14, v14, s67
    v_add_f32_e64 v28, v28, v11
    v_add_f32_e64 v29, v29, v12
    v_add_f32_e64 v30, v30, v13
    v_add_f32_e64 v31, v31, v14
    v_cvt_pk_bf16_f32 v22, v28, v29
    v_cvt_pk_bf16_f32 v23, v30, v31
    buffer_store_dwordx4 v[20:23], v0, s[16:19], s36 offen offset:512 sc1
    v_mul_f32_e64 v11, v32, s66
    v_mul_f32_e64 v12, v33, s66
    v_mul_f32_e64 v13, v34, s66
    v_mul_f32_e64 v14, v35, s66
    v_exp_f32_e64 v11, v11 clamp
    v_exp_f32_e64 v12, v12 clamp
    v_exp_f32_e64 v13, v13 clamp
    v_exp_f32_e64 v14, v14 clamp
    v_max_f32_e64 v32, v32, 0
    v_max_f32_e64 v33, v33, 0
    v_max_f32_e64 v34, v34, 0
    v_max_f32_e64 v35, v35, 0
    v_add_f32_e64 v11, v11, s67
    v_add_f32_e64 v12, v12, s67
    v_add_f32_e64 v13, v13, s67
    v_add_f32_e64 v14, v14, s67
    v_add_f32_e64 v32, v32, v11
    v_add_f32_e64 v33, v33, v12
    v_add_f32_e64 v34, v34, v13
    v_add_f32_e64 v35, v35, v14
    v_cvt_pk_bf16_f32 v32, v32, v33
    v_cvt_pk_bf16_f32 v33, v34, v35
    v_mul_f32_e64 v11, v36, s66
    v_mul_f32_e64 v12, v37, s66
    v_mul_f32_e64 v13, v38, s66
    v_mul_f32_e64 v14, v39, s66
    v_exp_f32_e64 v11, v11 clamp
    v_exp_f32_e64 v12, v12 clamp
    v_exp_f32_e64 v13, v13 clamp
    v_exp_f32_e64 v14, v14 clamp
    v_max_f32_e64 v36, v36, 0
    v_max_f32_e64 v37, v37, 0
    v_max_f32_e64 v38, v38, 0
    v_max_f32_e64 v39, v39, 0
    v_add_f32_e64 v11, v11, s67
    v_add_f32_e64 v12, v12, s67
    v_add_f32_e64 v13, v13, s67
    v_add_f32_e64 v14, v14, s67
    v_add_f32_e64 v36, v36, v11
    v_add_f32_e64 v37, v37, v12
    v_add_f32_e64 v38, v38, v13
    v_add_f32_e64 v39, v39, v14
    v_cvt_pk_bf16_f32 v34, v36, v37
    v_cvt_pk_bf16_f32 v35, v38, v39
    buffer_store_dwordx4 v[32:35], v8, s[16:19], s36 offen offset:0 sc1
    v_mul_f32_e64 v11, v40, s66
    v_mul_f32_e64 v12, v41, s66
    v_mul_f32_e64 v13, v42, s66
    v_mul_f32_e64 v14, v43, s66
    v_exp_f32_e64 v11, v11 clamp
    v_exp_f32_e64 v12, v12 clamp
    v_exp_f32_e64 v13, v13 clamp
    v_exp_f32_e64 v14, v14 clamp
    v_max_f32_e64 v40, v40, 0
    v_max_f32_e64 v41, v41, 0
    v_max_f32_e64 v42, v42, 0
    v_max_f32_e64 v43, v43, 0
    v_add_f32_e64 v11, v11, s67
    v_add_f32_e64 v12, v12, s67
    v_add_f32_e64 v13, v13, s67
    v_add_f32_e64 v14, v14, s67
    v_add_f32_e64 v40, v40, v11
    v_add_f32_e64 v41, v41, v12
    v_add_f32_e64 v42, v42, v13
    v_add_f32_e64 v43, v43, v14
    v_cvt_pk_bf16_f32 v36, v40, v41
    v_cvt_pk_bf16_f32 v37, v42, v43
    v_mul_f32_e64 v11, v44, s66
    v_mul_f32_e64 v12, v45, s66
    v_mul_f32_e64 v13, v46, s66
    v_mul_f32_e64 v14, v47, s66
    v_exp_f32_e64 v11, v11 clamp
    v_exp_f32_e64 v12, v12 clamp
    v_exp_f32_e64 v13, v13 clamp
    v_exp_f32_e64 v14, v14 clamp
    v_max_f32_e64 v44, v44, 0
    v_max_f32_e64 v45, v45, 0
    v_max_f32_e64 v46, v46, 0
    v_max_f32_e64 v47, v47, 0
    v_add_f32_e64 v11, v11, s67
    v_add_f32_e64 v12, v12, s67
    v_add_f32_e64 v13, v13, s67
    v_add_f32_e64 v14, v14, s67
    v_add_f32_e64 v44, v44, v11
    v_add_f32_e64 v45, v45, v12
    v_add_f32_e64 v46, v46, v13
    v_add_f32_e64 v47, v47, v14
    v_cvt_pk_bf16_f32 v38, v44, v45
    v_cvt_pk_bf16_f32 v39, v46, v47
    buffer_store_dwordx4 v[36:39], v8, s[16:19], s36 offen offset:512 sc1
    s_waitcnt vmcnt(4)
    s_barrier
    v_mov_b32 v15, 1
    s_mov_b64 exec, 1
    buffer_atomic_add v15, off, s[16:19], s31  offset:0 sc1
    s_mov_b64 exec, -1
    s_mov_b32 s64, 1
    s_mov_b32 s65, 1
    s_lshr_b32 s3, s25, 1
    s_lshl_b32 s3, s3, 7
    s_add_u32 s3, s3, 20449280
    s_cmp_eq_u32 s24, 0
    s_cselect_b32 s3, s3, 2130706432
    s_branch K1_P2
K1_CD:
    v_mul_f32_e64 v11, v16, s66
    v_mul_f32_e64 v12, v17, s66
    v_mul_f32_e64 v13, v18, s66
    v_mul_f32_e64 v14, v19, s66
    v_exp_f32_e64 v11, v11 clamp
    v_exp_f32_e64 v12, v12 clamp
    v_exp_f32_e64 v13, v13 clamp
    v_exp_f32_e64 v14, v14 clamp
    v_max_f32_e64 v16, v16, 0
    v_max_f32_e64 v17, v17, 0
    v_max_f32_e64 v18, v18, 0
    v_max_f32_e64 v19, v19, 0
    v_add_f32_e64 v11, v11, s67
    v_add_f32_e64 v12, v12, s67
    v_add_f32_e64 v13, v13, s67
    v_add_f32_e64 v14, v14, s67
    v_add_f32_e64 v16, v16, v11
    v_add_f32_e64 v17, v17, v12
    v_add_f32_e64 v18, v18, v13
    v_add_f32_e64 v19, v19, v14
    v_cvt_pk_bf16_f32 v16, v16, v17
    v_cvt_pk_bf16_f32 v17, v18, v19
    v_mul_f32_e64 v11, v20, s66
    v_mul_f32_e64 v12, v21, s66
    v_mul_f32_e64 v13, v22, s66
    v_mul_f32_e64 v14, v23, s66
    v_exp_f32_e64 v11, v11 clamp
    v_exp_f32_e64 v12, v12 clamp
    v_exp_f32_e64 v13, v13 clamp
    v_exp_f32_e64 v14, v14 clamp
    v_max_f32_e64 v20, v20, 0
    v_max_f32_e64 v21, v21, 0
    v_max_f32_e64 v22, v22, 0
    v_max_f32_e64 v23, v23, 0
    v_add_f32_e64 v11, v11, s67
    v_add_f32_e64 v12, v12, s67
    v_add_f32_e64 v13, v13, s67
    v_add_f32_e64 v14, v14, s67
    v_add_f32_e64 v20, v20, v11
    v_add_f32_e64 v21, v21, v12
    v_add_f32_e64 v22, v22, v13
    v_add_f32_e64 v23, v23, v14
    v_cvt_pk_bf16_f32 v18, v20, v21
    v_cvt_pk_bf16_f32 v19, v22, v23
    ds_write_b128 v8, v[16:19] offset:0
    v_mul_f32_e64 v11, v24, s66
    v_mul_f32_e64 v12, v25, s66
    v_mul_f32_e64 v13, v26, s66
    v_mul_f32_e64 v14, v27, s66
    v_exp_f32_e64 v11, v11 clamp
    v_exp_f32_e64 v12, v12 clamp
    v_exp_f32_e64 v13, v13 clamp
    v_exp_f32_e64 v14, v14 clamp
    v_max_f32_e64 v24, v24, 0
    v_max_f32_e64 v25, v25, 0
    v_max_f32_e64 v26, v26, 0
    v_max_f32_e64 v27, v27, 0
    v_add_f32_e64 v11, v11, s67
    v_add_f32_e64 v12, v12, s67
    v_add_f32_e64 v13, v13, s67
    v_add_f32_e64 v14, v14, s67
    v_add_f32_e64 v24, v24, v11
    v_add_f32_e64 v25, v25, v12
    v_add_f32_e64 v26, v26, v13
    v_add_f32_e64 v27, v27, v14
    v_cvt_pk_bf16_f32 v20, v24, v25
    v_cvt_pk_bf16_f32 v21, v26, v27
    v_mul_f32_e64 v11, v28, s66
    v_mul_f32_e64 v12, v29, s66
    v_mul_f32_e64 v13, v30, s66
    v_mul_f32_e64 v14, v31, s66
    v_exp_f32_e64 v11, v11 clamp
    v_exp_f32_e64 v12, v12 clamp
    v_exp_f32_e64 v13, v13 clamp
    v_exp_f32_e64 v14, v14 clamp
    v_max_f32_e64 v28, v28, 0
    v_max_f32_e64 v29, v29, 0
    v_max_f32_e64 v30, v30, 0
    v_max_f32_e64 v31, v31, 0
    v_add_f32_e64 v11, v11, s67
    v_add_f32_e64 v12, v12, s67
    v_add_f32_e64 v13, v13, s67
    v_add_f32_e64 v14, v14, s67
    v_add_f32_e64 v28, v28, v11
    v_add_f32_e64 v29, v29, v12
    v_add_f32_e64 v30, v30, v13
    v_add_f32_e64 v31, v31, v14
    v_cvt_pk_bf16_f32 v22, v28, v29
    v_cvt_pk_bf16_f32 v23, v30, v31
    ds_write_b128 v8, v[20:23] offset:32
    v_mul_f32_e64 v11, v32, s66
    v_mul_f32_e64 v12, v33, s66
    v_mul_f32_e64 v13, v34, s66
    v_mul_f32_e64 v14, v35, s66
    v_exp_f32_e64 v11, v11 clamp
    v_exp_f32_e64 v12, v12 clamp
    v_exp_f32_e64 v13, v13 clamp
    v_exp_f32_e64 v14, v14 clamp
    v_max_f32_e64 v32, v32, 0
    v_max_f32_e64 v33, v33, 0
    v_max_f32_e64 v34, v34, 0
    v_max_f32_e64 v35, v35, 0
    v_add_f32_e64 v11, v11, s67
    v_add_f32_e64 v12, v12, s67
    v_add_f32_e64 v13, v13, s67
    v_add_f32_e64 v14, v14, s67
    v_add_f32_e64 v32, v32, v11
    v_add_f32_e64 v33, v33, v12
    v_add_f32_e64 v34, v34, v13
    v_add_f32_e64 v35, v35, v14
    v_cvt_pk_bf16_f32 v32, v32, v33
    v_cvt_pk_bf16_f32 v33, v34, v35
    v_mul_f32_e64 v11, v36, s66
    v_mul_f32_e64 v12, v37, s66
    v_mul_f32_e64 v13, v38, s66
    v_mul_f32_e64 v14, v39, s66
    v_exp_f32_e64 v11, v11 clamp
    v_exp_f32_e64 v12, v12 clamp
    v_exp_f32_e64 v13, v13 clamp
    v_exp_f32_e64 v14, v14 clamp
    v_max_f32_e64 v36, v36, 0
    v_max_f32_e64 v37, v37, 0
    v_max_f32_e64 v38, v38, 0
    v_max_f32_e64 v39, v39, 0
    v_add_f32_e64 v11, v11, s67
    v_add_f32_e64 v12, v12, s67
    v_add_f32_e64 v13, v13, s67
    v_add_f32_e64 v14, v14, s67
    v_add_f32_e64 v36, v36, v11
    v_add_f32_e64 v37, v37, v12
    v_add_f32_e64 v38, v38, v13
    v_add_f32_e64 v39, v39, v14
    v_cvt_pk_bf16_f32 v34, v36, v37
    v_cvt_pk_bf16_f32 v35, v38, v39
    ds_write_b128 v8, v[32:35] offset:8704
    v_mul_f32_e64 v11, v40, s66
    v_mul_f32_e64 v12, v41, s66
    v_mul_f32_e64 v13, v42, s66
    v_mul_f32_e64 v14, v43, s66
    v_exp_f32_e64 v11, v11 clamp
    v_exp_f32_e64 v12, v12 clamp
    v_exp_f32_e64 v13, v13 clamp
    v_exp_f32_e64 v14, v14 clamp
    v_max_f32_e64 v40, v40, 0
    v_max_f32_e64 v41, v41, 0
    v_max_f32_e64 v42, v42, 0
    v_max_f32_e64 v43, v43, 0
    v_add_f32_e64 v11, v11, s67
    v_add_f32_e64 v12, v12, s67
    v_add_f32_e64 v13, v13, s67
    v_add_f32_e64 v14, v14, s67
    v_add_f32_e64 v40, v40, v11
    v_add_f32_e64 v41, v41, v12
    v_add_f32_e64 v42, v42, v13
    v_add_f32_e64 v43, v43, v14
    v_cvt_pk_bf16_f32 v36, v40, v41
    v_cvt_pk_bf16_f32 v37, v42, v43
    v_mul_f32_e64 v11, v44, s66
    v_mul_f32_e64 v12, v45, s66
    v_mul_f32_e64 v13, v46, s66
    v_mul_f32_e64 v14, v47, s66
    v_exp_f32_e64 v11, v11 clamp
    v_exp_f32_e64 v12, v12 clamp
    v_exp_f32_e64 v13, v13 clamp
    v_exp_f32_e64 v14, v14 clamp
    v_max_f32_e64 v44, v44, 0
    v_max_f32_e64 v45, v45, 0
    v_max_f32_e64 v46, v46, 0
    v_max_f32_e64 v47, v47, 0
    v_add_f32_e64 v11, v11, s67
    v_add_f32_e64 v12, v12, s67
    v_add_f32_e64 v13, v13, s67
    v_add_f32_e64 v14, v14, s67
    v_add_f32_e64 v44, v44, v11
    v_add_f32_e64 v45, v45, v12
    v_add_f32_e64 v46, v46, v13
    v_add_f32_e64 v47, v47, v14
    v_cvt_pk_bf16_f32 v38, v44, v45
    v_cvt_pk_bf16_f32 v39, v46, v47
    ds_write_b128 v8, v[36:39] offset:8736
    v_mul_f32_e64 v11, v48, s66
    v_mul_f32_e64 v12, v49, s66
    v_mul_f32_e64 v13, v50, s66
    v_mul_f32_e64 v14, v51, s66
    v_exp_f32_e64 v11, v11 clamp
    v_exp_f32_e64 v12, v12 clamp
    v_exp_f32_e64 v13, v13 clamp
    v_exp_f32_e64 v14, v14 clamp
    v_add_f32_e64 v11, v11, s67
    v_add_f32_e64 v12, v12, s67
    v_add_f32_e64 v13, v13, s67
    v_add_f32_e64 v14, v14, s67
    v_max_f32_e64 v15, v48, 0
    v_add_f32_e64 v11, v15, v11
    v_max_f32_e64 v15, v49, 0
    v_add_f32_e64 v12, v15, v12
    v_max_f32_e64 v15, v50, 0
    v_add_f32_e64 v13, v15, v13
    v_max_f32_e64 v15, v51, 0
    v_add_f32_e64 v14, v15, v14
    v_cndmask_b32_e64 v48, v11, v48, vcc
    v_cndmask_b32_e64 v49, v12, v49, vcc
    v_cndmask_b32_e64 v50, v13, v50, vcc
    v_cndmask_b32_e64 v51, v14, v51, vcc
    v_cvt_pk_bf16_f32 v48, v48, v49
    v_cvt_pk_bf16_f32 v49, v50, v51
    v_mul_f32_e64 v11, v52, s66
    v_mul_f32_e64 v12, v53, s66
    v_mul_f32_e64 v13, v54, s66
    v_mul_f32_e64 v14, v55, s66
    v_exp_f32_e64 v11, v11 clamp
    v_exp_f32_e64 v12, v12 clamp
    v_exp_f32_e64 v13, v13 clamp
    v_exp_f32_e64 v14, v14 clamp
    v_add_f32_e64 v11, v11, s67
    v_add_f32_e64 v12, v12, s67
    v_add_f32_e64 v13, v13, s67
    v_add_f32_e64 v14, v14, s67
    v_max_f32_e64 v15, v52, 0
    v_add_f32_e64 v11, v15, v11
    v_max_f32_e64 v15, v53, 0
    v_add_f32_e64 v12, v15, v12
    v_max_f32_e64 v15, v54, 0
    v_add_f32_e64 v13, v15, v13
    v_max_f32_e64 v15, v55, 0
    v_add_f32_e64 v14, v15, v14
    v_cndmask_b32_e64 v52, v11, v52, vcc
    v_cndmask_b32_e64 v53, v12, v53, vcc
    v_cndmask_b32_e64 v54, v13, v54, vcc
    v_cndmask_b32_e64 v55, v14, v55, vcc
    v_cvt_pk_bf16_f32 v50, v52, v53
    v_cvt_pk_bf16_f32 v51, v54, v55
    ds_write_b128 v8, v[48:51] offset:17408
    v_mul_f32_e64 v11, v56, s66
    v_mul_f32_e64 v12, v57, s66
    v_mul_f32_e64 v13, v58, s66
    v_mul_f32_e64 v14, v59, s66
    v_exp_f32_e64 v11, v11 clamp
    v_exp_f32_e64 v12, v12 clamp
    v_exp_f32_e64 v13, v13 clamp
    v_exp_f32_e64 v14, v14 clamp
    v_add_f32_e64 v11, v11, s67
    v_add_f32_e64 v12, v12, s67
    v_add_f32_e64 v13, v13, s67
    v_add_f32_e64 v14, v14, s67
    v_max_f32_e64 v15, v56, 0
    v_add_f32_e64 v11, v15, v11
    v_max_f32_e64 v15, v57, 0
    v_add_f32_e64 v12, v15, v12
    v_max_f32_e64 v15, v58, 0
    v_add_f32_e64 v13, v15, v13
    v_max_f32_e64 v15, v59, 0
    v_add_f32_e64 v14, v15, v14
    v_cndmask_b32_e64 v56, v11, v56, vcc
    v_cndmask_b32_e64 v57, v12, v57, vcc
    v_cndmask_b32_e64 v58, v13, v58, vcc
    v_cndmask_b32_e64 v59, v14, v59, vcc
    v_cvt_pk_bf16_f32 v52, v56, v57
    v_cvt_pk_bf16_f32 v53, v58, v59
    v_mul_f32_e64 v11, v60, s66
    v_mul_f32_e64 v12, v61, s66
    v_mul_f32_e64 v13, v62, s66
    v_mul_f32_e64 v14, v63, s66
    v_exp_f32_e64 v11, v11 clamp
    v_exp_f32_e64 v12, v12 clamp
    v_exp_f32_e64 v13, v13 clamp
    v_exp_f32_e64 v14, v14 clamp
    v_add_f32_e64 v11, v11, s67
    v_add_f32_e64 v12, v12, s67
    v_add_f32_e64 v13, v13, s67
    v_add_f32_e64 v14, v14, s67
    v_max_f32_e64 v15, v60, 0
    v_add_f32_e64 v11, v15, v11
    v_max_f32_e64 v15, v61, 0
    v_add_f32_e64 v12, v15, v12
    v_max_f32_e64 v15, v62, 0
    v_add_f32_e64 v13, v15, v13
    v_max_f32_e64 v15, v63, 0
    v_add_f32_e64 v14, v15, v14
    v_cndmask_b32_e64 v60, v11, v60, vcc
    v_cndmask_b32_e64 v61, v12, v61, vcc
    v_cndmask_b32_e64 v62, v13, v62, vcc
    v_cndmask_b32_e64 v63, v14, v63, vcc
    v_cvt_pk_bf16_f32 v54, v60, v61
    v_cvt_pk_bf16_f32 v55, v62, v63
    ds_write_b128 v8, v[52:55] offset:17440
    v_cvt_pk_bf16_f32 v64, v64, v65
    v_cvt_pk_bf16_f32 v65, v66, v67
    v_cvt_pk_bf16_f32 v66, v68, v69
    v_cvt_pk_bf16_f32 v67, v70, v71
    ds_write_b128 v8, v[64:67] offset:26112
    v_cvt_pk_bf16_f32 v68, v72, v73
    v_cvt_pk_bf16_f32 v69, v74, v75
    v_cvt_pk_bf16_f32 v70, v76, v77
    v_cvt_pk_bf16_f32 v71, v78, v79
    ds_write_b128 v8, v[68:71] offset:26144
    v_cvt_pk_bf16_f32 v80, v80, v81
    v_cvt_pk_bf16_f32 v81, v82, v83
    v_cvt_pk_bf16_f32 v82, v84, v85
    v_cvt_pk_bf16_f32 v83, v86, v87
    ds_write_b128 v8, v[80:83] offset:34816
    v_cvt_pk_bf16_f32 v84, v88, v89
    v_cvt_pk_bf16_f32 v85, v90, v91
    v_cvt_pk_bf16_f32 v86, v92, v93
    v_cvt_pk_bf16_f32 v87, v94, v95
    ds_write_b128 v8, v[84:87] offset:34848
    v_and_b32 v9, 31, v3
    v_lshrrev_b32 v10, 5, v3
    s_mul_i32 s71, s24, 5440
    s_add_u32 s71, s71, 81920
    v_add_u32 v0, s71, v0
    v_add_u32 v1, 21760, v0
    v_lshlrev_b32 v8, 4, v10
    v_add_u32 v8, 4096, v8
    v_cmp_lt_u32 vcc, 19, v9
    v_lshlrev_b32 v11, 2, v9
    v_lshlrev_b32 v12, 7, v10
    v_cndmask_b32 v1, v1, v8, vcc
    v_add_u32 v11, v11, v12
    v_mov_b32 v13, 2130706432
    v_cmp_lt_u32 vcc, 20, v9
    s_lshl_b32 s71, s26, 2
    s_add_u32 s71, s71, s24
    v_cndmask_b32 v11, v11, v13, vcc
    v_cmp_lt_u32 vcc, 31, v3
    s_nop 1
    v_cndmask_b32 v12, v11, v13, vcc
    s_lshl_b32 s71, s71, 12
    s_add_u32 s71, s71, 17825792
    s_waitcnt vmcnt(4)
    s_mov_b32 s75, 0
    s_branch K1_pKC_c
K1_pKC_l:
    s_sleep 8
    buffer_load_dwordx4 a[244:247], off, s[96:99], 0 sc1
    s_add_u32 s75, s75, 1
    s_waitcnt vmcnt(0)
    s_cmp_ge_u32 s75, 0x20000
    s_cbranch_scc1 K1_pKC_ok
K1_pKC_c:
    v_accvgpr_read_b32 v15, a244
    s_nop 1
    v_readfirstlane_b32 s74, v15
    s_bfe_u32 s74, s74, 524288
    s_cmp_ge_u32 s74, 32
    s_cbranch_scc0 K1_pKC_l
K1_pKC_ok:
    s_waitcnt lgkmcnt(0)
    s_barrier
    ds_read_b128 v[16:19], v0 offset:0
    ds_read_b128 v[20:23], v1 offset:0
    ds_read_b128 v[24:27], v0 offset:32
    ds_read_b128 v[28:31], v1 offset:32
    ds_read_b128 v[32:35], v0 offset:64
    ds_read_b128 v[36:39], v1 offset:64
    ds_read_b128 v[40:43], v0 offset:96
    ds_read_b128 v[44:47], v1 offset:96
    ds_read_b128 v[48:51], v0 offset:128
    ds_read_b128 v[52:55], v1 offset:128
    ds_read_b128 v[56:59], v0 offset:160
    ds_read_b128 v[60:63], v1 offset:160
    ds_read_b128 v[64:67], v0 offset:192
    ds_read_b128 v[68:71], v1 offset:192
    ds_read_b128 v[72:75], v0 offset:224
    ds_read_b128 v[76:79], v1 offset:224
    s_waitcnt lgkmcnt(14)
    v_mfma_f32_32x32x16_bf16 v[80:95], v[16:19], v[20:23], 0
    s_waitcnt lgkmcnt(12)
    v_mfma_f32_32x32x16_bf16 v[80:95], v[24:27], v[28:31], v[80:95]
    s_waitcnt lgkmcnt(10)
    v_mfma_f32_32x32x16_bf16 v[80:95], v[32:35], v[36:39], v[80:95]
    s_waitcnt lgkmcnt(8)
    v_mfma_f32_32x32x16_bf16 v[80:95], v[40:43], v[44:47], v[80:95]
    s_waitcnt lgkmcnt(6)
    v_mfma_f32_32x32x16_bf16 v[80:95], v[48:51], v[52:55], v[80:95]
    s_waitcnt lgkmcnt(4)
    v_mfma_f32_32x32x16_bf16 v[80:95], v[56:59], v[60:63], v[80:95]
    s_waitcnt lgkmcnt(2)
    v_mfma_f32_32x32x16_bf16 v[80:95], v[64:67], v[68:71], v[80:95]
    s_waitcnt lgkmcnt(0)
    v_mfma_f32_32x32x16_bf16 v[80:95], v[72:75], v[76:79], v[80:95]
    s_nop 7
    s_nop 7
    buffer_atomic_add_f32 v80, v11, s[16:19], s71 offen offset:0 sc1
    buffer_atomic_add_f32 v81, v11, s[16:19], s71 offen offset:256 sc1
    buffer_atomic_add_f32 v82, v11, s[16:19], s71 offen offset:512 sc1
    buffer_atomic_add_f32 v83, v11, s[16:19], s71 offen offset:768 sc1
    buffer_atomic_add_f32 v84, v11, s[16:19], s71 offen offset:1024 sc1
    buffer_atomic_add_f32 v85, v11, s[16:19], s71 offen offset:1280 sc1
    buffer_atomic_add_f32 v86, v11, s[16:19], s71 offen offset:1536 sc1
    buffer_atomic_add_f32 v87, v11, s[16:19], s71 offen offset:1792 sc1
    buffer_atomic_add_f32 v88, v12, s[16:19], s71 offen offset:2048 sc1
    buffer_atomic_add_f32 v89, v12, s[16:19], s71 offen offset:2304 sc1
    buffer_atomic_add_f32 v90, v12, s[16:19], s71 offen offset:2560 sc1
    buffer_atomic_add_f32 v91, v12, s[16:19], s71 offen offset:2816 sc1
    s_cmp_ge_u32 s72, 5
    s_cbranch_scc1 K1_D
    v_mbcnt_lo_u32_b32 v12, -1, 0
    v_mbcnt_hi_u32_b32 v12, -1, v12
    v_bfe_u32 v13, v12, 2, 2
    v_lshrrev_b32 v9, 5, v12
    v_lshl_add_u32 v9, v9, 3, v13
    v_lshlrev_b32 v9, 7, v9
    v_bfe_u32 v13, v12, 3, 1
    v_lshl_add_u32 v9, v13, 6, v9
    v_bfe_u32 v13, v12, 4, 1
    v_lshl_add_u32 v9, v13, 5, v9
    v_and_b32 v13, 3, v12
    v_lshl_add_u32 v9, v13, 3, v9
    v_xor_b32 v10, 64, v9
    s_nop 3
    v_accvgpr_read_b32 v80, a96
    v_accvgpr_read_b32 v81, a97
    v_accvgpr_read_b32 v82, a98
    v_accvgpr_read_b32 v83, a99
    v_accvgpr_read_b32 v84, a100
    v_accvgpr_read_b32 v85, a101
    v_accvgpr_read_b32 v86, a102
    v_accvgpr_read_b32 v87, a103
    v_accvgpr_read_b32 v88, a104
    v_accvgpr_read_b32 v89, a105
    v_accvgpr_read_b32 v90, a106
    v_accvgpr_read_b32 v91, a107
    v_add_f32 v84, v84, v88
    v_add_f32 v85, v85, v89
    v_add_f32 v86, v86, v90
    v_add_f32 v87, v87, v91
    v_and_b32 v13, 16, v3
    v_cmp_ne_u32 vcc, 0, v13
    v_and_b32 v13, 1, v3
    v_cmp_ne_u32 s[74:75], 0, v13
    v_cndmask_b32 v11, v80, v81, vcc
    v_cndmask_b32 v12, v82, v83, vcc
    v_and_b32 v13, 2, v3
    v_cmp_ne_u32 vcc, 0, v13
    v_cndmask_b32 v84, v84, v85, s[74:75]
    v_cndmask_b32 v86, v86, v87, s[74:75]
    v_cndmask_b32 v2, v84, v86, vcc
    v_mov_b32 v3, v2
    s_nop 1
    v_permlane32_swap_b32 v2, v3
    v_mul_f32 v12, 0x3acccccd, v12
    v_add_f32 v2, v2, v3
    v_mul_f32 v2, 0x3acccccd, v2
    v_fma_f32 v2, -v12, v12, v2
    v_max_f32 v2, 0, v2
    v_add_f32 v2, 0x3727c5ac, v2
    v_sqrt_f32 v13, v2
    v_mul_f32 v11, s66, v11
    v_exp_f32 v14, v11
    v_exp_f32_e64 v11, -v11
    v_rcp_f32 v15, v13
    v_add_f32 v14, 1.0, v14
    v_add_f32 v11, 1.0, v11
    v_min_f32 v14, 0x6f000000, v14
    v_rcp_f32 v11, v11
    v_mul_f32 v3, v14, v13
    v_mul_f32 v1, 0xc0135761, v15
    v_mul_f32 v2, v15, v15
    v_mul_f32 v2, v2, v1
    v_mul_f32 v2, 0x3d372713, v2
    v_mbcnt_lo_u32_b32 v14, -1, 0
    v_mbcnt_hi_u32_b32 v14, -1, v14
    v_cmp_gt_u32 vcc, 32, v14
    v_and_b32 v14, 31, v14
    v_lshlrev_b32 v14, 2, v14
    buffer_store_dword v11, v14, s[16:19], s69 offen sc1
    v_and_b32 v15, 0xffff0000, v13
    v_sub_f32 v13, v13, v15
    v_cndmask_b32 v13, v13, v15, vcc
    v_lshrrev_b32 v13, 16, v13
    v_accvgpr_write_b32 a80, v13
    v_accvgpr_read_b32 v0, a116
    v_sub_f32 v80, 0, v12
    v_sub_f32 v81, 0, v12
    v_sub_f32 v82, 0, v12
    v_sub_f32 v83, 0, v12
    v_sub_f32 v84, 0, v12
    v_sub_f32 v85, 0, v12
    v_sub_f32 v86, 0, v12
    v_sub_f32 v87, 0, v12
    v_sub_f32 v88, 0, v12
    v_sub_f32 v89, 0, v12
    v_sub_f32 v90, 0, v12
    v_sub_f32 v91, 0, v12
    v_sub_f32 v92, 0, v12
    v_sub_f32 v93, 0, v12
    v_sub_f32 v94, 0, v12
    v_sub_f32 v95, 0, v12
    v_add_u32 v8, 0x1000, v0
    s_nop 1
    v_mfma_f32_32x32x16_bf16 v[48:63], a[84:87], v[96:99], v[80:95]
    s_nop 1
    v_mfma_f32_32x32x16_bf16 v[48:63], a[88:91], v[100:103], v[48:63]
    v_mfma_f32_32x32x16_bf16 v[64:79], a[84:87], v[104:107], v[80:95]
    s_nop 9
    s_nop 5
    v_mfma_f32_32x32x16_bf16 v[64:79], a[88:91], v[108:111], v[64:79]
    v_cvt_pk_bf16_f32 v96, v48, v49
    v_cvt_pk_bf16_f32 v97, v50, v51
    v_cvt_pk_bf16_f32 v98, v52, v53
    v_cvt_pk_bf16_f32 v99, v54, v55
    v_cvt_pk_bf16_f32 v100, v56, v57
    v_cvt_pk_bf16_f32 v101, v58, v59
    v_cvt_pk_bf16_f32 v102, v60, v61
    v_cvt_pk_bf16_f32 v103, v62, v63
    v_mfma_f32_32x32x16_bf16 v[48:63], a[84:87], v[112:115], v[80:95]
    s_nop 1
    v_mfma_f32_32x32x16_bf16 v[48:63], a[88:91], v[116:119], v[48:63]
    v_cvt_pk_bf16_f32 v104, v64, v65
    v_cvt_pk_bf16_f32 v105, v66, v67
    v_cvt_pk_bf16_f32 v106, v68, v69
    v_cvt_pk_bf16_f32 v107, v70, v71
    v_cvt_pk_bf16_f32 v108, v72, v73
    v_cvt_pk_bf16_f32 v109, v74, v75
    v_cvt_pk_bf16_f32 v110, v76, v77
    v_cvt_pk_bf16_f32 v111, v78, v79
    v_mfma_f32_32x32x16_bf16 v[64:79], a[84:87], v[120:123], v[80:95]
    s_nop 1
    v_mfma_f32_32x32x16_bf16 v[64:79], a[88:91], v[124:127], v[64:79]
    v_cvt_pk_bf16_f32 v112, v48, v49
    v_cvt_pk_bf16_f32 v113, v50, v51
    v_cvt_pk_bf16_f32 v114, v52, v53
    v_cvt_pk_bf16_f32 v115, v54, v55
    v_cvt_pk_bf16_f32 v116, v56, v57
    v_cvt_pk_bf16_f32 v117, v58, v59
    v_cvt_pk_bf16_f32 v118, v60, v61
    v_cvt_pk_bf16_f32 v119, v62, v63
    v_mfma_f32_32x32x16_bf16 v[48:63], a[84:87], v[128:131], v[80:95]
    s_nop 1
    v_mfma_f32_32x32x16_bf16 v[48:63], a[88:91], v[132:135], v[48:63]
    v_cvt_pk_bf16_f32 v120, v64, v65
    v_cvt_pk_bf16_f32 v121, v66, v67
    v_cvt_pk_bf16_f32 v122, v68, v69
    v_cvt_pk_bf16_f32 v123, v70, v71
    v_cvt_pk_bf16_f32 v124, v72, v73
    v_cvt_pk_bf16_f32 v125, v74, v75
    v_cvt_pk_bf16_f32 v126, v76, v77
    v_cvt_pk_bf16_f32 v127, v78, v79
    v_mfma_f32_32x32x16_bf16 v[64:79], a[84:87], v[136:139], v[80:95]
    s_nop 1
    v_mfma_f32_32x32x16_bf16 v[64:79], a[88:91], v[140:143], v[64:79]
    v_cvt_pk_bf16_f32 v128, v48, v49
    v_cvt_pk_bf16_f32 v129, v50, v51
    v_cvt_pk_bf16_f32 v130, v52, v53
    v_cvt_pk_bf16_f32 v131, v54, v55
    v_cvt_pk_bf16_f32 v132, v56, v57
    v_cvt_pk_bf16_f32 v133, v58, v59
    v_cvt_pk_bf16_f32 v134, v60, v61
    v_cvt_pk_bf16_f32 v135, v62, v63
    v_mfma_f32_32x32x16_bf16 v[48:63], a[84:87], v[144:147], v[80:95]
    s_nop 1
    v_mfma_f32_32x32x16_bf16 v[48:63], a[88:91], v[148:151], v[48:63]
    v_cvt_pk_bf16_f32 v136, v64, v65
    v_cvt_pk_bf16_f32 v137, v66, v67
    v_cvt_pk_bf16_f32 v138, v68, v69
    v_cvt_pk_bf16_f32 v139, v70, v71
    v_cvt_pk_bf16_f32 v140, v72, v73
    v_cvt_pk_bf16_f32 v141, v74, v75
    v_cvt_pk_bf16_f32 v142, v76, v77
    v_cvt_pk_bf16_f32 v143, v78, v79
    v_mfma_f32_32x32x16_bf16 v[64:79], a[84:87], v[152:155], v[80:95]
    s_nop 1
    v_mfma_f32_32x32x16_bf16 v[64:79], a[88:91], v[156:159], v[64:79]
    v_cvt_pk_bf16_f32 v144, v48, v49
    v_cvt_pk_bf16_f32 v145, v50, v51
    v_cvt_pk_bf16_f32 v146, v52, v53
    v_cvt_pk_bf16_f32 v147, v54, v55
    v_cvt_pk_bf16_f32 v148, v56, v57
    v_cvt_pk_bf16_f32 v149, v58, v59
    v_cvt_pk_bf16_f32 v150, v60, v61
    v_cvt_pk_bf16_f32 v151, v62, v63
    v_mfma_f32_32x32x16_bf16 v[48:63], a[84:87], v[160:163], v[80:95]
    s_nop 1
    v_mfma_f32_32x32x16_bf16 v[48:63], a[88:91], v[164:167], v[48:63]
    v_cvt_pk_bf16_f32 v152, v64, v65
    v_cvt_pk_bf16_f32 v153, v66, v67
    v_cvt_pk_bf16_f32 v154, v68, v69
    v_cvt_pk_bf16_f32 v155, v70, v71
    v_cvt_pk_bf16_f32 v156, v72, v73
    v_cvt_pk_bf16_f32 v157, v74, v75
    v_cvt_pk_bf16_f32 v158, v76, v77
    v_cvt_pk_bf16_f32 v159, v78, v79
    v_mfma_f32_32x32x16_bf16 v[64:79], a[84:87], v[168:171], v[80:95]
    s_nop 1
    v_mfma_f32_32x32x16_bf16 v[64:79], a[88:91], v[172:175], v[64:79]
    v_cvt_pk_bf16_f32 v160, v48, v49
    v_cvt_pk_bf16_f32 v161, v50, v51
    v_cvt_pk_bf16_f32 v162, v52, v53
    v_cvt_pk_bf16_f32 v163, v54, v55
    v_cvt_pk_bf16_f32 v164, v56, v57
    v_cvt_pk_bf16_f32 v165, v58, v59
    v_cvt_pk_bf16_f32 v166, v60, v61
    v_cvt_pk_bf16_f32 v167, v62, v63
    v_mfma_f32_32x32x16_bf16 v[48:63], a[84:87], v[176:179], v[80:95]
    s_nop 1
    v_mfma_f32_32x32x16_bf16 v[48:63], a[88:91], v[180:183], v[48:63]
    v_cvt_pk_bf16_f32 v168, v64, v65
    v_cvt_pk_bf16_f32 v169, v66, v67
    v_cvt_pk_bf16_f32 v170, v68, v69
    v_cvt_pk_bf16_f32 v171, v70, v71
    v_cvt_pk_bf16_f32 v172, v72, v73
    v_cvt_pk_bf16_f32 v173, v74, v75
    v_cvt_pk_bf16_f32 v174, v76, v77
    v_cvt_pk_bf16_f32 v175, v78, v79
    v_mfma_f32_32x32x16_bf16 v[64:79], a[84:87], v[184:187], v[80:95]
    s_nop 1
    v_mfma_f32_32x32x16_bf16 v[64:79], a[88:91], v[188:191], v[64:79]
    v_cvt_pk_bf16_f32 v176, v48, v49
    v_cvt_pk_bf16_f32 v177, v50, v51
    v_cvt_pk_bf16_f32 v178, v52, v53
    v_cvt_pk_bf16_f32 v179, v54, v55
    v_cvt_pk_bf16_f32 v180, v56, v57
    v_cvt_pk_bf16_f32 v181, v58, v59
    v_cvt_pk_bf16_f32 v182, v60, v61
    v_cvt_pk_bf16_f32 v183, v62, v63
    s_waitcnt vmcnt(1)
    s_barrier
    v_mov_b32 v15, 1
    s_mov_b64 exec, 1
    buffer_atomic_add v15, off, s[16:19], s31  offset:0 sc1
    s_mov_b64 exec, -1
    v_mfma_f32_32x32x16_bf16 v[48:63], a[84:87], v[192:195], v[80:95]
    s_nop 1
    v_mfma_f32_32x32x16_bf16 v[48:63], a[88:91], v[196:199], v[48:63]
    v_cvt_pk_bf16_f32 v184, v64, v65
    v_cvt_pk_bf16_f32 v185, v66, v67
    v_cvt_pk_bf16_f32 v186, v68, v69
    v_cvt_pk_bf16_f32 v187, v70, v71
    v_cvt_pk_bf16_f32 v188, v72, v73
    v_cvt_pk_bf16_f32 v189, v74, v75
    v_cvt_pk_bf16_f32 v190, v76, v77
    v_cvt_pk_bf16_f32 v191, v78, v79
    v_mfma_f32_32x32x16_bf16 v[64:79], a[84:87], v[200:203], v[80:95]
    s_nop 1
    v_mfma_f32_32x32x16_bf16 v[64:79], a[88:91], v[204:207], v[64:79]
    v_cvt_pk_bf16_f32 v192, v48, v49
    v_cvt_pk_bf16_f32 v193, v50, v51
    v_cvt_pk_bf16_f32 v194, v52, v53
    v_cvt_pk_bf16_f32 v195, v54, v55
    v_cvt_pk_bf16_f32 v196, v56, v57
    v_cvt_pk_bf16_f32 v197, v58, v59
    v_cvt_pk_bf16_f32 v198, v60, v61
    v_cvt_pk_bf16_f32 v199, v62, v63
    v_mfma_f32_32x32x16_bf16 v[48:63], a[84:87], v[208:211], v[80:95]
    s_nop 1
    v_mfma_f32_32x32x16_bf16 v[48:63], a[88:91], v[212:215], v[48:63]
    v_cvt_pk_bf16_f32 v200, v64, v65
    v_cvt_pk_bf16_f32 v201, v66, v67
    v_cvt_pk_bf16_f32 v202, v68, v69
    v_cvt_pk_bf16_f32 v203, v70, v71
    v_cvt_pk_bf16_f32 v204, v72, v73
    v_cvt_pk_bf16_f32 v205, v74, v75
    v_cvt_pk_bf16_f32 v206, v76, v77
    v_cvt_pk_bf16_f32 v207, v78, v79
    v_mfma_f32_32x32x16_bf16 v[64:79], a[84:87], v[216:219], v[80:95]
    s_nop 1
    v_mfma_f32_32x32x16_bf16 v[64:79], a[88:91], v[220:223], v[64:79]
    v_cvt_pk_bf16_f32 v208, v48, v49
    v_cvt_pk_bf16_f32 v209, v50, v51
    v_cvt_pk_bf16_f32 v210, v52, v53
    v_cvt_pk_bf16_f32 v211, v54, v55
    v_cvt_pk_bf16_f32 v212, v56, v57
    v_cvt_pk_bf16_f32 v213, v58, v59
    v_cvt_pk_bf16_f32 v214, v60, v61
    v_cvt_pk_bf16_f32 v215, v62, v63
    v_mfma_f32_32x32x16_bf16 v[48:63], a[84:87], v[224:227], v[80:95]
    s_nop 1
    v_mfma_f32_32x32x16_bf16 v[48:63], a[88:91], v[228:231], v[48:63]
    v_cvt_pk_bf16_f32 v216, v64, v65
    v_cvt_pk_bf16_f32 v217, v66, v67
    v_cvt_pk_bf16_f32 v218, v68, v69
    v_cvt_pk_bf16_f32 v219, v70, v71
    v_cvt_pk_bf16_f32 v220, v72, v73
    v_cvt_pk_bf16_f32 v221, v74, v75
    v_cvt_pk_bf16_f32 v222, v76, v77
    v_cvt_pk_bf16_f32 v223, v78, v79
    v_mfma_f32_32x32x16_bf16 v[64:79], a[84:87], v[232:235], v[80:95]
    s_nop 1
    v_mfma_f32_32x32x16_bf16 v[64:79], a[88:91], v[236:239], v[64:79]
    v_cvt_pk_bf16_f32 v224, v48, v49
    v_cvt_pk_bf16_f32 v225, v50, v51
    v_cvt_pk_bf16_f32 v226, v52, v53
    v_cvt_pk_bf16_f32 v227, v54, v55
    v_cvt_pk_bf16_f32 v228, v56, v57
    v_cvt_pk_bf16_f32 v229, v58, v59
    v_cvt_pk_bf16_f32 v230, v60, v61
    v_cvt_pk_bf16_f32 v231, v62, v63
    v_mfma_f32_32x32x16_bf16 v[48:63], a[84:87], v[240:243], v[80:95]
    s_nop 1
    v_mfma_f32_32x32x16_bf16 v[48:63], a[88:91], v[244:247], v[48:63]
    v_cvt_pk_bf16_f32 v232, v64, v65
    v_cvt_pk_bf16_f32 v233, v66, v67
    v_cvt_pk_bf16_f32 v234, v68, v69
    v_cvt_pk_bf16_f32 v235, v70, v71
    v_cvt_pk_bf16_f32 v236, v72, v73
    v_cvt_pk_bf16_f32 v237, v74, v75
    v_cvt_pk_bf16_f32 v238, v76, v77
    v_cvt_pk_bf16_f32 v239, v78, v79
    v_mfma_f32_32x32x16_bf16 v[64:79], a[84:87], v[248:251], v[80:95]
    s_nop 1
    v_mfma_f32_32x32x16_bf16 v[64:79], a[88:91], v[252:255], v[64:79]
    v_cvt_pk_bf16_f32 v240, v48, v49
    v_cvt_pk_bf16_f32 v241, v50, v51
    v_cvt_pk_bf16_f32 v242, v52, v53
    v_cvt_pk_bf16_f32 v243, v54, v55
    v_cvt_pk_bf16_f32 v244, v56, v57
    v_cvt_pk_bf16_f32 v245, v58, v59
    v_cvt_pk_bf16_f32 v246, v60, v61
    v_cvt_pk_bf16_f32 v247, v62, v63
    s_nop 9
    v_cvt_pk_bf16_f32 v248, v64, v65
    v_cvt_pk_bf16_f32 v249, v66, v67
    v_cvt_pk_bf16_f32 v250, v68, v69
    v_cvt_pk_bf16_f32 v251, v70, v71
    v_cvt_pk_bf16_f32 v252, v72, v73
    v_cvt_pk_bf16_f32 v253, v74, v75
    v_cvt_pk_bf16_f32 v254, v76, v77
    v_cvt_pk_bf16_f32 v255, v78, v79
    s_barrier
    v_add_u32 v9, 143360, v9
    ds_read_b64_tr_b16 a[32:33], v9 offset:0
    ds_read_b64_tr_b16 a[34:35], v9 offset:512
    ds_read_b64_tr_b16 a[36:37], v9 offset:2048
    ds_read_b64_tr_b16 a[38:39], v9 offset:2560
    ds_read_b64_tr_b16 a[40:41], v9 offset:4096
    ds_read_b64_tr_b16 a[42:43], v9 offset:4608
    ds_read_b64_tr_b16 a[44:45], v9 offset:6144
    ds_read_b64_tr_b16 a[46:47], v9 offset:6656
    ds_read_b64_tr_b16 a[0:1], v9 offset:8192
    ds_read_b64_tr_b16 a[2:3], v9 offset:8704
    ds_read_b64_tr_b16 a[4:5], v9 offset:10240
    ds_read_b64_tr_b16 a[6:7], v9 offset:10752
    s_waitcnt lgkmcnt(6)
    v_mfma_f32_32x32x16_bf16 v[16:31], a[64:67], a[80:83], 0
    ds_read_b64_tr_b16 a[8:9], v9 offset:12288
    ds_read_b64_tr_b16 a[10:11], v9 offset:12800
    v_mfma_f32_32x32x16_bf16 v[16:31], a[32:35], v[96:99], v[16:31]
    ds_read_b64_tr_b16 a[12:13], v9 offset:14336
    ds_read_b64_tr_b16 a[14:15], v9 offset:14848
    v_mfma_f32_32x32x16_bf16 v[16:31], a[36:39], v[100:103], v[16:31]
    s_barrier
    v_add_u32 v9, 4294844416, v9
    ds_read_b64_tr_b16 a[16:17], v9 offset:0
    ds_read_b64_tr_b16 a[18:19], v9 offset:512
    v_mfma_f32_32x32x16_bf16 v[16:31], a[40:43], v[104:107], v[16:31]
    ds_read_b64_tr_b16 a[20:21], v9 offset:2048
    ds_read_b64_tr_b16 a[22:23], v9 offset:2560
    s_waitcnt lgkmcnt(6)
    v_mfma_f32_32x32x16_bf16 v[16:31], a[44:47], v[108:111], v[16:31]
    ds_read_b64_tr_b16 a[24:25], v9 offset:4096
    ds_read_b64_tr_b16 a[26:27], v9 offset:4608
    v_mfma_f32_32x32x16_bf16 v[16:31], a[0:3], v[112:115], v[16:31]
    ds_read_b64_tr_b16 a[28:29], v9 offset:6144
    ds_read_b64_tr_b16 a[30:31], v9 offset:6656
    v_mfma_f32_32x32x16_bf16 v[16:31], a[4:7], v[116:119], v[16:31]
    ds_read_b64_tr_b16 a[32:33], v9 offset:8192
    ds_read_b64_tr_b16 a[34:35], v9 offset:8704
    v_mfma_f32_32x32x16_bf16 v[16:31], a[8:11], v[120:123], v[16:31]
    ds_read_b64_tr_b16 a[36:37], v9 offset:10240
    ds_read_b64_tr_b16 a[38:39], v9 offset:10752
    s_waitcnt lgkmcnt(6)
    v_mfma_f32_32x32x16_bf16 v[16:31], a[12:15], v[124:127], v[16:31]
    ds_read_b64_tr_b16 a[40:41], v9 offset:12288
    ds_read_b64_tr_b16 a[42:43], v9 offset:12800
    v_mfma_f32_32x32x16_bf16 v[16:31], a[16:19], v[128:131], v[16:31]
    ds_read_b64_tr_b16 a[44:45], v9 offset:14336
    ds_read_b64_tr_b16 a[46:47], v9 offset:14848
    v_mfma_f32_32x32x16_bf16 v[16:31], a[20:23], v[132:135], v[16:31]
    s_barrier
    ds_read_b64_tr_b16 a[0:1], v9 offset:20480
    ds_read_b64_tr_b16 a[2:3], v9 offset:20992
    v_mfma_f32_32x32x16_bf16 v[16:31], a[24:27], v[136:139], v[16:31]
    ds_read_b64_tr_b16 a[4:5], v9 offset:22528
    ds_read_b64_tr_b16 a[6:7], v9 offset:23040
    s_waitcnt lgkmcnt(6)
    v_mfma_f32_32x32x16_bf16 v[16:31], a[28:31], v[140:143], v[16:31]
    ds_read_b64_tr_b16 a[8:9], v9 offset:24576
    ds_read_b64_tr_b16 a[10:11], v9 offset:25088
    v_mfma_f32_32x32x16_bf16 v[16:31], a[32:35], v[144:147], v[16:31]
    ds_read_b64_tr_b16 a[12:13], v9 offset:26624
    ds_read_b64_tr_b16 a[14:15], v9 offset:27136
    v_mfma_f32_32x32x16_bf16 v[16:31], a[36:39], v[148:151], v[16:31]
    ds_read_b64_tr_b16 a[16:17], v9 offset:28672
    ds_read_b64_tr_b16 a[18:19], v9 offset:29184
    v_mfma_f32_32x32x16_bf16 v[16:31], a[40:43], v[152:155], v[16:31]
    ds_read_b64_tr_b16 a[20:21], v9 offset:30720
    ds_read_b64_tr_b16 a[22:23], v9 offset:31232
    s_waitcnt lgkmcnt(6)
    v_mfma_f32_32x32x16_bf16 v[16:31], a[44:47], v[156:159], v[16:31]
    ds_read_b64_tr_b16 a[24:25], v9 offset:32768
    ds_read_b64_tr_b16 a[26:27], v9 offset:33280
    v_mfma_f32_32x32x16_bf16 v[16:31], a[0:3], v[160:163], v[16:31]
    ds_read_b64_tr_b16 a[28:29], v9 offset:34816
    ds_read_b64_tr_b16 a[30:31], v9 offset:35328
    v_mfma_f32_32x32x16_bf16 v[16:31], a[4:7], v[164:167], v[16:31]
    s_barrier
    ds_read_b64_tr_b16 a[32:33], v9 offset:40960
    ds_read_b64_tr_b16 a[34:35], v9 offset:41472
    v_mfma_f32_32x32x16_bf16 v[16:31], a[8:11], v[168:171], v[16:31]
    ds_read_b64_tr_b16 a[36:37], v9 offset:43008
    ds_read_b64_tr_b16 a[38:39], v9 offset:43520
    s_waitcnt lgkmcnt(6)
    v_mfma_f32_32x32x16_bf16 v[16:31], a[12:15], v[172:175], v[16:31]
    ds_read_b64_tr_b16 a[40:41], v9 offset:45056
    ds_read_b64_tr_b16 a[42:43], v9 offset:45568
    v_mfma_f32_32x32x16_bf16 v[16:31], a[16:19], v[176:179], v[16:31]
    ds_read_b64_tr_b16 a[44:45], v9 offset:47104
    ds_read_b64_tr_b16 a[46:47], v9 offset:47616
    v_mfma_f32_32x32x16_bf16 v[16:31], a[20:23], v[180:183], v[16:31]
    ds_read_b64_tr_b16 a[0:1], v9 offset:49152
    ds_read_b64_tr_b16 a[2:3], v9 offset:49664
    v_mfma_f32_32x32x16_bf16 v[16:31], a[24:27], v[184:187], v[16:31]
    ds_read_b64_tr_b16 a[4:5], v9 offset:51200
    ds_read_b64_tr_b16 a[6:7], v9 offset:51712
    s_waitcnt lgkmcnt(6)
    v_mfma_f32_32x32x16_bf16 v[16:31], a[28:31], v[188:191], v[16:31]
    ds_read_b64_tr_b16 a[8:9], v9 offset:53248
    ds_read_b64_tr_b16 a[10:11], v9 offset:53760
    v_mfma_f32_32x32x16_bf16 v[16:31], a[32:35], v[192:195], v[16:31]
    ds_read_b64_tr_b16 a[12:13], v9 offset:55296
    ds_read_b64_tr_b16 a[14:15], v9 offset:55808
    v_mfma_f32_32x32x16_bf16 v[16:31], a[36:39], v[196:199], v[16:31]
    s_barrier
    v_add_u32 v9, 106496, v9
    ds_read_b64_tr_b16 a[16:17], v9 offset:0
    ds_read_b64_tr_b16 a[18:19], v9 offset:512
    v_mfma_f32_32x32x16_bf16 v[16:31], a[40:43], v[200:203], v[16:31]
    ds_read_b64_tr_b16 a[20:21], v9 offset:2048
    ds_read_b64_tr_b16 a[22:23], v9 offset:2560
    s_waitcnt lgkmcnt(6)
    v_mfma_f32_32x32x16_bf16 v[16:31], a[44:47], v[204:207], v[16:31]
    ds_read_b64_tr_b16 a[24:25], v9 offset:4096
    ds_read_b64_tr_b16 a[26:27], v9 offset:4608
    v_mfma_f32_32x32x16_bf16 v[16:31], a[0:3], v[208:211], v[16:31]
    ds_read_b64_tr_b16 a[28:29], v9 offset:6144
    ds_read_b64_tr_b16 a[30:31], v9 offset:6656
    v_mfma_f32_32x32x16_bf16 v[16:31], a[4:7], v[212:215], v[16:31]
    ds_read_b64_tr_b16 a[32:33], v9 offset:8192
    ds_read_b64_tr_b16 a[34:35], v9 offset:8704
    v_mfma_f32_32x32x16_bf16 v[16:31], a[8:11], v[216:219], v[16:31]
    ds_read_b64_tr_b16 a[36:37], v9 offset:10240
    ds_read_b64_tr_b16 a[38:39], v9 offset:10752
    s_waitcnt lgkmcnt(6)
    v_mfma_f32_32x32x16_bf16 v[16:31], a[12:15], v[220:223], v[16:31]
    ds_read_b64_tr_b16 a[40:41], v9 offset:12288
    ds_read_b64_tr_b16 a[42:43], v9 offset:12800
    v_mfma_f32_32x32x16_bf16 v[16:31], a[16:19], v[224:227], v[16:31]
    ds_read_b64_tr_b16 a[44:45], v9 offset:14336
    ds_read_b64_tr_b16 a[46:47], v9 offset:14848
    v_mfma_f32_32x32x16_bf16 v[16:31], a[20:23], v[228:231], v[16:31]
    v_mfma_f32_32x32x16_bf16 v[16:31], a[24:27], v[232:235], v[16:31]
    v_add_u32 v10, 143360, v10
    ds_read_b64_tr_b16 a[0:1], v10 offset:0
    ds_read_b64_tr_b16 a[2:3], v10 offset:512
    s_waitcnt lgkmcnt(4)
    v_mfma_f32_32x32x16_bf16 v[16:31], a[28:31], v[236:239], v[16:31]
    ds_read_b64_tr_b16 a[4:5], v10 offset:2048
    ds_read_b64_tr_b16 a[6:7], v10 offset:2560
    v_mfma_f32_32x32x16_bf16 v[16:31], a[32:35], v[240:243], v[16:31]
    ds_read_b64_tr_b16 a[8:9], v10 offset:4096
    ds_read_b64_tr_b16 a[10:11], v10 offset:4608
    v_mfma_f32_32x32x16_bf16 v[16:31], a[36:39], v[244:247], v[16:31]
    ds_read_b64_tr_b16 a[12:13], v10 offset:6144
    ds_read_b64_tr_b16 a[14:15], v10 offset:6656
    v_mfma_f32_32x32x16_bf16 v[16:31], a[40:43], v[248:251], v[16:31]
    ds_read_b64_tr_b16 a[16:17], v10 offset:8192
    ds_read_b64_tr_b16 a[18:19], v10 offset:8704
    s_waitcnt lgkmcnt(6)
    v_mfma_f32_32x32x16_bf16 v[16:31], a[44:47], v[252:255], v[16:31]
    ds_read_b64_tr_b16 a[20:21], v10 offset:10240
    ds_read_b64_tr_b16 a[22:23], v10 offset:10752
    v_mfma_f32_32x32x16_bf16 v[32:47], a[66:69], a[80:83], 0
    ds_read_b64_tr_b16 a[24:25], v10 offset:12288
    ds_read_b64_tr_b16 a[26:27], v10 offset:12800
    v_mfma_f32_32x32x16_bf16 v[32:47], a[0:3], v[96:99], v[32:47]
    ds_read_b64_tr_b16 a[28:29], v10 offset:14336
    ds_read_b64_tr_b16 a[30:31], v10 offset:14848
    v_mfma_f32_32x32x16_bf16 v[32:47], a[4:7], v[100:103], v[32:47]
    v_add_u32 v10, 4294844416, v10
    ds_read_b64_tr_b16 a[32:33], v10 offset:0
    ds_read_b64_tr_b16 a[34:35], v10 offset:512
    s_waitcnt lgkmcnt(6)
    v_mfma_f32_32x32x16_bf16 v[32:47], a[8:11], v[104:107], v[32:47]
    ds_read_b64_tr_b16 a[36:37], v10 offset:2048
    ds_read_b64_tr_b16 a[38:39], v10 offset:2560
    v_mfma_f32_32x32x16_bf16 v[32:47], a[12:15], v[108:111], v[32:47]
    ds_read_b64_tr_b16 a[40:41], v10 offset:4096
    ds_read_b64_tr_b16 a[42:43], v10 offset:4608
    v_mfma_f32_32x32x16_bf16 v[32:47], a[16:19], v[112:115], v[32:47]
    ds_read_b64_tr_b16 a[44:45], v10 offset:6144
    ds_read_b64_tr_b16 a[46:47], v10 offset:6656
    v_mfma_f32_32x32x16_bf16 v[32:47], a[20:23], v[116:119], v[32:47]
    ds_read_b64_tr_b16 a[0:1], v10 offset:8192
    ds_read_b64_tr_b16 a[2:3], v10 offset:8704
    s_waitcnt lgkmcnt(6)
    v_mfma_f32_32x32x16_bf16 v[32:47], a[24:27], v[120:123], v[32:47]
    ds_read_b64_tr_b16 a[4:5], v10 offset:10240
    ds_read_b64_tr_b16 a[6:7], v10 offset:10752
    v_mul_f32_e64 v11, v16, v16
    v_mul_f32_e64 v12, v17, v17
    v_mul_f32_e64 v13, v18, v18
    v_mul_f32_e64 v14, v19, v19
    v_mfma_f32_32x32x16_bf16 v[32:47], a[28:31], v[124:127], v[32:47]
    ds_read_b64_tr_b16 a[8:9], v10 offset:12288
    ds_read_b64_tr_b16 a[10:11], v10 offset:12800
    v_fma_f32 v11, v11, v2, v1
    v_fma_f32 v12, v12, v2, v1
    v_fma_f32 v13, v13, v2, v1
    v_fma_f32 v14, v14, v2, v1
    v_mfma_f32_32x32x16_bf16 v[32:47], a[32:35], v[128:131], v[32:47]
    ds_read_b64_tr_b16 a[12:13], v10 offset:14336
    ds_read_b64_tr_b16 a[14:15], v10 offset:14848
    v_mul_f32_e64 v11, v16, v11
    v_mul_f32_e64 v12, v17, v12
    v_mul_f32_e64 v13, v18, v13
    v_mul_f32_e64 v14, v19, v14
    v_mfma_f32_32x32x16_bf16 v[32:47], a[36:39], v[132:135], v[32:47]
    ds_read_b64_tr_b16 a[16:17], v10 offset:20480
    ds_read_b64_tr_b16 a[18:19], v10 offset:20992
    v_exp_f32_e64 v11, v11
    v_exp_f32_e64 v12, v12
    v_exp_f32_e64 v13, v13
    v_exp_f32_e64 v14, v14
    s_waitcnt lgkmcnt(6)
    v_mfma_f32_32x32x16_bf16 v[32:47], a[40:43], v[136:139], v[32:47]
    ds_read_b64_tr_b16 a[20:21], v10 offset:22528
    ds_read_b64_tr_b16 a[22:23], v10 offset:23040
    v_fma_f32 v11, v11, v3, v3
    v_fma_f32 v12, v12, v3, v3
    v_fma_f32 v13, v13, v3, v3
    v_fma_f32 v14, v14, v3, v3
    v_mfma_f32_32x32x16_bf16 v[32:47], a[44:47], v[140:143], v[32:47]
    ds_read_b64_tr_b16 a[24:25], v10 offset:24576
    ds_read_b64_tr_b16 a[26:27], v10 offset:25088
    v_rcp_f32_e64 v11, v11
    v_rcp_f32_e64 v12, v12
    v_rcp_f32_e64 v13, v13
    v_rcp_f32_e64 v14, v14
    v_mfma_f32_32x32x16_bf16 v[32:47], a[0:3], v[144:147], v[32:47]
    ds_read_b64_tr_b16 a[28:29], v10 offset:26624
    ds_read_b64_tr_b16 a[30:31], v10 offset:27136
    v_mul_f32_e64 v16, v16, v11
    v_mul_f32_e64 v17, v17, v12
    v_mul_f32_e64 v18, v18, v13
    v_mul_f32_e64 v19, v19, v14
    v_mfma_f32_32x32x16_bf16 v[32:47], a[4:7], v[148:151], v[32:47]
    ds_read_b64_tr_b16 a[32:33], v10 offset:28672
    ds_read_b64_tr_b16 a[34:35], v10 offset:29184
    v_cvt_pk_bf16_f32 v16, v16, v17
    v_cvt_pk_bf16_f32 v17, v18, v19
    v_mul_f32_e64 v11, v20, v20
    v_mul_f32_e64 v12, v21, v21
    s_waitcnt lgkmcnt(6)
    v_mfma_f32_32x32x16_bf16 v[32:47], a[8:11], v[152:155], v[32:47]
    ds_read_b64_tr_b16 a[36:37], v10 offset:30720
    ds_read_b64_tr_b16 a[38:39], v10 offset:31232
    v_mul_f32_e64 v13, v22, v22
    v_mul_f32_e64 v14, v23, v23
    v_fma_f32 v11, v11, v2, v1
    v_fma_f32 v12, v12, v2, v1
    v_mfma_f32_32x32x16_bf16 v[32:47], a[12:15], v[156:159], v[32:47]
    ds_read_b64_tr_b16 a[40:41], v10 offset:32768
    ds_read_b64_tr_b16 a[42:43], v10 offset:33280
    v_fma_f32 v13, v13, v2, v1
    v_fma_f32 v14, v14, v2, v1
    v_mul_f32_e64 v11, v20, v11
    v_mul_f32_e64 v12, v21, v12
    v_mfma_f32_32x32x16_bf16 v[32:47], a[16:19], v[160:163], v[32:47]
    ds_read_b64_tr_b16 a[44:45], v10 offset:34816
    ds_read_b64_tr_b16 a[46:47], v10 offset:35328
    v_mul_f32_e64 v13, v22, v13
    v_mul_f32_e64 v14, v23, v14
    v_exp_f32_e64 v11, v11
    v_exp_f32_e64 v12, v12
    v_mfma_f32_32x32x16_bf16 v[32:47], a[20:23], v[164:167], v[32:47]
    ds_read_b64_tr_b16 a[0:1], v10 offset:40960
    ds_read_b64_tr_b16 a[2:3], v10 offset:41472
    v_exp_f32_e64 v13, v13
    v_exp_f32_e64 v14, v14
    v_fma_f32 v11, v11, v3, v3
    v_fma_f32 v12, v12, v3, v3
    s_waitcnt lgkmcnt(6)
    v_mfma_f32_32x32x16_bf16 v[32:47], a[24:27], v[168:171], v[32:47]
    ds_read_b64_tr_b16 a[4:5], v10 offset:43008
    ds_read_b64_tr_b16 a[6:7], v10 offset:43520
    v_fma_f32 v13, v13, v3, v3
    v_fma_f32 v14, v14, v3, v3
    v_rcp_f32_e64 v11, v11
    v_rcp_f32_e64 v12, v12
    v_mfma_f32_32x32x16_bf16 v[32:47], a[28:31], v[172:175], v[32:47]
    ds_read_b64_tr_b16 a[8:9], v10 offset:45056
    ds_read_b64_tr_b16 a[10:11], v10 offset:45568
    v_rcp_f32_e64 v13, v13
    v_rcp_f32_e64 v14, v14
    v_mul_f32_e64 v20, v20, v11
    v_mul_f32_e64 v21, v21, v12
    v_mfma_f32_32x32x16_bf16 v[32:47], a[32:35], v[176:179], v[32:47]
    ds_read_b64_tr_b16 a[12:13], v10 offset:47104
    ds_read_b64_tr_b16 a[14:15], v10 offset:47616
    v_mul_f32_e64 v22, v22, v13
    v_mul_f32_e64 v23, v23, v14
    v_cvt_pk_bf16_f32 v18, v20, v21
    v_cvt_pk_bf16_f32 v19, v22, v23
    v_mfma_f32_32x32x16_bf16 v[32:47], a[36:39], v[180:183], v[32:47]
    ds_read_b64_tr_b16 a[16:17], v10 offset:49152
    ds_read_b64_tr_b16 a[18:19], v10 offset:49664
    buffer_store_dwordx4 v[16:19], v0, s[16:19], s36 offen offset:0 sc1
    v_mul_f32_e64 v11, v24, v24
    v_mul_f32_e64 v12, v25, v25
    v_mul_f32_e64 v13, v26, v26
    s_waitcnt lgkmcnt(6)
    v_mfma_f32_32x32x16_bf16 v[32:47], a[40:43], v[184:187], v[32:47]
    ds_read_b64_tr_b16 a[20:21], v10 offset:51200
    ds_read_b64_tr_b16 a[22:23], v10 offset:51712
    v_mul_f32_e64 v14, v27, v27
    v_fma_f32 v11, v11, v2, v1
    v_fma_f32 v12, v12, v2, v1
    v_fma_f32 v13, v13, v2, v1
    v_mfma_f32_32x32x16_bf16 v[32:47], a[44:47], v[188:191], v[32:47]
    ds_read_b64_tr_b16 a[24:25], v10 offset:53248
    ds_read_b64_tr_b16 a[26:27], v10 offset:53760
    v_fma_f32 v14, v14, v2, v1
    v_mul_f32_e64 v11, v24, v11
    v_mul_f32_e64 v12, v25, v12
    v_mul_f32_e64 v13, v26, v13
    v_mfma_f32_32x32x16_bf16 v[32:47], a[0:3], v[192:195], v[32:47]
    ds_read_b64_tr_b16 a[28:29], v10 offset:55296
    ds_read_b64_tr_b16 a[30:31], v10 offset:55808
    v_mul_f32_e64 v14, v27, v14
    v_exp_f32_e64 v11, v11
    v_exp_f32_e64 v12, v12
    v_exp_f32_e64 v13, v13
    v_mfma_f32_32x32x16_bf16 v[32:47], a[4:7], v[196:199], v[32:47]
    v_add_u32 v10, 106496, v10
    ds_read_b64_tr_b16 a[32:33], v10 offset:0
    ds_read_b64_tr_b16 a[34:35], v10 offset:512
    v_exp_f32_e64 v14, v14
    v_fma_f32 v11, v11, v3, v3
    v_fma_f32 v12, v12, v3, v3
    v_fma_f32 v13, v13, v3, v3
    s_waitcnt lgkmcnt(6)
    v_mfma_f32_32x32x16_bf16 v[32:47], a[8:11], v[200:203], v[32:47]
    ds_read_b64_tr_b16 a[36:37], v10 offset:2048
    ds_read_b64_tr_b16 a[38:39], v10 offset:2560
    v_fma_f32 v14, v14, v3, v3
    v_rcp_f32_e64 v11, v11
    v_rcp_f32_e64 v12, v12
    v_mfma_f32_32x32x16_bf16 v[32:47], a[12:15], v[204:207], v[32:47]
    ds_read_b64_tr_b16 a[40:41], v10 offset:4096
    ds_read_b64_tr_b16 a[42:43], v10 offset:4608
    v_rcp_f32_e64 v13, v13
    v_rcp_f32_e64 v14, v14
    v_mul_f32_e64 v24, v24, v11
    v_mfma_f32_32x32x16_bf16 v[32:47], a[16:19], v[208:211], v[32:47]
    ds_read_b64_tr_b16 a[44:45], v10 offset:6144
    ds_read_b64_tr_b16 a[46:47], v10 offset:6656
    v_mul_f32_e64 v25, v25, v12
    v_mul_f32_e64 v26, v26, v13
    v_mul_f32_e64 v27, v27, v14
    v_mfma_f32_32x32x16_bf16 v[32:47], a[20:23], v[212:215], v[32:47]
    ds_read_b64_tr_b16 a[0:1], v10 offset:8192
    ds_read_b64_tr_b16 a[2:3], v10 offset:8704
    v_cvt_pk_bf16_f32 v20, v24, v25
    v_cvt_pk_bf16_f32 v21, v26, v27
    v_mul_f32_e64 v11, v28, v28
    s_waitcnt lgkmcnt(6)
    v_mfma_f32_32x32x16_bf16 v[32:47], a[24:27], v[216:219], v[32:47]
    ds_read_b64_tr_b16 a[4:5], v10 offset:10240
    ds_read_b64_tr_b16 a[6:7], v10 offset:10752
    v_mul_f32_e64 v12, v29, v29
    v_mul_f32_e64 v13, v30, v30
    v_mul_f32_e64 v14, v31, v31
    v_mfma_f32_32x32x16_bf16 v[32:47], a[28:31], v[220:223], v[32:47]
    ds_read_b64_tr_b16 a[8:9], v10 offset:12288
    ds_read_b64_tr_b16 a[10:11], v10 offset:12800
    v_fma_f32 v11, v11, v2, v1
    v_fma_f32 v12, v12, v2, v1
    v_fma_f32 v13, v13, v2, v1
    v_mfma_f32_32x32x16_bf16 v[32:47], a[32:35], v[224:227], v[32:47]
    ds_read_b64_tr_b16 a[12:13], v10 offset:14336
    ds_read_b64_tr_b16 a[14:15], v10 offset:14848
    v_fma_f32 v14, v14, v2, v1
    v_mul_f32_e64 v11, v28, v11
    v_mul_f32_e64 v12, v29, v12
    v_mfma_f32_32x32x16_bf16 v[32:47], a[36:39], v[228:231], v[32:47]
    v_mul_f32_e64 v13, v30, v13
    v_mul_f32_e64 v14, v31, v14
    v_exp_f32_e64 v11, v11
    s_waitcnt lgkmcnt(4)
    v_mfma_f32_32x32x16_bf16 v[32:47], a[40:43], v[232:235], v[32:47]
    v_exp_f32_e64 v12, v12
    v_exp_f32_e64 v13, v13
    v_exp_f32_e64 v14, v14
    v_mfma_f32_32x32x16_bf16 v[32:47], a[44:47], v[236:239], v[32:47]
    v_fma_f32 v11, v11, v3, v3
    v_fma_f32 v12, v12, v3, v3
    v_fma_f32 v13, v13, v3, v3
    v_mfma_f32_32x32x16_bf16 v[32:47], a[0:3], v[240:243], v[32:47]
    v_fma_f32 v14, v14, v3, v3
    v_rcp_f32_e64 v11, v11
    v_rcp_f32_e64 v12, v12
    v_mfma_f32_32x32x16_bf16 v[32:47], a[4:7], v[244:247], v[32:47]
    v_rcp_f32_e64 v13, v13
    v_rcp_f32_e64 v14, v14
    v_mul_f32_e64 v28, v28, v11
    s_waitcnt lgkmcnt(0)
    v_mfma_f32_32x32x16_bf16 v[32:47], a[8:11], v[248:251], v[32:47]
    v_mul_f32_e64 v29, v29, v12
    v_mul_f32_e64 v30, v30, v13
    v_mul_f32_e64 v31, v31, v14
    v_mfma_f32_32x32x16_bf16 v[32:47], a[12:15], v[252:255], v[32:47]
    v_cvt_pk_bf16_f32 v22, v28, v29
    v_cvt_pk_bf16_f32 v23, v30, v31
    buffer_store_dwordx4 v[20:23], v0, s[16:19], s36 offen offset:512 sc1
    s_bfe_u32 s48, s2, 0x20001
    s_andn2_b32 s49, 1, s2
    s_lshl2_add_u32 s48, s49, s48
    s_lshl_b32 s48, s48, 8
    s_add_u32 s48, s48, 20447232
    s_cmp_eq_u32 s24, 0
    s_cselect_b32 s48, s48, 2130706432
    buffer_load_dwordx4 a[244:247], off, s[16:19], s48 sc1
    s_nop 4
    v_mul_f32_e64 v11, v32, v32
    v_mul_f32_e64 v12, v33, v33
    v_mul_f32_e64 v13, v34, v34
    v_mul_f32_e64 v14, v35, v35
    v_fma_f32 v11, v11, v2, v1
    v_fma_f32 v12, v12, v2, v1
    v_fma_f32 v13, v13, v2, v1
    v_fma_f32 v14, v14, v2, v1
    v_mul_f32_e64 v11, v32, v11
    v_mul_f32_e64 v12, v33, v12
    v_mul_f32_e64 v13, v34, v13
    v_mul_f32_e64 v14, v35, v14
    v_exp_f32_e64 v11, v11
    v_exp_f32_e64 v12, v12
    v_exp_f32_e64 v13, v13
    v_exp_f32_e64 v14, v14
    v_fma_f32 v11, v11, v3, v3
    v_fma_f32 v12, v12, v3, v3
    v_fma_f32 v13, v13, v3, v3
    v_fma_f32 v14, v14, v3, v3
    v_rcp_f32_e64 v11, v11
    v_rcp_f32_e64 v12, v12
    v_rcp_f32_e64 v13, v13
    v_rcp_f32_e64 v14, v14
    v_mul_f32_e64 v32, v32, v11
    v_mul_f32_e64 v33, v33, v12
    v_mul_f32_e64 v34, v34, v13
    v_mul_f32_e64 v35, v35, v14
    v_cvt_pk_bf16_f32 v32, v32, v33
    v_cvt_pk_bf16_f32 v33, v34, v35
    v_mul_f32_e64 v11, v36, v36
    v_mul_f32_e64 v12, v37, v37
    v_mul_f32_e64 v13, v38, v38
    v_mul_f32_e64 v14, v39, v39
    v_fma_f32 v11, v11, v2, v1
    v_fma_f32 v12, v12, v2, v1
    v_fma_f32 v13, v13, v2, v1
    v_fma_f32 v14, v14, v2, v1
    v_mul_f32_e64 v11, v36, v11
    v_mul_f32_e64 v12, v37, v12
    v_mul_f32_e64 v13, v38, v13
    v_mul_f32_e64 v14, v39, v14
    v_exp_f32_e64 v11, v11
    v_exp_f32_e64 v12, v12
    v_exp_f32_e64 v13, v13
    v_exp_f32_e64 v14, v14
    v_fma_f32 v11, v11, v3, v3
    v_fma_f32 v12, v12, v3, v3
    v_fma_f32 v13, v13, v3, v3
    v_fma_f32 v14, v14, v3, v3
    v_rcp_f32_e64 v11, v11
    v_rcp_f32_e64 v12, v12
    v_rcp_f32_e64 v13, v13
    v_rcp_f32_e64 v14, v14
    v_mul_f32_e64 v36, v36, v11
    v_mul_f32_e64 v37, v37, v12
    v_mul_f32_e64 v38, v38, v13
    v_mul_f32_e64 v39, v39, v14
    v_cvt_pk_bf16_f32 v34, v36, v37
    v_cvt_pk_bf16_f32 v35, v38, v39
    buffer_store_dwordx4 v[32:35], v8, s[16:19], s36 offen offset:0 sc1
    v_mul_f32_e64 v11, v40, v40
    v_mul_f32_e64 v12, v41, v41
    v_mul_f32_e64 v13, v42, v42
    v_mul_f32_e64 v14, v43, v43
    v_fma_f32 v11, v11, v2, v1
    v_fma_f32 v12, v12, v2, v1
    v_fma_f32 v13, v13, v2, v1
    v_fma_f32 v14, v14, v2, v1
    v_mul_f32_e64 v11, v40, v11
    v_mul_f32_e64 v12, v41, v12
    v_mul_f32_e64 v13, v42, v13
    v_mul_f32_e64 v14, v43, v14
    v_exp_f32_e64 v11, v11
    v_exp_f32_e64 v12, v12
    v_exp_f32_e64 v13, v13
    v_exp_f32_e64 v14, v14
    v_fma_f32 v11, v11, v3, v3
    v_fma_f32 v12, v12, v3, v3
    v_fma_f32 v13, v13, v3, v3
    v_fma_f32 v14, v14, v3, v3
    v_rcp_f32_e64 v11, v11
    v_rcp_f32_e64 v12, v12
    v_rcp_f32_e64 v13, v13
    v_rcp_f32_e64 v14, v14
    v_mul_f32_e64 v40, v40, v11
    v_mul_f32_e64 v41, v41, v12
    v_mul_f32_e64 v42, v42, v13
    v_mul_f32_e64 v43, v43, v14
    v_cvt_pk_bf16_f32 v36, v40, v41
    v_cvt_pk_bf16_f32 v37, v42, v43
    v_mul_f32_e64 v11, v44, v44
    v_mul_f32_e64 v12, v45, v45
    v_mul_f32_e64 v13, v46, v46
    v_mul_f32_e64 v14, v47, v47
    v_fma_f32 v11, v11, v2, v1
    v_fma_f32 v12, v12, v2, v1
    v_fma_f32 v13, v13, v2, v1
    v_fma_f32 v14, v14, v2, v1
    v_mul_f32_e64 v11, v44, v11
    v_mul_f32_e64 v12, v45, v12
    v_mul_f32_e64 v13, v46, v13
    v_mul_f32_e64 v14, v47, v14
    v_exp_f32_e64 v11, v11
    v_exp_f32_e64 v12, v12
    v_exp_f32_e64 v13, v13
    v_exp_f32_e64 v14, v14
    v_fma_f32 v11, v11, v3, v3
    v_fma_f32 v12, v12, v3, v3
    v_fma_f32 v13, v13, v3, v3
    v_fma_f32 v14, v14, v3, v3
    v_rcp_f32_e64 v11, v11
    v_rcp_f32_e64 v12, v12
    v_rcp_f32_e64 v13, v13
    v_rcp_f32_e64 v14, v14
    v_mul_f32_e64 v44, v44, v11
    v_mul_f32_e64 v45, v45, v12
    v_mul_f32_e64 v46, v46, v13
    v_mul_f32_e64 v47, v47, v14
    v_cvt_pk_bf16_f32 v38, v44, v45
    v_cvt_pk_bf16_f32 v39, v46, v47
    buffer_store_dwordx4 v[36:39], v8, s[16:19], s36 offen offset:512 sc1
    s_branch K1_P2C
K1_D:
    v_bfe_u32 v8, v3, 2, 3
    v_lshrrev_b32 v9, 5, v3
    v_lshl_add_u32 v9, v9, 4, v8
    s_and_b32 s71, s24, 1
    s_lshl_b32 s71, s71, 5
    v_add_u32 v9, s71, v9
    v_lshlrev_b32 v9, 8, v9
    v_and_b32 v10, 3, v3
    v_lshl_add_u32 v9, v10, 3, v9
    s_lshr_b32 s71, s24, 1
    s_lshl_b32 s74, s71, 2
    v_xor_b32 v8, s74, v8
    v_lshl_add_u32 v9, v8, 5, v9
    v_lshlrev_b32 v2, 4, v3
    s_waitcnt vmcnt(12)
    s_barrier
    v_xor_b32 v10, 131072, v9
    ds_read_b64_tr_b16 v[96:97], v10 offset:12288
    ds_read_b64_tr_b16 v[98:99], v10 offset:14336
    v_xor_b32 v11, 131104, v9
    ds_read_b64_tr_b16 v[100:101], v11 offset:12288
    ds_read_b64_tr_b16 v[102:103], v11 offset:14336
    v_xor_b32 v12, 131136, v9
    ds_read_b64_tr_b16 v[104:105], v12 offset:12288
    ds_read_b64_tr_b16 v[106:107], v12 offset:14336
    v_xor_b32 v13, 131168, v9
    ds_read_b64_tr_b16 v[108:109], v13 offset:12288
    ds_read_b64_tr_b16 v[110:111], v13 offset:14336
    s_mov_b32 s74, 0
    s_cmp_eq_u32 s71, 0
    s_cselect_b32 s74, s74, 4096
    s_add_u32 s74, s74, s36
    s_waitcnt lgkmcnt(6)
    buffer_store_dwordx4 v[96:99], v2, s[16:19], s74 offen sc1
    s_mov_b32 s74, 1024
    s_cmp_eq_u32 s71, 0
    s_cselect_b32 s74, s74, 378880
    s_add_u32 s74, s74, s36
    s_waitcnt lgkmcnt(4)
    buffer_store_dwordx4 v[100:103], v2, s[16:19], s74 offen sc1
    s_mov_b32 s74, 2048
    s_cmp_eq_u32 s71, 0
    s_cselect_b32 s74, s74, 379904
    s_add_u32 s74, s74, s36
    s_waitcnt lgkmcnt(2)
    buffer_store_dwordx4 v[104:107], v2, s[16:19], s74 offen sc1
    s_mov_b32 s74, 3072
    s_cmp_eq_u32 s71, 0
    s_cselect_b32 s74, s74, 380928
    s_add_u32 s74, s74, s36
    s_waitcnt lgkmcnt(0)
    buffer_store_dwordx4 v[108:111], v2, s[16:19], s74 offen sc1
    v_xor_b32 v10, 0, v9
    ds_read_b64_tr_b16 v[112:113], v10 offset:20480
    ds_read_b64_tr_b16 v[114:115], v10 offset:22528
    v_xor_b32 v11, 32, v9
    ds_read_b64_tr_b16 v[116:117], v11 offset:20480
    ds_read_b64_tr_b16 v[118:119], v11 offset:22528
    v_xor_b32 v12, 64, v9
    ds_read_b64_tr_b16 v[120:121], v12 offset:20480
    ds_read_b64_tr_b16 v[122:123], v12 offset:22528
    v_xor_b32 v13, 96, v9
    ds_read_b64_tr_b16 v[124:125], v13 offset:20480
    ds_read_b64_tr_b16 v[126:127], v13 offset:22528
    s_mov_b32 s74, 381952
    s_cmp_eq_u32 s71, 0
    s_cselect_b32 s74, s74, 759808
    s_add_u32 s74, s74, s36
    s_waitcnt lgkmcnt(6)
    buffer_store_dwordx4 v[112:115], v2, s[16:19], s74 offen sc1
    s_mov_b32 s74, 382976
    s_cmp_eq_u32 s71, 0
    s_cselect_b32 s74, s74, 760832
    s_add_u32 s74, s74, s36
    s_waitcnt lgkmcnt(4)
    buffer_store_dwordx4 v[116:119], v2, s[16:19], s74 offen sc1
    s_mov_b32 s74, 757760
    s_cmp_eq_u32 s71, 0
    s_cselect_b32 s74, s74, 761856
    s_add_u32 s74, s74, s36
    s_waitcnt lgkmcnt(2)
    buffer_store_dwordx4 v[120:123], v2, s[16:19], s74 offen sc1
    s_mov_b32 s74, 758784
    s_cmp_eq_u32 s71, 0
    s_cselect_b32 s74, s74, 1136640
    s_add_u32 s74, s74, s36
    s_waitcnt lgkmcnt(0)
    buffer_store_dwordx4 v[124:127], v2, s[16:19], s74 offen sc1
    v_xor_b32 v10, 0, v9
    ds_read_b64_tr_b16 v[128:129], v10 offset:40960
    ds_read_b64_tr_b16 v[130:131], v10 offset:43008
    v_xor_b32 v11, 32, v9
    ds_read_b64_tr_b16 v[132:133], v11 offset:40960
    ds_read_b64_tr_b16 v[134:135], v11 offset:43008
    v_xor_b32 v12, 64, v9
    ds_read_b64_tr_b16 v[136:137], v12 offset:40960
    ds_read_b64_tr_b16 v[138:139], v12 offset:43008
    v_xor_b32 v13, 96, v9
    ds_read_b64_tr_b16 v[140:141], v13 offset:40960
    ds_read_b64_tr_b16 v[142:143], v13 offset:43008
    s_mov_b32 s74, 1137664
    s_cmp_eq_u32 s71, 0
    s_cselect_b32 s74, s74, 1515520
    s_add_u32 s74, s74, s36
    s_waitcnt lgkmcnt(6)
    buffer_store_dwordx4 v[128:131], v2, s[16:19], s74 offen sc1
    s_mov_b32 s74, 1138688
    s_cmp_eq_u32 s71, 0
    s_cselect_b32 s74, s74, 1516544
    s_add_u32 s74, s74, s36
    s_waitcnt lgkmcnt(4)
    buffer_store_dwordx4 v[132:135], v2, s[16:19], s74 offen sc1
    s_mov_b32 s74, 1139712
    s_cmp_eq_u32 s71, 0
    s_cselect_b32 s74, s74, 1517568
    s_add_u32 s74, s74, s36
    s_waitcnt lgkmcnt(2)
    buffer_store_dwordx4 v[136:139], v2, s[16:19], s74 offen sc1
    s_mov_b32 s74, 1140736
    s_cmp_eq_u32 s71, 0
    s_cselect_b32 s74, s74, 1518592
    s_add_u32 s74, s74, s36
    s_waitcnt lgkmcnt(0)
    buffer_store_dwordx4 v[140:143], v2, s[16:19], s74 offen sc1
    v_xor_b32 v10, 0, v9
    ds_read_b64_tr_b16 v[144:145], v10 offset:61440
    ds_read_b64_tr_b16 v[146:147], v10 offset:63488
    v_xor_b32 v11, 32, v9
    ds_read_b64_tr_b16 v[148:149], v11 offset:61440
    ds_read_b64_tr_b16 v[150:151], v11 offset:63488
    v_xor_b32 v12, 64, v9
    ds_read_b64_tr_b16 v[152:153], v12 offset:61440
    ds_read_b64_tr_b16 v[154:155], v12 offset:63488
    v_xor_b32 v13, 96, v9
    ds_read_b64_tr_b16 v[156:157], v13 offset:61440
    ds_read_b64_tr_b16 v[158:159], v13 offset:63488
    s_mov_b32 s74, 1519616
    s_cmp_eq_u32 s71, 0
    s_cselect_b32 s74, s74, 1897472
    s_add_u32 s74, s74, s36
    s_waitcnt lgkmcnt(6)
    buffer_store_dwordx4 v[144:147], v2, s[16:19], s74 offen sc1
    s_mov_b32 s74, 1894400
    s_cmp_eq_u32 s71, 0
    s_cselect_b32 s74, s74, 1898496
    s_add_u32 s74, s74, s36
    s_waitcnt lgkmcnt(4)
    buffer_store_dwordx4 v[148:151], v2, s[16:19], s74 offen sc1
    s_mov_b32 s74, 1895424
    s_cmp_eq_u32 s71, 0
    s_cselect_b32 s74, s74, 2273280
    s_add_u32 s74, s74, s36
    s_waitcnt lgkmcnt(2)
    buffer_store_dwordx4 v[152:155], v2, s[16:19], s74 offen sc1
    s_mov_b32 s74, 1896448
    s_cmp_eq_u32 s71, 0
    s_cselect_b32 s74, s74, 2274304
    s_add_u32 s74, s74, s36
    s_waitcnt lgkmcnt(0)
    buffer_store_dwordx4 v[156:159], v2, s[16:19], s74 offen sc1
    s_waitcnt vmcnt(16)
    s_barrier
    v_mov_b32 v15, 1
    s_mov_b64 exec, 1
    buffer_atomic_add v15, off, s[16:19], s31  offset:0 sc1
    s_mov_b64 exec, -1
    v_xor_b32 v10, 65536, v9
    ds_read_b64_tr_b16 v[160:161], v10 offset:61440
    ds_read_b64_tr_b16 v[162:163], v10 offset:63488
    v_xor_b32 v11, 65568, v9
    ds_read_b64_tr_b16 v[164:165], v11 offset:61440
    ds_read_b64_tr_b16 v[166:167], v11 offset:63488
    v_xor_b32 v12, 65600, v9
    ds_read_b64_tr_b16 v[168:169], v12 offset:61440
    ds_read_b64_tr_b16 v[170:171], v12 offset:63488
    v_xor_b32 v13, 65632, v9
    ds_read_b64_tr_b16 v[172:173], v13 offset:61440
    ds_read_b64_tr_b16 v[174:175], v13 offset:63488
    s_mov_b32 s74, 2275328
    s_cmp_eq_u32 s71, 0
    s_cselect_b32 s74, s74, 2653184
    s_add_u32 s74, s74, s36
    s_waitcnt lgkmcnt(6)
    buffer_store_dwordx4 v[160:163], v2, s[16:19], s74 offen sc1
    s_mov_b32 s74, 2276352
    s_cmp_eq_u32 s71, 0
    s_cselect_b32 s74, s74, 2654208
    s_add_u32 s74, s74, s36
    s_waitcnt lgkmcnt(4)
    buffer_store_dwordx4 v[164:167], v2, s[16:19], s74 offen sc1
    s_mov_b32 s74, 2277376
    s_cmp_eq_u32 s71, 0
    s_cselect_b32 s74, s74, 2655232
    s_add_u32 s74, s74, s36
    s_waitcnt lgkmcnt(2)
    buffer_store_dwordx4 v[168:171], v2, s[16:19], s74 offen sc1
    s_mov_b32 s74, 2652160
    s_cmp_eq_u32 s71, 0
    s_cselect_b32 s74, s74, 2656256
    s_add_u32 s74, s74, s36
    s_waitcnt lgkmcnt(0)
    buffer_store_dwordx4 v[172:175], v2, s[16:19], s74 offen sc1
    s_mov_b32 s65, 1
    s_mov_b32 s64, 1
    s_mov_b32 s3, 20447236
    s_cmp_eq_u32 s24, 0
    s_cselect_b32 s3, s3, 2130706432
    s_waitcnt vmcnt(0)
    s_barrier
    v_mov_b32 v10, 1
    v_lshlrev_b32 v11, 7, v3
    s_mov_b64 exec, 1
    s_mov_b32 exec_lo, 0xffff
    buffer_atomic_add v10, v11, s[16:19], s3 offen offset:0 sc1
    s_mov_b64 exec, -1
    s_mov_b32 s3, 2130706432
    s_cmp_eq_u32 s72, 7
    s_cbranch_scc0 K1_P2
    s_bfe_u32 s48, s2, 0x20001
    s_andn2_b32 s49, 1, s2
    s_lshl2_add_u32 s48, s49, s48
    s_lshl_b32 s48, s48, 8
    s_add_u32 s48, s48, 20447232
    s_cmp_eq_u32 s24, 0
    s_cselect_b32 s48, s48, 2130706432
    buffer_load_dwordx4 a[244:247], off, s[16:19], s48 sc1
    s_waitcnt vmcnt(0)
    s_branch K1_P2A
K1_P2:
    s_load_dwordx2 s[84:85], s[0:1], 72
    s_bfe_u32 s21, s2, 0x20001
    s_andn2_b32 s22, 1, s2
    s_lshl2_add_u32 s21, s22, s21
    s_lshr_b32 s22, s2, 3
    s_lshr_b32 s23, s22, 3
    s_lshl_b32 s26, s21, 2
    s_add_u32 s23, s23, s26
    s_lshr_b32 s42, s23, 1
    s_lshl_b32 s48, s42, 7
    s_add_u32 s48, s48, 20447232
    s_mov_b32 s20, s24
    s_cmp_eq_u32 s20, 0
    s_cselect_b32 s48, s48, 2130706432
    v_accvgpr_read_b32 v0, a117
    s_and_b32 s27, s22, 7
    s_mul_i32 s28, s23, 74
    s_mul_i32 s29, s27, 74
    v_and_b32 v3, 63, v0
    s_lshr_b32 s42, s42, 1
    s_mul_i32 s43, s42, 86
    s_lshr_b32 s43, s43, 8
    s_mul_i32 s43, s43, 3
    s_sub_u32 s42, s42, s43
    s_lshr_b32 s43, s20, 1
    s_lshl_b32 s43, s43, 2
    s_add_u32 s43, s43, s20
    v_lshlrev_b32 v1, 4, v3
    v_add_u32 v2, 0x1000, v1
    s_lshl_b32 s37, s42, 1
    s_add_u32 s37, s37, s43
    s_add_u32 s38, s37, s28
    s_lshl_b32 s50, s38, 12
    s_add_u32 s38, s37, s29
    s_mul_i32 s38, s38, 5120
    s_add_u32 s54, s38, 10485760
    s_add_u32 s42, s42, 1
    s_cmp_eq_u32 s42, 3
    s_cselect_b32 s42, 0, s42
    s_lshl_b32 s37, s42, 1
    s_add_u32 s37, s37, s43
    s_add_u32 s38, s37, s28
    s_lshl_b32 s51, s38, 12
    s_add_u32 s38, s37, s29
    s_mul_i32 s38, s38, 5120
    s_add_u32 s55, s38, 10485760
    s_add_u32 s42, s42, 1
    s_cmp_eq_u32 s42, 3
    s_cselect_b32 s42, 0, s42
    s_lshl_b32 s37, s42, 1
    s_add_u32 s37, s37, s43
    s_add_u32 s38, s37, s28
    s_lshl_b32 s52, s38, 12
    s_add_u32 s38, s37, s29
    s_mul_i32 s38, s38, 5120
    s_add_u32 s56, s38, 10485760
    s_add_u32 s28, s28, s20
    s_add_u32 s29, s29, s20
    s_lshl_b32 s53, s28, 12
    s_mul_i32 s29, s29, 5120
    s_add_u32 s57, s29, 10485760
    s_lshr_b32 s37, s2, 6
    s_mul_i32 s61, s37, 61440
    s_mul_i32 s62, s37, 20480
    s_add_u32 s63, s62, 245760
    s_cmp_eq_u32 s37, 2
    s_cselect_b32 s63, 358400, s63
    s_cmp_eq_u32 s37, 3
    s_cselect_b32 s63, 2130706432, s63
    s_add_u32 s63, s63, s57
    s_add_u32 s62, s62, s57
    s_add_u32 s62, s62, 276480
    s_add_u32 s49, s61, s55
    s_add_u32 s61, s61, s56
    v_min_u32 v23, 39, v3
    v_lshlrev_b32 v23, 7, v23
    s_waitcnt lgkmcnt(0)
    s_mov_b32 s8, s84
    s_and_b32 s9, s85, 0xffff
    s_mov_b32 s10, 2621440
    s_mov_b32 s11, 0x20000
    s_mov_b32 s12, s90
    s_and_b32 s13, s91, 0xffff
    s_mov_b32 s14, 1280
    s_mov_b32 s15, 0x20000
    s_sub_u32 s44, s72, 3
    s_cmp_lt_u32 s72, 2
    s_cselect_b32 s44, s72, s44
    s_lshl_b32 s44, s44, 4
    s_add_u32 s44, s44, s25
    s_lshr_b32 s45, s44, 3
    s_and_b32 s44, s44, 7
    s_lshl_b32 s26, s45, 2
    s_add_u32 s26, s26, s20
    s_lshl_b32 s34, s45, 10
    s_add_u32 s34, s34, 19922944
    s_lshl_b32 s45, s45, 8
    s_lshr_b32 s59, s45, 1
    s_add_u32 s59, s59, 20449280
    s_lshl_b32 s58, s44, 7
    s_add_u32 s58, s58, 20451328
    s_add_u32 s45, s45, 20447240
    s_cmp_eq_u32 s20, 0
    s_cselect_b32 s58, s58, 2130706432
    s_cselect_b32 s59, s59, 2130706432
    s_cselect_b32 s45, s45, 2130706432
    buffer_load_dwordx4 a[240:243], off, s[16:19], s58 sc1
    s_lshl_b32 s30, s44, 2
    s_add_u32 s30, s30, s20
    s_lshl_b32 s30, s30, 12
    s_add_u32 s30, s30, 17825792
    s_mul_i32 s32, s26, 81920
    s_add_u32 s32, s32, 14680064
    s_mul_i32 s33, s26, 221184
    s_add_u32 s33, s33, 4280508416
    s_mul_i32 s36, s44, 5
    s_add_u32 s37, s36, 0
    s_lshr_b32 s38, s37, 1
    s_lshl_b32 s38, s38, 12
    s_and_b32 s37, s37, 1
    s_lshl_b32 s37, s37, 9
    s_add_u32 s37, s37, s38
    s_add_u32 s66, s37, s32
    s_add_u32 s37, s36, 1
    s_lshr_b32 s38, s37, 1
    s_lshl_b32 s38, s38, 12
    s_and_b32 s37, s37, 1
    s_lshl_b32 s37, s37, 9
    s_add_u32 s37, s37, s38
    s_add_u32 s67, s37, s32
    s_add_u32 s37, s36, 2
    s_lshr_b32 s38, s37, 1
    s_lshl_b32 s38, s38, 12
    s_and_b32 s37, s37, 1
    s_lshl_b32 s37, s37, 9
    s_add_u32 s37, s37, s38
    s_add_u32 s68, s37, s32
    s_add_u32 s37, s36, 3
    s_lshr_b32 s38, s37, 1
    s_lshl_b32 s38, s38, 12
    s_and_b32 s37, s37, 1
    s_lshl_b32 s37, s37, 9
    s_add_u32 s37, s37, s38
    s_add_u32 s69, s37, s32
    s_add_u32 s37, s36, 4
    s_lshr_b32 s38, s37, 1
    s_lshl_b32 s38, s38, 12
    s_and_b32 s37, s37, 1
    s_lshl_b32 s37, s37, 9
    s_add_u32 s37, s37, s38
    s_add_u32 s70, s37, s32
    s_mul_i32 s36, s20, 5
    s_mul_i32 s37, s20, 10240
    v_and_b32 v10, 31, v3
    v_lshrrev_b32 v11, 5, v3
    v_cmp_eq_u32 vcc, 24, v10
    v_mov_b32 v13, 2130706432
    v_lshlrev_b32 v9, 2, v10
    v_cndmask_b32 v12, v10, 20, vcc
    v_cmp_lt_u32 vcc, 20, v12
    v_lshlrev_b32 v4, 7, v11
    v_lshl_add_u32 v4, v12, 2, v4
    v_cndmask_b32 v4, v4, v13, vcc
    v_cmp_lt_u32 vcc, 31, v3
    v_lshrrev_b32 v12, 4, v10
    v_lshlrev_b32 v12, 9, v12
    v_cndmask_b32 v5, v4, v13, vcc
    v_and_b32 v14, 15, v10
    v_lshl_add_u32 v12, v14, 4, v12
    v_lshlrev_b32 v21, 10, v11
    v_lshl_add_u32 v21, v10, 4, v21
    v_add_u32 v22, s37, v1
    v_add_u32 v11, s36, v11
    v_add_u32 v14, 0, v11
    v_lshrrev_b32 v15, 2, v14
    v_lshl_add_u32 v6, v15, 11, v12
    v_and_b32 v15, 1, v14
    v_lshl_add_u32 v6, v15, 8, v6
    v_bfe_u32 v15, v14, 1, 1
    v_lshl_add_u32 v6, v15, 3, v6
    v_add_u32 v14, 2, v11
    v_lshrrev_b32 v15, 2, v14
    v_lshl_add_u32 v7, v15, 11, v12
    v_and_b32 v15, 1, v14
    v_lshl_add_u32 v7, v15, 8, v7
    v_bfe_u32 v15, v14, 1, 1
    v_lshl_add_u32 v7, v15, 3, v7
    v_add_u32 v14, 4, v11
    v_lshrrev_b32 v15, 2, v14
    v_lshl_add_u32 v8, v15, 11, v12
    v_and_b32 v15, 1, v14
    v_lshl_add_u32 v8, v15, 8, v8
    v_bfe_u32 v15, v14, 1, 1
    v_lshl_add_u32 v8, v15, 3, v8
    v_add_u32 v15, 0xa000, v8
    v_cndmask_b32 v20, v8, v15, vcc
    v_cndmask_b32 v8, v8, v7, vcc
    v_mov_b32 v16, 0
    v_mov_b32 v17, 0
    s_waitcnt vmcnt(1)
    s_barrier
    v_mov_b32 v10, s65
    v_lshlrev_b32 v11, 7, v3
    s_mov_b64 exec, 1
    s_mov_b32 exec_lo, s64
    buffer_atomic_add v10, v11, s[16:19], s3 offen offset:0 sc1
    s_mov_b64 exec, -1
    s_cmp_lg_u32 s20, 0
    s_cbranch_scc1 P2Kk_ok
    s_waitcnt vmcnt(1)
    s_mov_b32 s38, 0
    s_branch P2Kk_c
P2Kk_l:
    s_sleep 8
    buffer_load_dwordx4 a[240:243], off, s[16:19], s58 sc1
    s_add_u32 s38, s38, 1
    s_waitcnt vmcnt(0)
    s_cmp_ge_u32 s38, 0x20000
    s_cbranch_scc1 P2Kk_ok
P2Kk_c:
    v_accvgpr_read_b32 v19, a240
    s_nop 1
    v_readfirstlane_b32 s37, v19
    s_bfe_u32 s37, s37, 524288
    s_cmp_ge_u32 s37, 16
    s_cbranch_scc0 P2Kk_l
P2Kk_ok:
    s_barrier
    buffer_load_dword v232, v4, s[16:19], s30 offen offset:0 sc1
    buffer_load_dword v233, v4, s[16:19], s30 offen offset:256 sc1
    buffer_load_dword v234, v4, s[16:19], s30 offen offset:512 sc1
    buffer_load_dword v235, v4, s[16:19], s30 offen offset:768 sc1
    buffer_load_dword v236, v4, s[16:19], s30 offen offset:1024 sc1
    buffer_load_dword v237, v4, s[16:19], s30 offen offset:1280 sc1
    buffer_load_dword v238, v4, s[16:19], s30 offen offset:1536 sc1
    buffer_load_dword v239, v4, s[16:19], s30 offen offset:1792 sc1
    buffer_load_dword v240, v5, s[16:19], s30 offen offset:2048 sc1
    buffer_load_dword v241, v5, s[16:19], s30 offen offset:2304 sc1
    buffer_load_dword v242, v5, s[16:19], s30 offen offset:2560 sc1
    buffer_load_dword v243, v5, s[16:19], s30 offen offset:2816 sc1
    buffer_load_dwordx4 a[240:243], off, s[16:19], s59 sc1
    v_accvgpr_write_b32 a166, 0
    v_accvgpr_write_b32 a167, 0
    v_accvgpr_write_b32 a174, 0
    v_accvgpr_write_b32 a175, 0
    v_accvgpr_write_b32 a182, 0
    v_accvgpr_write_b32 a183, 0
    v_accvgpr_write_b32 a190, 0
    v_accvgpr_write_b32 a191, 0
    v_accvgpr_write_b32 a198, 0
    v_accvgpr_write_b32 a199, 0
    v_accvgpr_write_b32 a206, 0
    v_accvgpr_write_b32 a207, 0
    v_accvgpr_write_b32 a214, 0
    v_accvgpr_write_b32 a215, 0
    v_accvgpr_write_b32 a222, 0
    v_accvgpr_write_b32 a223, 0
    s_waitcnt vmcnt(1)
    v_cvt_pk_bf16_f32 v10, v232, v233
    v_cvt_pk_bf16_f32 v11, v234, v235
    v_cvt_pk_bf16_f32 v12, v236, v237
    v_cvt_pk_bf16_f32 v13, v238, v239
    v_cvt_pk_bf16_f32 v14, v240, v241
    v_cvt_pk_bf16_f32 v15, v242, v243
    s_cmp_lg_u32 s20, 0
    s_cbranch_scc1 P2Kq_ok
    s_waitcnt vmcnt(0)
    s_mov_b32 s38, 0
    s_branch P2Kq_c
P2Kq_l:
    s_sleep 2
    buffer_load_dwordx4 a[240:243], off, s[16:19], s59 sc1
    s_add_u32 s38, s38, 1
    s_waitcnt vmcnt(0)
    s_cmp_ge_u32 s38, 0x20000
    s_cbranch_scc1 P2Kq_ok
P2Kq_c:
    v_accvgpr_read_b32 v19, a240
    s_nop 1
    v_readfirstlane_b32 s37, v19
    s_bfe_u32 s37, s37, 524288
    s_cmp_ge_u32 s37, 20
    s_cbranch_scc0 P2Kq_l
P2Kq_ok:
    s_barrier
    buffer_load_dwordx4 a[244:247], off, s[16:19], s48 sc1
    buffer_load_dwordx4 v[176:179], v21, s[16:19], s66 offen offset:0 sc1
    buffer_load_dwordx4 v[180:183], v21, s[16:19], s66 offen offset:2048 sc1
    buffer_load_dwordx4 v[184:187], v21, s[16:19], s67 offen offset:0 sc1
    buffer_load_dwordx4 v[188:191], v21, s[16:19], s67 offen offset:2048 sc1
    buffer_load_dwordx4 v[192:195], v21, s[16:19], s68 offen offset:0 sc1
    buffer_load_dwordx4 v[196:199], v21, s[16:19], s68 offen offset:2048 sc1
    buffer_load_dwordx4 v[200:203], v21, s[16:19], s69 offen offset:0 sc1
    buffer_load_dwordx4 v[204:207], v21, s[16:19], s69 offen offset:2048 sc1
    buffer_load_dwordx4 v[208:211], v21, s[16:19], s70 offen offset:0 sc1
    buffer_load_dwordx4 v[212:215], v21, s[16:19], s70 offen offset:2048 sc1
    buffer_load_dword v224, v9, s[16:19], s34 offen offset:0 sc1
    buffer_load_dword v225, v9, s[16:19], s34 offen offset:128 sc1
    buffer_load_dword v226, v9, s[16:19], s34 offen offset:256 sc1
    buffer_load_dword v227, v9, s[16:19], s34 offen offset:384 sc1
    buffer_load_dword v228, v9, s[16:19], s34 offen offset:512 sc1
    buffer_load_dword v229, v9, s[16:19], s34 offen offset:640 sc1
    buffer_load_dword v230, v9, s[16:19], s34 offen offset:768 sc1
    buffer_load_dword v231, v9, s[16:19], s34 offen offset:896 sc1
    s_waitcnt vmcnt(17)
    ds_write_b128 v22, v[176:179] offset:0
    s_waitcnt vmcnt(16)
    ds_write_b128 v22, v[180:183] offset:1024
    s_waitcnt vmcnt(15)
    ds_write_b128 v22, v[184:187] offset:2048
    s_waitcnt vmcnt(14)
    ds_write_b128 v22, v[188:191] offset:3072
    s_waitcnt vmcnt(13)
    ds_write_b128 v22, v[192:195] offset:4096
    s_waitcnt vmcnt(12)
    ds_write_b128 v22, v[196:199] offset:5120
    s_waitcnt vmcnt(11)
    ds_write_b128 v22, v[200:203] offset:6144
    s_waitcnt vmcnt(10)
    ds_write_b128 v22, v[204:207] offset:7168
    s_waitcnt vmcnt(9)
    ds_write_b128 v22, v[208:211] offset:8192
    s_waitcnt vmcnt(8)
    ds_write_b128 v22, v[212:215] offset:9216
    s_waitcnt lgkmcnt(0)
    s_cmp_lg_u32 s20, 0
    s_cbranch_scc1 P2Ka_ok
    s_mov_b32 s38, 0
    s_branch P2Ka_c
P2Ka_l:
    s_sleep 8
    buffer_load_dwordx4 a[244:247], off, s[16:19], s48 sc1
    s_add_u32 s38, s38, 1
    s_waitcnt vmcnt(0)
    s_cmp_ge_u32 s38, 0x20000
    s_cbranch_scc1 P2Ka_ok
P2Ka_c:
    v_accvgpr_read_b32 v19, a244
    s_nop 1
    v_readfirstlane_b32 s37, v19
    s_bfe_u32 s37, s37, 524288
    s_cmp_ge_u32 s37, 8
    s_cbranch_scc0 P2Ka_l
    v_accvgpr_read_b32 v19, a245
    s_nop 1
    v_readfirstlane_b32 s37, v19
    s_bfe_u32 s37, s37, 524288
    s_cmp_ge_u32 s37, 48
    s_cbranch_scc0 P2Ka_l
P2Ka_ok:
    s_barrier
    ds_read_b64 a[160:161], v6 offset:0
    ds_read_b64 a[162:163], v7 offset:0
    ds_read_b64 a[164:165], v8 offset:0
    ds_read_b64 a[168:169], v6 offset:1024
    ds_read_b64 a[170:171], v7 offset:1024
    ds_read_b64 a[172:173], v8 offset:1024
    ds_read_b64 a[176:177], v6 offset:10240
    ds_read_b64 a[178:179], v7 offset:10240
    ds_read_b64 a[180:181], v8 offset:10240
    ds_read_b64 a[184:185], v6 offset:11264
    ds_read_b64 a[186:187], v7 offset:11264
    ds_read_b64 a[188:189], v8 offset:11264
    ds_read_b64 a[192:193], v6 offset:20480
    ds_read_b64 a[194:195], v7 offset:20480
    ds_read_b64 a[196:197], v8 offset:20480
    ds_read_b64 a[200:201], v6 offset:21504
    ds_read_b64 a[202:203], v7 offset:21504
    ds_read_b64 a[204:205], v8 offset:21504
    ds_read_b64 a[208:209], v6 offset:30720
    ds_read_b64 a[210:211], v7 offset:30720
    ds_read_b64 a[212:213], v8 offset:30720
    ds_read_b64 a[216:217], v6 offset:31744
    ds_read_b64 a[218:219], v7 offset:31744
    ds_read_b64 a[220:221], v8 offset:31744
    s_add_u32 s66, s66, s33
    s_add_u32 s67, s67, s33
    s_add_u32 s68, s68, s33
    s_add_u32 s69, s69, s33
    s_add_u32 s70, s70, s33
    s_add_u32 s24, s50, 0
    s_add_u32 s25, s54, 0
    buffer_load_dwordx4 v[44:47], v1, s[16:19], s25 offen offset:0 sc1
    buffer_load_dwordx4 v[48:51], v1, s[16:19], s25 offen offset:1024 sc1
    s_waitcnt lgkmcnt(15)
    v_mfma_f32_32x32x16_bf16 v[176:191], v[10:13], a[160:163], 0
    v_mfma_f32_32x32x16_bf16 v[176:191], v[14:17], a[164:167], v[176:191]
    s_waitcnt lgkmcnt(15)
    v_mfma_f32_32x32x16_bf16 v[192:207], v[10:13], a[168:171], 0
    v_mfma_f32_32x32x16_bf16 v[192:207], v[14:17], a[172:175], v[192:207]
    s_waitcnt lgkmcnt(15)
    v_mfma_f32_32x32x16_bf16 v[208:223], v[10:13], a[176:179], 0
    v_mfma_f32_32x32x16_bf16 v[208:223], v[14:17], a[180:183], v[208:223]
    s_waitcnt vmcnt(2)
    v_cndmask_b32 v18, v188, v184, vcc
    v_add_f32 v18, 0x358637bd, v18
    v_rcp_f32 v18, v18
    s_nop 0
    v_mul_f32 v18, v18, v224
    v_mul_f32 v176, v176, v18
    v_mul_f32 v177, v177, v18
    v_mul_f32 v178, v178, v18
    v_mul_f32 v179, v179, v18
    v_mul_f32 v180, v180, v18
    v_mul_f32 v181, v181, v18
    v_mul_f32 v182, v182, v18
    v_mul_f32 v183, v183, v18
    v_mul_f32 v184, v184, v18
    v_mul_f32 v185, v185, v18
    v_mul_f32 v186, v186, v18
    v_mul_f32 v187, v187, v18
    v_cvt_pk_bf16_f32 v232, v176, v177
    v_cvt_pk_bf16_f32 v233, v178, v179
    v_cvt_pk_bf16_f32 v234, v180, v181
    v_cvt_pk_bf16_f32 v235, v182, v183
    v_cvt_pk_bf16_f32 v236, v184, v185
    v_cvt_pk_bf16_f32 v237, v186, v187
    s_waitcnt lgkmcnt(12)
    v_mfma_f32_32x32x16_bf16 v[176:191], v[10:13], a[184:187], 0
    v_mfma_f32_32x32x16_bf16 v[176:191], v[14:17], a[188:191], v[176:191]
    buffer_load_dwordx4 v[52:55], v1, s[16:19], s25 offen offset:2048 sc1
    buffer_load_dwordx4 v[56:59], v1, s[16:19], s25 offen offset:3072 sc1
    buffer_load_dwordx4 v[60:63], v2, s[16:19], s25 offen offset:0 sc1
    buffer_load_dwordx4 v[28:31], v1, s[16:19], s24 offen offset:0 sc1
    ds_write_b64 v6, v[232:233] offset:0
    ds_write_b64 v7, v[234:235] offset:0
    ds_write_b64 v20, v[236:237] offset:0
    v_cndmask_b32 v18, v204, v200, vcc
    v_add_f32 v18, 0x358637bd, v18
    v_rcp_f32 v18, v18
    s_nop 0
    v_mul_f32 v18, v18, v225
    v_mul_f32 v192, v192, v18
    v_mul_f32 v193, v193, v18
    v_mul_f32 v194, v194, v18
    v_mul_f32 v195, v195, v18
    v_mul_f32 v196, v196, v18
    v_mul_f32 v197, v197, v18
    v_mul_f32 v198, v198, v18
    v_mul_f32 v199, v199, v18
    v_mul_f32 v200, v200, v18
    v_mul_f32 v201, v201, v18
    v_mul_f32 v202, v202, v18
    v_mul_f32 v203, v203, v18
    v_cvt_pk_bf16_f32 v240, v192, v193
    v_cvt_pk_bf16_f32 v241, v194, v195
    v_cvt_pk_bf16_f32 v242, v196, v197
    v_cvt_pk_bf16_f32 v243, v198, v199
    v_cvt_pk_bf16_f32 v244, v200, v201
    v_cvt_pk_bf16_f32 v245, v202, v203
    s_waitcnt lgkmcnt(12)
    v_mfma_f32_32x32x16_bf16 v[192:207], v[10:13], a[192:195], 0
    v_mfma_f32_32x32x16_bf16 v[192:207], v[14:17], a[196:199], v[192:207]
    buffer_load_dwordx4 v[32:35], v1, s[16:19], s24 offen offset:1024 sc1
    buffer_load_dwordx4 v[36:39], v1, s[16:19], s24 offen offset:2048 sc1
    buffer_load_dwordx4 v[40:43], v1, s[16:19], s24 offen offset:3072 sc1
    s_add_u32 s24, s50, 49152
    ds_write_b64 v6, v[240:241] offset:1024
    ds_write_b64 v7, v[242:243] offset:1024
    ds_write_b64 v20, v[244:245] offset:1024
    v_cndmask_b32 v18, v220, v216, vcc
    v_add_f32 v18, 0x358637bd, v18
    v_rcp_f32 v18, v18
    s_nop 0
    v_mul_f32 v18, v18, v226
    v_mul_f32 v208, v208, v18
    v_mul_f32 v209, v209, v18
    v_mul_f32 v210, v210, v18
    v_mul_f32 v211, v211, v18
    v_mul_f32 v212, v212, v18
    v_mul_f32 v213, v213, v18
    v_mul_f32 v214, v214, v18
    v_mul_f32 v215, v215, v18
    v_mul_f32 v216, v216, v18
    v_mul_f32 v217, v217, v18
    v_mul_f32 v218, v218, v18
    v_mul_f32 v219, v219, v18
    v_cvt_pk_bf16_f32 v232, v208, v209
    v_cvt_pk_bf16_f32 v233, v210, v211
    v_cvt_pk_bf16_f32 v234, v212, v213
    v_cvt_pk_bf16_f32 v235, v214, v215
    v_cvt_pk_bf16_f32 v236, v216, v217
    v_cvt_pk_bf16_f32 v237, v218, v219
    s_waitcnt lgkmcnt(12)
    v_mfma_f32_32x32x16_bf16 v[208:223], v[10:13], a[200:203], 0
    v_mfma_f32_32x32x16_bf16 v[208:223], v[14:17], a[204:207], v[208:223]
    s_add_u32 s25, s54, 61440
    buffer_load_dwordx4 v[80:83], v1, s[16:19], s25 offen offset:0 sc1
    buffer_load_dwordx4 v[84:87], v1, s[16:19], s25 offen offset:1024 sc1
    buffer_load_dwordx4 v[88:91], v1, s[16:19], s25 offen offset:2048 sc1
    ds_write_b64 v6, v[232:233] offset:10240
    ds_write_b64 v7, v[234:235] offset:10240
    ds_write_b64 v20, v[236:237] offset:10240
    v_cndmask_b32 v18, v188, v184, vcc
    v_add_f32 v18, 0x358637bd, v18
    v_rcp_f32 v18, v18
    s_nop 0
    v_mul_f32 v18, v18, v227
    v_mul_f32 v176, v176, v18
    v_mul_f32 v177, v177, v18
    v_mul_f32 v178, v178, v18
    v_mul_f32 v179, v179, v18
    v_mul_f32 v180, v180, v18
    v_mul_f32 v181, v181, v18
    v_mul_f32 v182, v182, v18
    v_mul_f32 v183, v183, v18
    v_mul_f32 v184, v184, v18
    v_mul_f32 v185, v185, v18
    v_mul_f32 v186, v186, v18
    v_mul_f32 v187, v187, v18
    v_cvt_pk_bf16_f32 v240, v176, v177
    v_cvt_pk_bf16_f32 v241, v178, v179
    v_cvt_pk_bf16_f32 v242, v180, v181
    v_cvt_pk_bf16_f32 v243, v182, v183
    v_cvt_pk_bf16_f32 v244, v184, v185
    v_cvt_pk_bf16_f32 v245, v186, v187
    s_waitcnt lgkmcnt(12)
    v_mfma_f32_32x32x16_bf16 v[176:191], v[10:13], a[208:211], 0
    v_mfma_f32_32x32x16_bf16 v[176:191], v[14:17], a[212:215], v[176:191]
    buffer_load_dwordx4 v[92:95], v1, s[16:19], s25 offen offset:3072 sc1
    buffer_load_dwordx4 v[96:99], v2, s[16:19], s25 offen offset:0 sc1
    buffer_load_dwordx4 v[64:67], v1, s[16:19], s24 offen offset:0 sc1
    buffer_load_dwordx4 v[68:71], v1, s[16:19], s24 offen offset:1024 sc1
    ds_write_b64 v6, v[240:241] offset:11264
    ds_write_b64 v7, v[242:243] offset:11264
    ds_write_b64 v20, v[244:245] offset:11264
    v_cndmask_b32 v18, v204, v200, vcc
    v_add_f32 v18, 0x358637bd, v18
    v_rcp_f32 v18, v18
    s_nop 0
    v_mul_f32 v18, v18, v228
    v_mul_f32 v192, v192, v18
    v_mul_f32 v193, v193, v18
    v_mul_f32 v194, v194, v18
    v_mul_f32 v195, v195, v18
    v_mul_f32 v196, v196, v18
    v_mul_f32 v197, v197, v18
    v_mul_f32 v198, v198, v18
    v_mul_f32 v199, v199, v18
    v_mul_f32 v200, v200, v18
    v_mul_f32 v201, v201, v18
    v_mul_f32 v202, v202, v18
    v_mul_f32 v203, v203, v18
    v_cvt_pk_bf16_f32 v232, v192, v193
    v_cvt_pk_bf16_f32 v233, v194, v195
    v_cvt_pk_bf16_f32 v234, v196, v197
    v_cvt_pk_bf16_f32 v235, v198, v199
    v_cvt_pk_bf16_f32 v236, v200, v201
    v_cvt_pk_bf16_f32 v237, v202, v203
    s_waitcnt lgkmcnt(12)
    v_mfma_f32_32x32x16_bf16 v[192:207], v[10:13], a[216:219], 0
    v_mfma_f32_32x32x16_bf16 v[192:207], v[14:17], a[220:223], v[192:207]
    buffer_load_dwordx4 v[72:75], v1, s[16:19], s24 offen offset:2048 sc1
    buffer_load_dwordx4 v[76:79], v1, s[16:19], s24 offen offset:3072 sc1
    s_add_u32 s24, s50, 98304
    s_add_u32 s25, s54, 122880
    ds_write_b64 v6, v[232:233] offset:20480
    ds_write_b64 v7, v[234:235] offset:20480
    ds_write_b64 v20, v[236:237] offset:20480
    v_cndmask_b32 v18, v220, v216, vcc
    v_add_f32 v18, 0x358637bd, v18
    v_rcp_f32 v18, v18
    s_nop 0
    v_mul_f32 v18, v18, v229
    v_mul_f32 v208, v208, v18
    v_mul_f32 v209, v209, v18
    v_mul_f32 v210, v210, v18
    v_mul_f32 v211, v211, v18
    v_mul_f32 v212, v212, v18
    v_mul_f32 v213, v213, v18
    v_mul_f32 v214, v214, v18
    v_mul_f32 v215, v215, v18
    v_mul_f32 v216, v216, v18
    v_mul_f32 v217, v217, v18
    v_mul_f32 v218, v218, v18
    v_mul_f32 v219, v219, v18
    v_cvt_pk_bf16_f32 v240, v208, v209
    v_cvt_pk_bf16_f32 v241, v210, v211
    v_cvt_pk_bf16_f32 v242, v212, v213
    v_cvt_pk_bf16_f32 v243, v214, v215
    v_cvt_pk_bf16_f32 v244, v216, v217
    v_cvt_pk_bf16_f32 v245, v218, v219
    buffer_load_dwordx4 v[116:119], v1, s[16:19], s25 offen offset:0 sc1
    buffer_load_dwordx4 v[120:123], v1, s[16:19], s25 offen offset:1024 sc1
    buffer_load_dwordx4 v[124:127], v1, s[16:19], s25 offen offset:2048 sc1
    buffer_load_dwordx4 v[128:131], v1, s[16:19], s25 offen offset:3072 sc1
    ds_write_b64 v6, v[240:241] offset:21504
    ds_write_b64 v7, v[242:243] offset:21504
    ds_write_b64 v20, v[244:245] offset:21504
    v_cndmask_b32 v18, v188, v184, vcc
    v_add_f32 v18, 0x358637bd, v18
    v_rcp_f32 v18, v18
    s_nop 0
    v_mul_f32 v18, v18, v230
    v_mul_f32 v176, v176, v18
    v_mul_f32 v177, v177, v18
    v_mul_f32 v178, v178, v18
    v_mul_f32 v179, v179, v18
    v_mul_f32 v180, v180, v18
    v_mul_f32 v181, v181, v18
    v_mul_f32 v182, v182, v18
    v_mul_f32 v183, v183, v18
    v_mul_f32 v184, v184, v18
    v_mul_f32 v185, v185, v18
    v_mul_f32 v186, v186, v18
    v_mul_f32 v187, v187, v18
    v_cvt_pk_bf16_f32 v232, v176, v177
    v_cvt_pk_bf16_f32 v233, v178, v179
    v_cvt_pk_bf16_f32 v234, v180, v181
    v_cvt_pk_bf16_f32 v235, v182, v183
    v_cvt_pk_bf16_f32 v236, v184, v185
    v_cvt_pk_bf16_f32 v237, v186, v187
    buffer_load_dwordx4 v[132:135], v2, s[16:19], s25 offen offset:0 sc1
    buffer_load_dwordx4 v[100:103], v1, s[16:19], s24 offen offset:0 sc1
    buffer_load_dwordx4 v[104:107], v1, s[16:19], s24 offen offset:1024 sc1
    buffer_load_dwordx4 v[108:111], v1, s[16:19], s24 offen offset:2048 sc1
    ds_write_b64 v6, v[232:233] offset:30720
    ds_write_b64 v7, v[234:235] offset:30720
    ds_write_b64 v20, v[236:237] offset:30720
    v_cndmask_b32 v18, v204, v200, vcc
    v_add_f32 v18, 0x358637bd, v18
    v_rcp_f32 v18, v18
    s_nop 0
    v_mul_f32 v18, v18, v231
    v_mul_f32 v192, v192, v18
    v_mul_f32 v193, v193, v18
    v_mul_f32 v194, v194, v18
    v_mul_f32 v195, v195, v18
    v_mul_f32 v196, v196, v18
    v_mul_f32 v197, v197, v18
    v_mul_f32 v198, v198, v18
    v_mul_f32 v199, v199, v18
    v_mul_f32 v200, v200, v18
    v_mul_f32 v201, v201, v18
    v_mul_f32 v202, v202, v18
    v_mul_f32 v203, v203, v18
    v_cvt_pk_bf16_f32 v240, v192, v193
    v_cvt_pk_bf16_f32 v241, v194, v195
    v_cvt_pk_bf16_f32 v242, v196, v197
    v_cvt_pk_bf16_f32 v243, v198, v199
    v_cvt_pk_bf16_f32 v244, v200, v201
    v_cvt_pk_bf16_f32 v245, v202, v203
    buffer_load_dwordx4 v[112:115], v1, s[16:19], s24 offen offset:3072 sc1
    ds_write_b64 v6, v[240:241] offset:31744
    ds_write_b64 v7, v[242:243] offset:31744
    ds_write_b64 v20, v[244:245] offset:31744
    s_waitcnt lgkmcnt(0)
    s_barrier
    ds_read_b128 v[176:179], v22 offset:0
    ds_read_b128 v[180:183], v22 offset:1024
    ds_read_b128 v[184:187], v22 offset:2048
    ds_read_b128 v[188:191], v22 offset:3072
    ds_read_b128 v[192:195], v22 offset:4096
    ds_read_b128 v[196:199], v22 offset:5120
    ds_read_b128 v[200:203], v22 offset:6144
    ds_read_b128 v[204:207], v22 offset:7168
    ds_read_b128 v[208:211], v22 offset:8192
    ds_read_b128 v[212:215], v22 offset:9216
    s_waitcnt lgkmcnt(9)
    buffer_store_dwordx4 v[176:179], v21, s[16:19], s66 offen offset:0 sc1
    s_waitcnt lgkmcnt(8)
    buffer_store_dwordx4 v[180:183], v21, s[16:19], s66 offen offset:2048 sc1
    s_waitcnt lgkmcnt(7)
    buffer_store_dwordx4 v[184:187], v21, s[16:19], s67 offen offset:0 sc1
    s_waitcnt lgkmcnt(6)
    buffer_store_dwordx4 v[188:191], v21, s[16:19], s67 offen offset:2048 sc1
    s_waitcnt lgkmcnt(5)
    buffer_store_dwordx4 v[192:195], v21, s[16:19], s68 offen offset:0 sc1
    s_waitcnt lgkmcnt(4)
    buffer_store_dwordx4 v[196:199], v21, s[16:19], s68 offen offset:2048 sc1
    s_waitcnt lgkmcnt(3)
    buffer_store_dwordx4 v[200:203], v21, s[16:19], s69 offen offset:0 sc1
    s_waitcnt lgkmcnt(2)
    buffer_store_dwordx4 v[204:207], v21, s[16:19], s69 offen offset:2048 sc1
    s_waitcnt lgkmcnt(1)
    buffer_store_dwordx4 v[208:211], v21, s[16:19], s70 offen offset:0 sc1
    s_waitcnt lgkmcnt(0)
    buffer_store_dwordx4 v[212:215], v21, s[16:19], s70 offen offset:2048 sc1
    buffer_load_dwordx4 a[244:247], off, s[16:19], s48 sc1
    s_add_u32 s24, s50, 147456
    s_add_u32 s25, s54, 184320
    buffer_load_dwordx4 v[152:155], v1, s[16:19], s25 offen offset:0 sc1
    buffer_load_dwordx4 v[156:159], v1, s[16:19], s25 offen offset:1024 sc1
    buffer_load_dwordx4 v[160:163], v1, s[16:19], s25 offen offset:2048 sc1
    buffer_load_dwordx4 v[164:167], v1, s[16:19], s25 offen offset:3072 sc1
    buffer_load_dwordx4 v[168:171], v2, s[16:19], s25 offen offset:0 sc1
    buffer_load_dwordx4 v[136:139], v1, s[16:19], s24 offen offset:0 sc1
    buffer_load_dwordx4 v[140:143], v1, s[16:19], s24 offen offset:1024 sc1
    buffer_load_dwordx4 v[144:147], v1, s[16:19], s24 offen offset:2048 sc1
    buffer_load_dwordx4 v[148:151], v1, s[16:19], s24 offen offset:3072 sc1
    s_cmp_lg_u32 s20, 0
    s_cbranch_scc1 P2Kb_ok
    s_waitcnt vmcnt(9)
    s_mov_b32 s38, 0
    s_branch P2Kb_c
P2Kb_l:
    s_sleep 8
    buffer_load_dwordx4 a[244:247], off, s[16:19], s48 sc1
    s_add_u32 s38, s38, 1
    s_waitcnt vmcnt(0)
    s_cmp_ge_u32 s38, 0x20000
    s_cbranch_scc1 P2Kb_ok
P2Kb_c:
    v_accvgpr_read_b32 v19, a244
    s_nop 1
    v_readfirstlane_b32 s37, v19
    s_bfe_u32 s37, s37, 524296
    s_cmp_ge_u32 s37, 8
    s_cbranch_scc0 P2Kb_l
P2Kb_ok:
    s_barrier
    s_add_u32 s24, s51, 0
    s_add_u32 s25, s55, 0
    buffer_load_dwordx4 a[96:99], v1, s[16:19], s25 offen offset:0 sc1
    buffer_load_dwordx4 a[100:103], v1, s[16:19], s25 offen offset:1024 sc1
    buffer_load_dwordx4 a[104:107], v1, s[16:19], s25 offen offset:2048 sc1
    buffer_load_dwordx4 a[108:111], v1, s[16:19], s25 offen offset:3072 sc1
    buffer_load_dwordx4 a[112:115], v2, s[16:19], s25 offen offset:0 sc1
    buffer_load_dwordx4 a[80:83], v1, s[16:19], s24 offen offset:0 sc1
    buffer_load_dwordx4 a[84:87], v1, s[16:19], s24 offen offset:1024 sc1
    buffer_load_dwordx4 a[88:91], v1, s[16:19], s24 offen offset:2048 sc1
    buffer_load_dwordx4 a[92:95], v1, s[16:19], s24 offen offset:3072 sc1
    s_waitcnt vmcnt(19)
    s_barrier
    v_mov_b32 v10, 1
    v_lshlrev_b32 v11, 7, v3
    s_mov_b64 exec, 1
    s_mov_b32 exec_lo, 3
    buffer_atomic_add v10, v11, s[16:19], s45 offen offset:0 sc1
    s_mov_b64 exec, -1
    v_mfma_f32_16x16x32_bf16 a[0:3], v[44:47], v[28:31], 0
    buffer_load_dwordx4 a[244:247], off, s[16:19], s48 sc1
    v_mfma_f32_16x16x32_bf16 a[4:7], v[48:51], v[28:31], 0
    s_add_u32 s24, s51, 49152
    v_mfma_f32_16x16x32_bf16 a[8:11], v[52:55], v[28:31], 0
    s_add_u32 s25, s55, 61440
    v_mfma_f32_16x16x32_bf16 a[12:15], v[56:59], v[28:31], 0
    buffer_load_dwordx4 a[132:135], v1, s[16:19], s25 offen offset:0 sc1
    v_mfma_f32_16x16x32_bf16 a[16:19], v[60:63], v[28:31], 0
    buffer_load_dwordx4 a[136:139], v1, s[16:19], s25 offen offset:1024 sc1
    v_mfma_f32_16x16x32_bf16 a[20:23], v[44:47], v[32:35], 0
    buffer_load_dwordx4 a[140:143], v1, s[16:19], s25 offen offset:2048 sc1
    v_mfma_f32_16x16x32_bf16 a[24:27], v[48:51], v[32:35], 0
    buffer_load_dwordx4 a[144:147], v1, s[16:19], s25 offen offset:3072 sc1
    v_mfma_f32_16x16x32_bf16 a[28:31], v[52:55], v[32:35], 0
    buffer_load_dwordx4 a[148:151], v2, s[16:19], s25 offen offset:0 sc1
    v_mfma_f32_16x16x32_bf16 a[32:35], v[56:59], v[32:35], 0
    buffer_load_dwordx4 a[116:119], v1, s[16:19], s24 offen offset:0 sc1
    v_mfma_f32_16x16x32_bf16 a[36:39], v[60:63], v[32:35], 0
    buffer_load_dwordx4 a[120:123], v1, s[16:19], s24 offen offset:1024 sc1
    v_mfma_f32_16x16x32_bf16 a[40:43], v[44:47], v[36:39], 0
    buffer_load_dwordx4 a[124:127], v1, s[16:19], s24 offen offset:2048 sc1
    v_mfma_f32_16x16x32_bf16 a[44:47], v[48:51], v[36:39], 0
    buffer_load_dwordx4 a[128:131], v1, s[16:19], s24 offen offset:3072 sc1
    v_mfma_f32_16x16x32_bf16 a[48:51], v[52:55], v[36:39], 0
    v_mfma_f32_16x16x32_bf16 a[52:55], v[56:59], v[36:39], 0
    v_mfma_f32_16x16x32_bf16 a[56:59], v[60:63], v[36:39], 0
    v_mfma_f32_16x16x32_bf16 a[60:63], v[44:47], v[40:43], 0
    v_mfma_f32_16x16x32_bf16 a[64:67], v[48:51], v[40:43], 0
    v_mfma_f32_16x16x32_bf16 a[68:71], v[52:55], v[40:43], 0
    v_mfma_f32_16x16x32_bf16 a[72:75], v[56:59], v[40:43], 0
    v_mfma_f32_16x16x32_bf16 a[76:79], v[60:63], v[40:43], 0
    v_mfma_f32_16x16x32_bf16 a[0:3], v[80:83], v[64:67], a[0:3]
    s_add_u32 s24, s51, 98304
    v_mfma_f32_16x16x32_bf16 a[4:7], v[84:87], v[64:67], a[4:7]
    s_add_u32 s25, s55, 122880
    v_mfma_f32_16x16x32_bf16 a[8:11], v[88:91], v[64:67], a[8:11]
    buffer_load_dwordx4 v[44:47], v1, s[16:19], s25 offen offset:0 sc1
    v_mfma_f32_16x16x32_bf16 a[12:15], v[92:95], v[64:67], a[12:15]
    buffer_load_dwordx4 v[48:51], v1, s[16:19], s25 offen offset:1024 sc1
    v_mfma_f32_16x16x32_bf16 a[16:19], v[96:99], v[64:67], a[16:19]
    buffer_load_dwordx4 v[52:55], v1, s[16:19], s25 offen offset:2048 sc1
    v_mfma_f32_16x16x32_bf16 a[20:23], v[80:83], v[68:71], a[20:23]
    buffer_load_dwordx4 v[56:59], v1, s[16:19], s25 offen offset:3072 sc1
    v_mfma_f32_16x16x32_bf16 a[24:27], v[84:87], v[68:71], a[24:27]
    buffer_load_dwordx4 v[60:63], v2, s[16:19], s25 offen offset:0 sc1
    v_mfma_f32_16x16x32_bf16 a[28:31], v[88:91], v[68:71], a[28:31]
    buffer_load_dwordx4 v[28:31], v1, s[16:19], s24 offen offset:0 sc1
    v_mfma_f32_16x16x32_bf16 a[32:35], v[92:95], v[68:71], a[32:35]
    buffer_load_dwordx4 v[32:35], v1, s[16:19], s24 offen offset:1024 sc1
    v_mfma_f32_16x16x32_bf16 a[36:39], v[96:99], v[68:71], a[36:39]
    buffer_load_dwordx4 v[36:39], v1, s[16:19], s24 offen offset:2048 sc1
    v_mfma_f32_16x16x32_bf16 a[40:43], v[80:83], v[72:75], a[40:43]
    buffer_load_dwordx4 v[40:43], v1, s[16:19], s24 offen offset:3072 sc1
    v_mfma_f32_16x16x32_bf16 a[44:47], v[84:87], v[72:75], a[44:47]
    v_mfma_f32_16x16x32_bf16 a[48:51], v[88:91], v[72:75], a[48:51]
    v_mfma_f32_16x16x32_bf16 a[52:55], v[92:95], v[72:75], a[52:55]
    v_mfma_f32_16x16x32_bf16 a[56:59], v[96:99], v[72:75], a[56:59]
    v_mfma_f32_16x16x32_bf16 a[60:63], v[80:83], v[76:79], a[60:63]
    v_mfma_f32_16x16x32_bf16 a[64:67], v[84:87], v[76:79], a[64:67]
    v_mfma_f32_16x16x32_bf16 a[68:71], v[88:91], v[76:79], a[68:71]
    v_mfma_f32_16x16x32_bf16 a[72:75], v[92:95], v[76:79], a[72:75]
    v_mfma_f32_16x16x32_bf16 a[76:79], v[96:99], v[76:79], a[76:79]
    v_mfma_f32_16x16x32_bf16 a[0:3], v[116:119], v[100:103], a[0:3]
    s_add_u32 s24, s51, 147456
    v_mfma_f32_16x16x32_bf16 a[4:7], v[120:123], v[100:103], a[4:7]
    s_add_u32 s25, s55, 184320
    v_mfma_f32_16x16x32_bf16 a[8:11], v[124:127], v[100:103], a[8:11]
    buffer_load_dwordx4 v[80:83], v1, s[16:19], s25 offen offset:0 sc1
    v_mfma_f32_16x16x32_bf16 a[12:15], v[128:131], v[100:103], a[12:15]
    buffer_load_dwordx4 v[84:87], v1, s[16:19], s25 offen offset:1024 sc1
    v_mfma_f32_16x16x32_bf16 a[16:19], v[132:135], v[100:103], a[16:19]
    buffer_load_dwordx4 v[88:91], v1, s[16:19], s25 offen offset:2048 sc1
    v_mfma_f32_16x16x32_bf16 a[20:23], v[116:119], v[104:107], a[20:23]
    buffer_load_dwordx4 v[92:95], v1, s[16:19], s25 offen offset:3072 sc1
    v_mfma_f32_16x16x32_bf16 a[24:27], v[120:123], v[104:107], a[24:27]
    buffer_load_dwordx4 v[96:99], v2, s[16:19], s25 offen offset:0 sc1
    v_mfma_f32_16x16x32_bf16 a[28:31], v[124:127], v[104:107], a[28:31]
    buffer_load_dwordx4 v[64:67], v1, s[16:19], s24 offen offset:0 sc1
    v_mfma_f32_16x16x32_bf16 a[32:35], v[128:131], v[104:107], a[32:35]
    buffer_load_dwordx4 v[68:71], v1, s[16:19], s24 offen offset:1024 sc1
    v_mfma_f32_16x16x32_bf16 a[36:39], v[132:135], v[104:107], a[36:39]
    buffer_load_dwordx4 v[72:75], v1, s[16:19], s24 offen offset:2048 sc1
    v_mfma_f32_16x16x32_bf16 a[40:43], v[116:119], v[108:111], a[40:43]
    buffer_load_dwordx4 v[76:79], v1, s[16:19], s24 offen offset:3072 sc1
    v_mfma_f32_16x16x32_bf16 a[44:47], v[120:123], v[108:111], a[44:47]
    v_mfma_f32_16x16x32_bf16 a[48:51], v[124:127], v[108:111], a[48:51]
    v_mfma_f32_16x16x32_bf16 a[52:55], v[128:131], v[108:111], a[52:55]
    v_mfma_f32_16x16x32_bf16 a[56:59], v[132:135], v[108:111], a[56:59]
    v_mfma_f32_16x16x32_bf16 a[60:63], v[116:119], v[112:115], a[60:63]
    v_mfma_f32_16x16x32_bf16 a[64:67], v[120:123], v[112:115], a[64:67]
    v_mfma_f32_16x16x32_bf16 a[68:71], v[124:127], v[112:115], a[68:71]
    v_mfma_f32_16x16x32_bf16 a[72:75], v[128:131], v[112:115], a[72:75]
    v_mfma_f32_16x16x32_bf16 a[76:79], v[132:135], v[112:115], a[76:79]
    s_waitcnt vmcnt(38)
    s_cmp_lg_u32 s20, 0
    s_cbranch_scc1 P2Kc_ok
    s_waitcnt vmcnt(27)
    s_mov_b32 s38, 0
    s_branch P2Kc_c
P2Kc_l:
    s_sleep 8
    buffer_load_dwordx4 a[244:247], off, s[16:19], s48 sc1
    s_add_u32 s38, s38, 1
    s_waitcnt vmcnt(0)
    s_cmp_ge_u32 s38, 0x20000
    s_cbranch_scc1 P2Kc_ok
P2Kc_c:
    v_accvgpr_read_b32 v10, a244
    s_nop 1
    v_readfirstlane_b32 s37, v10
    s_bfe_u32 s37, s37, 524304
    s_cmp_ge_u32 s37, 11
    s_cbranch_scc0 P2Kc_l
P2Kc_ok:
    s_barrier
    v_mfma_f32_16x16x32_bf16 a[0:3], v[152:155], v[136:139], a[0:3]
    s_add_u32 s24, s52, 0
    v_mfma_f32_16x16x32_bf16 a[4:7], v[156:159], v[136:139], a[4:7]
    s_add_u32 s25, s56, 0
    v_mfma_f32_16x16x32_bf16 a[8:11], v[160:163], v[136:139], a[8:11]
    buffer_load_dwordx4 v[116:119], v1, s[16:19], s25 offen offset:0 sc1
    v_mfma_f32_16x16x32_bf16 a[12:15], v[164:167], v[136:139], a[12:15]
    buffer_load_dwordx4 v[120:123], v1, s[16:19], s25 offen offset:1024 sc1
    v_mfma_f32_16x16x32_bf16 a[16:19], v[168:171], v[136:139], a[16:19]
    buffer_load_dwordx4 v[124:127], v1, s[16:19], s25 offen offset:2048 sc1
    v_mfma_f32_16x16x32_bf16 a[20:23], v[152:155], v[140:143], a[20:23]
    buffer_load_dwordx4 v[128:131], v1, s[16:19], s25 offen offset:3072 sc1
    v_mfma_f32_16x16x32_bf16 a[24:27], v[156:159], v[140:143], a[24:27]
    buffer_load_dwordx4 v[132:135], v2, s[16:19], s25 offen offset:0 sc1
    v_mfma_f32_16x16x32_bf16 a[28:31], v[160:163], v[140:143], a[28:31]
    buffer_load_dwordx4 v[100:103], v1, s[16:19], s24 offen offset:0 sc1
    v_mfma_f32_16x16x32_bf16 a[32:35], v[164:167], v[140:143], a[32:35]
    buffer_load_dwordx4 v[104:107], v1, s[16:19], s24 offen offset:1024 sc1
    v_mfma_f32_16x16x32_bf16 a[36:39], v[168:171], v[140:143], a[36:39]
    buffer_load_dwordx4 v[108:111], v1, s[16:19], s24 offen offset:2048 sc1
    v_mfma_f32_16x16x32_bf16 a[40:43], v[152:155], v[144:147], a[40:43]
    buffer_load_dwordx4 v[112:115], v1, s[16:19], s24 offen offset:3072 sc1
    v_mfma_f32_16x16x32_bf16 a[44:47], v[156:159], v[144:147], a[44:47]
    v_mfma_f32_16x16x32_bf16 a[48:51], v[160:163], v[144:147], a[48:51]
    v_mfma_f32_16x16x32_bf16 a[52:55], v[164:167], v[144:147], a[52:55]
    v_mfma_f32_16x16x32_bf16 a[56:59], v[168:171], v[144:147], a[56:59]
    v_mfma_f32_16x16x32_bf16 a[60:63], v[152:155], v[148:151], a[60:63]
    v_mfma_f32_16x16x32_bf16 a[64:67], v[156:159], v[148:151], a[64:67]
    v_mfma_f32_16x16x32_bf16 a[68:71], v[160:163], v[148:151], a[68:71]
    v_mfma_f32_16x16x32_bf16 a[72:75], v[164:167], v[148:151], a[72:75]
    v_mfma_f32_16x16x32_bf16 a[76:79], v[168:171], v[148:151], a[76:79]
    s_waitcnt vmcnt(38)
    v_mfma_f32_16x16x32_bf16 a[0:3], a[96:99], a[80:83], a[0:3]
    s_add_u32 s24, s52, 49152
    v_mfma_f32_16x16x32_bf16 a[4:7], a[100:103], a[80:83], a[4:7]
    s_add_u32 s25, s56, 61440
    v_mfma_f32_16x16x32_bf16 a[8:11], a[104:107], a[80:83], a[8:11]
    buffer_load_dwordx4 v[152:155], v1, s[16:19], s25 offen offset:0 sc1
    v_mfma_f32_16x16x32_bf16 a[12:15], a[108:111], a[80:83], a[12:15]
    buffer_load_dwordx4 v[156:159], v1, s[16:19], s25 offen offset:1024 sc1
    v_mfma_f32_16x16x32_bf16 a[16:19], a[112:115], a[80:83], a[16:19]
    buffer_load_dwordx4 v[160:163], v1, s[16:19], s25 offen offset:2048 sc1
    v_mfma_f32_16x16x32_bf16 a[20:23], a[96:99], a[84:87], a[20:23]
    buffer_load_dwordx4 v[164:167], v1, s[16:19], s25 offen offset:3072 sc1
    v_mfma_f32_16x16x32_bf16 a[24:27], a[100:103], a[84:87], a[24:27]
    buffer_load_dwordx4 v[168:171], v2, s[16:19], s25 offen offset:0 sc1
    v_mfma_f32_16x16x32_bf16 a[28:31], a[104:107], a[84:87], a[28:31]
    buffer_load_dwordx4 v[136:139], v1, s[16:19], s24 offen offset:0 sc1
    v_mfma_f32_16x16x32_bf16 a[32:35], a[108:111], a[84:87], a[32:35]
    buffer_load_dwordx4 v[140:143], v1, s[16:19], s24 offen offset:1024 sc1
    v_mfma_f32_16x16x32_bf16 a[36:39], a[112:115], a[84:87], a[36:39]
    buffer_load_dwordx4 v[144:147], v1, s[16:19], s24 offen offset:2048 sc1
    v_mfma_f32_16x16x32_bf16 a[40:43], a[96:99], a[88:91], a[40:43]
    buffer_load_dwordx4 v[148:151], v1, s[16:19], s24 offen offset:3072 sc1
    v_mfma_f32_16x16x32_bf16 a[44:47], a[100:103], a[88:91], a[44:47]
    v_mfma_f32_16x16x32_bf16 a[48:51], a[104:107], a[88:91], a[48:51]
    v_mfma_f32_16x16x32_bf16 a[52:55], a[108:111], a[88:91], a[52:55]
    v_mfma_f32_16x16x32_bf16 a[56:59], a[112:115], a[88:91], a[56:59]
    v_mfma_f32_16x16x32_bf16 a[60:63], a[96:99], a[92:95], a[60:63]
    v_mfma_f32_16x16x32_bf16 a[64:67], a[100:103], a[92:95], a[64:67]
    v_mfma_f32_16x16x32_bf16 a[68:71], a[104:107], a[92:95], a[68:71]
    v_mfma_f32_16x16x32_bf16 a[72:75], a[108:111], a[92:95], a[72:75]
    v_mfma_f32_16x16x32_bf16 a[76:79], a[112:115], a[92:95], a[76:79]
    s_waitcnt vmcnt(36)
    v_mfma_f32_16x16x32_bf16 a[0:3], a[132:135], a[116:119], a[0:3]
    s_add_u32 s24, s52, 98304
    v_mfma_f32_16x16x32_bf16 a[4:7], a[136:139], a[116:119], a[4:7]
    s_add_u32 s25, s56, 122880
    v_mfma_f32_16x16x32_bf16 a[8:11], a[140:143], a[116:119], a[8:11]
    buffer_load_dwordx4 a[96:99], v1, s[16:19], s25 offen offset:0 sc1
    v_mfma_f32_16x16x32_bf16 a[12:15], a[144:147], a[116:119], a[12:15]
    buffer_load_dwordx4 a[100:103], v1, s[16:19], s25 offen offset:1024 sc1
    v_mfma_f32_16x16x32_bf16 a[16:19], a[148:151], a[116:119], a[16:19]
    buffer_load_dwordx4 a[104:107], v1, s[16:19], s25 offen offset:2048 sc1
    v_mfma_f32_16x16x32_bf16 a[20:23], a[132:135], a[120:123], a[20:23]
    buffer_load_dwordx4 a[108:111], v1, s[16:19], s25 offen offset:3072 sc1
    v_mfma_f32_16x16x32_bf16 a[24:27], a[136:139], a[120:123], a[24:27]
    buffer_load_dwordx4 a[112:115], v2, s[16:19], s25 offen offset:0 sc1
    v_mfma_f32_16x16x32_bf16 a[28:31], a[140:143], a[120:123], a[28:31]
    buffer_load_dwordx4 a[80:83], v1, s[16:19], s24 offen offset:0 sc1
    v_mfma_f32_16x16x32_bf16 a[32:35], a[144:147], a[120:123], a[32:35]
    buffer_load_dwordx4 a[84:87], v1, s[16:19], s24 offen offset:1024 sc1
    v_mfma_f32_16x16x32_bf16 a[36:39], a[148:151], a[120:123], a[36:39]
    buffer_load_dwordx4 a[88:91], v1, s[16:19], s24 offen offset:2048 sc1
    v_mfma_f32_16x16x32_bf16 a[40:43], a[132:135], a[124:127], a[40:43]
    buffer_load_dwordx4 a[92:95], v1, s[16:19], s24 offen offset:3072 sc1
    v_mfma_f32_16x16x32_bf16 a[44:47], a[136:139], a[124:127], a[44:47]
    v_mfma_f32_16x16x32_bf16 a[48:51], a[140:143], a[124:127], a[48:51]
    v_mfma_f32_16x16x32_bf16 a[52:55], a[144:147], a[124:127], a[52:55]
    v_mfma_f32_16x16x32_bf16 a[56:59], a[148:151], a[124:127], a[56:59]
    v_mfma_f32_16x16x32_bf16 a[60:63], a[132:135], a[128:131], a[60:63]
    v_mfma_f32_16x16x32_bf16 a[64:67], a[136:139], a[128:131], a[64:67]
    v_mfma_f32_16x16x32_bf16 a[68:71], a[140:143], a[128:131], a[68:71]
    v_mfma_f32_16x16x32_bf16 a[72:75], a[144:147], a[128:131], a[72:75]
    v_mfma_f32_16x16x32_bf16 a[76:79], a[148:151], a[128:131], a[76:79]
    s_waitcnt vmcnt(36)
    v_mfma_f32_16x16x32_bf16 a[0:3], v[44:47], v[28:31], a[0:3]
    buffer_load_dwordx4 a[244:247], off, s[16:19], s48 sc1
    v_mfma_f32_16x16x32_bf16 a[4:7], v[48:51], v[28:31], a[4:7]
    s_add_u32 s24, s52, 147456
    v_mfma_f32_16x16x32_bf16 a[8:11], v[52:55], v[28:31], a[8:11]
    s_add_u32 s25, s56, 184320
    v_mfma_f32_16x16x32_bf16 a[12:15], v[56:59], v[28:31], a[12:15]
    buffer_load_dwordx4 a[132:135], v1, s[16:19], s25 offen offset:0 sc1
    v_mfma_f32_16x16x32_bf16 a[16:19], v[60:63], v[28:31], a[16:19]
    buffer_load_dwordx4 a[136:139], v1, s[16:19], s25 offen offset:1024 sc1
    v_mfma_f32_16x16x32_bf16 a[20:23], v[44:47], v[32:35], a[20:23]
    buffer_load_dwordx4 a[140:143], v1, s[16:19], s25 offen offset:2048 sc1
    v_mfma_f32_16x16x32_bf16 a[24:27], v[48:51], v[32:35], a[24:27]
    buffer_load_dwordx4 a[144:147], v1, s[16:19], s25 offen offset:3072 sc1
    v_mfma_f32_16x16x32_bf16 a[28:31], v[52:55], v[32:35], a[28:31]
    buffer_load_dwordx4 a[148:151], v2, s[16:19], s25 offen offset:0 sc1
    v_mfma_f32_16x16x32_bf16 a[32:35], v[56:59], v[32:35], a[32:35]
    buffer_load_dwordx4 a[116:119], v1, s[16:19], s24 offen offset:0 sc1
    v_mfma_f32_16x16x32_bf16 a[36:39], v[60:63], v[32:35], a[36:39]
    buffer_load_dwordx4 a[120:123], v1, s[16:19], s24 offen offset:1024 sc1
    v_mfma_f32_16x16x32_bf16 a[40:43], v[44:47], v[36:39], a[40:43]
    buffer_load_dwordx4 a[124:127], v1, s[16:19], s24 offen offset:2048 sc1
    v_mfma_f32_16x16x32_bf16 a[44:47], v[48:51], v[36:39], a[44:47]
    buffer_load_dwordx4 a[128:131], v1, s[16:19], s24 offen offset:3072 sc1
    v_mfma_f32_16x16x32_bf16 a[48:51], v[52:55], v[36:39], a[48:51]
    v_mfma_f32_16x16x32_bf16 a[52:55], v[56:59], v[36:39], a[52:55]
    v_mfma_f32_16x16x32_bf16 a[56:59], v[60:63], v[36:39], a[56:59]
    v_mfma_f32_16x16x32_bf16 a[60:63], v[44:47], v[40:43], a[60:63]
    v_mfma_f32_16x16x32_bf16 a[64:67], v[48:51], v[40:43], a[64:67]
    v_mfma_f32_16x16x32_bf16 a[68:71], v[52:55], v[40:43], a[68:71]
    v_mfma_f32_16x16x32_bf16 a[72:75], v[56:59], v[40:43], a[72:75]
    v_mfma_f32_16x16x32_bf16 a[76:79], v[60:63], v[40:43], a[76:79]
    s_waitcnt vmcnt(37)
    v_mfma_f32_16x16x32_bf16 a[0:3], v[80:83], v[64:67], a[0:3]
    s_add_u32 s24, s53, 196608
    v_mfma_f32_16x16x32_bf16 a[4:7], v[84:87], v[64:67], a[4:7]
    s_add_u32 s25, s57, 245760
    v_mfma_f32_16x16x32_bf16 a[8:11], v[88:91], v[64:67], a[8:11]
    buffer_load_dwordx4 v[44:47], v1, s[16:19], s25 offen offset:0 sc1
    v_mfma_f32_16x16x32_bf16 a[12:15], v[92:95], v[64:67], a[12:15]
    buffer_load_dwordx4 v[48:51], v1, s[16:19], s25 offen offset:1024 sc1
    v_mfma_f32_16x16x32_bf16 a[16:19], v[96:99], v[64:67], a[16:19]
    buffer_load_dwordx4 v[52:55], v1, s[16:19], s25 offen offset:2048 sc1
    v_mfma_f32_16x16x32_bf16 a[20:23], v[80:83], v[68:71], a[20:23]
    buffer_load_dwordx4 v[56:59], v1, s[16:19], s25 offen offset:3072 sc1
    v_mfma_f32_16x16x32_bf16 a[24:27], v[84:87], v[68:71], a[24:27]
    buffer_load_dwordx4 v[60:63], v2, s[16:19], s25 offen offset:0 sc1
    v_mfma_f32_16x16x32_bf16 a[28:31], v[88:91], v[68:71], a[28:31]
    buffer_load_dwordx4 v[28:31], v1, s[16:19], s24 offen offset:0 sc1
    v_mfma_f32_16x16x32_bf16 a[32:35], v[92:95], v[68:71], a[32:35]
    buffer_load_dwordx4 v[32:35], v1, s[16:19], s24 offen offset:1024 sc1
    v_mfma_f32_16x16x32_bf16 a[36:39], v[96:99], v[68:71], a[36:39]
    buffer_load_dwordx4 v[36:39], v1, s[16:19], s24 offen offset:2048 sc1
    v_mfma_f32_16x16x32_bf16 a[40:43], v[80:83], v[72:75], a[40:43]
    buffer_load_dwordx4 v[40:43], v1, s[16:19], s24 offen offset:3072 sc1
    v_mfma_f32_16x16x32_bf16 a[44:47], v[84:87], v[72:75], a[44:47]
    v_mfma_f32_16x16x32_bf16 a[48:51], v[88:91], v[72:75], a[48:51]
    v_mfma_f32_16x16x32_bf16 a[52:55], v[92:95], v[72:75], a[52:55]
    v_mfma_f32_16x16x32_bf16 a[56:59], v[96:99], v[72:75], a[56:59]
    v_mfma_f32_16x16x32_bf16 a[60:63], v[80:83], v[76:79], a[60:63]
    v_mfma_f32_16x16x32_bf16 a[64:67], v[84:87], v[76:79], a[64:67]
    v_mfma_f32_16x16x32_bf16 a[68:71], v[88:91], v[76:79], a[68:71]
    v_mfma_f32_16x16x32_bf16 a[72:75], v[92:95], v[76:79], a[72:75]
    v_mfma_f32_16x16x32_bf16 a[76:79], v[96:99], v[76:79], a[76:79]
    s_waitcnt vmcnt(37)
    v_mfma_f32_16x16x32_bf16 a[0:3], v[116:119], v[100:103], a[0:3]
    s_add_u32 s24, s53, 212992
    v_mfma_f32_16x16x32_bf16 a[4:7], v[120:123], v[100:103], a[4:7]
    s_add_u32 s25, s57, 266240
    v_mfma_f32_16x16x32_bf16 a[8:11], v[124:127], v[100:103], a[8:11]
    s_cmp_lt_u32 s20, 2
    v_mfma_f32_16x16x32_bf16 a[12:15], v[128:131], v[100:103], a[12:15]
    s_cselect_b32 s24, s24, 2130706432
    v_mfma_f32_16x16x32_bf16 a[16:19], v[132:135], v[100:103], a[16:19]
    s_cselect_b32 s25, s25, 2130706432
    v_mfma_f32_16x16x32_bf16 a[20:23], v[116:119], v[104:107], a[20:23]
    buffer_load_dwordx4 v[80:83], v1, s[16:19], s25 offen offset:0 sc1
    v_mfma_f32_16x16x32_bf16 a[24:27], v[120:123], v[104:107], a[24:27]
    buffer_load_dwordx4 v[84:87], v1, s[16:19], s25 offen offset:1024 sc1
    v_mfma_f32_16x16x32_bf16 a[28:31], v[124:127], v[104:107], a[28:31]
    buffer_load_dwordx4 v[88:91], v1, s[16:19], s25 offen offset:2048 sc1
    v_mfma_f32_16x16x32_bf16 a[32:35], v[128:131], v[104:107], a[32:35]
    buffer_load_dwordx4 v[92:95], v1, s[16:19], s25 offen offset:3072 sc1
    v_mfma_f32_16x16x32_bf16 a[36:39], v[132:135], v[104:107], a[36:39]
    buffer_load_dwordx4 v[96:99], v2, s[16:19], s25 offen offset:0 sc1
    v_mfma_f32_16x16x32_bf16 a[40:43], v[116:119], v[108:111], a[40:43]
    buffer_load_dwordx4 v[64:67], v1, s[16:19], s24 offen offset:0 sc1
    v_mfma_f32_16x16x32_bf16 a[44:47], v[120:123], v[108:111], a[44:47]
    buffer_load_dwordx4 v[68:71], v1, s[16:19], s24 offen offset:1024 sc1
    v_mfma_f32_16x16x32_bf16 a[48:51], v[124:127], v[108:111], a[48:51]
    buffer_load_dwordx4 v[72:75], v1, s[16:19], s24 offen offset:2048 sc1
    v_mfma_f32_16x16x32_bf16 a[52:55], v[128:131], v[108:111], a[52:55]
    buffer_load_dwordx4 v[76:79], v1, s[16:19], s24 offen offset:3072 sc1
    v_mfma_f32_16x16x32_bf16 a[56:59], v[132:135], v[108:111], a[56:59]
    v_mfma_f32_16x16x32_bf16 a[60:63], v[116:119], v[112:115], a[60:63]
    v_mfma_f32_16x16x32_bf16 a[64:67], v[120:123], v[112:115], a[64:67]
    v_mfma_f32_16x16x32_bf16 a[68:71], v[124:127], v[112:115], a[68:71]
    v_mfma_f32_16x16x32_bf16 a[72:75], v[128:131], v[112:115], a[72:75]
    v_mfma_f32_16x16x32_bf16 a[76:79], v[132:135], v[112:115], a[76:79]
    s_waitcnt vmcnt(37)
    s_cmp_lg_u32 s20, 0
    s_cbranch_scc1 P2Kd_ok
    s_waitcnt vmcnt(27)
    s_mov_b32 s38, 0
    s_branch P2Kd_c
P2Kd_l:
    s_sleep 8
    buffer_load_dwordx4 a[244:247], off, s[16:19], s48 sc1
    s_add_u32 s38, s38, 1
    s_waitcnt vmcnt(0)
    s_cmp_ge_u32 s38, 0x20000
    s_cbranch_scc1 P2Kd_ok
P2Kd_c:
    v_accvgpr_read_b32 v10, a246
    s_nop 1
    v_readfirstlane_b32 s37, v10
    s_bfe_u32 s37, s37, 524288
    s_cmp_ge_u32 s37, 8
    s_cbranch_scc0 P2Kd_l
P2Kd_ok:
    s_barrier
    v_mfma_f32_16x16x32_bf16 a[0:3], v[152:155], v[136:139], a[0:3]
    s_add_u32 s24, s53, 221184
    v_mfma_f32_16x16x32_bf16 a[4:7], v[156:159], v[136:139], a[4:7]
    s_add_u32 s25, s57, 276480
    v_mfma_f32_16x16x32_bf16 a[8:11], v[160:163], v[136:139], a[8:11]
    buffer_load_dwordx4 v[116:119], v1, s[16:19], s25 offen offset:0 sc1
    v_mfma_f32_16x16x32_bf16 a[12:15], v[164:167], v[136:139], a[12:15]
    buffer_load_dwordx4 v[120:123], v1, s[16:19], s25 offen offset:1024 sc1
    v_mfma_f32_16x16x32_bf16 a[16:19], v[168:171], v[136:139], a[16:19]
    buffer_load_dwordx4 v[124:127], v1, s[16:19], s25 offen offset:2048 sc1
    v_mfma_f32_16x16x32_bf16 a[20:23], v[152:155], v[140:143], a[20:23]
    buffer_load_dwordx4 v[128:131], v1, s[16:19], s25 offen offset:3072 sc1
    v_mfma_f32_16x16x32_bf16 a[24:27], v[156:159], v[140:143], a[24:27]
    buffer_load_dwordx4 v[132:135], v2, s[16:19], s25 offen offset:0 sc1
    v_mfma_f32_16x16x32_bf16 a[28:31], v[160:163], v[140:143], a[28:31]
    buffer_load_dwordx4 v[100:103], v1, s[16:19], s24 offen offset:0 sc1
    v_mfma_f32_16x16x32_bf16 a[32:35], v[164:167], v[140:143], a[32:35]
    buffer_load_dwordx4 v[104:107], v1, s[16:19], s24 offen offset:1024 sc1
    v_mfma_f32_16x16x32_bf16 a[36:39], v[168:171], v[140:143], a[36:39]
    buffer_load_dwordx4 v[108:111], v1, s[16:19], s24 offen offset:2048 sc1
    v_mfma_f32_16x16x32_bf16 a[40:43], v[152:155], v[144:147], a[40:43]
    buffer_load_dwordx4 v[112:115], v1, s[16:19], s24 offen offset:3072 sc1
    v_mfma_f32_16x16x32_bf16 a[44:47], v[156:159], v[144:147], a[44:47]
    v_mfma_f32_16x16x32_bf16 a[48:51], v[160:163], v[144:147], a[48:51]
    v_mfma_f32_16x16x32_bf16 a[52:55], v[164:167], v[144:147], a[52:55]
    v_mfma_f32_16x16x32_bf16 a[56:59], v[168:171], v[144:147], a[56:59]
    v_mfma_f32_16x16x32_bf16 a[60:63], v[152:155], v[148:151], a[60:63]
    v_mfma_f32_16x16x32_bf16 a[64:67], v[156:159], v[148:151], a[64:67]
    v_mfma_f32_16x16x32_bf16 a[68:71], v[160:163], v[148:151], a[68:71]
    v_mfma_f32_16x16x32_bf16 a[72:75], v[164:167], v[148:151], a[72:75]
    v_mfma_f32_16x16x32_bf16 a[76:79], v[168:171], v[148:151], a[76:79]
    s_waitcnt vmcnt(37)
    v_mfma_f32_16x16x32_bf16 a[0:3], a[96:99], a[80:83], a[0:3]
    s_add_u32 s24, s53, 237568
    v_mfma_f32_16x16x32_bf16 a[4:7], a[100:103], a[80:83], a[4:7]
    s_add_u32 s25, s57, 296960
    v_mfma_f32_16x16x32_bf16 a[8:11], a[104:107], a[80:83], a[8:11]
    buffer_load_dwordx4 v[152:155], v1, s[16:19], s25 offen offset:0 sc1
    v_mfma_f32_16x16x32_bf16 a[12:15], a[108:111], a[80:83], a[12:15]
    buffer_load_dwordx4 v[156:159], v1, s[16:19], s25 offen offset:1024 sc1
    v_mfma_f32_16x16x32_bf16 a[16:19], a[112:115], a[80:83], a[16:19]
    buffer_load_dwordx4 v[160:163], v1, s[16:19], s25 offen offset:2048 sc1
    v_mfma_f32_16x16x32_bf16 a[20:23], a[96:99], a[84:87], a[20:23]
    buffer_load_dwordx4 v[164:167], v1, s[16:19], s25 offen offset:3072 sc1
    v_mfma_f32_16x16x32_bf16 a[24:27], a[100:103], a[84:87], a[24:27]
    buffer_load_dwordx4 v[168:171], v2, s[16:19], s25 offen offset:0 sc1
    v_mfma_f32_16x16x32_bf16 a[28:31], a[104:107], a[84:87], a[28:31]
    buffer_load_dwordx4 v[136:139], v1, s[16:19], s24 offen offset:0 sc1
    v_mfma_f32_16x16x32_bf16 a[32:35], a[108:111], a[84:87], a[32:35]
    buffer_load_dwordx4 v[140:143], v1, s[16:19], s24 offen offset:1024 sc1
    v_mfma_f32_16x16x32_bf16 a[36:39], a[112:115], a[84:87], a[36:39]
    buffer_load_dwordx4 v[144:147], v1, s[16:19], s24 offen offset:2048 sc1
    v_mfma_f32_16x16x32_bf16 a[40:43], a[96:99], a[88:91], a[40:43]
    buffer_load_dwordx4 v[148:151], v1, s[16:19], s24 offen offset:3072 sc1
    v_mfma_f32_16x16x32_bf16 a[44:47], a[100:103], a[88:91], a[44:47]
    v_mfma_f32_16x16x32_bf16 a[48:51], a[104:107], a[88:91], a[48:51]
    v_mfma_f32_16x16x32_bf16 a[52:55], a[108:111], a[88:91], a[52:55]
    v_mfma_f32_16x16x32_bf16 a[56:59], a[112:115], a[88:91], a[56:59]
    v_mfma_f32_16x16x32_bf16 a[60:63], a[96:99], a[92:95], a[60:63]
    v_mfma_f32_16x16x32_bf16 a[64:67], a[100:103], a[92:95], a[64:67]
    v_mfma_f32_16x16x32_bf16 a[68:71], a[104:107], a[92:95], a[68:71]
    v_mfma_f32_16x16x32_bf16 a[72:75], a[108:111], a[92:95], a[72:75]
    v_mfma_f32_16x16x32_bf16 a[76:79], a[112:115], a[92:95], a[76:79]
    s_waitcnt vmcnt(36)
    v_mfma_f32_16x16x32_bf16 a[0:3], a[132:135], a[116:119], a[0:3]
    s_add_u32 s24, s53, 253952
    v_mfma_f32_16x16x32_bf16 a[4:7], a[136:139], a[116:119], a[4:7]
    s_add_u32 s25, s57, 317440
    v_mfma_f32_16x16x32_bf16 a[8:11], a[140:143], a[116:119], a[8:11]
    buffer_load_dwordx4 a[96:99], v1, s[16:19], s25 offen offset:0 sc1
    v_mfma_f32_16x16x32_bf16 a[12:15], a[144:147], a[116:119], a[12:15]
    buffer_load_dwordx4 a[100:103], v1, s[16:19], s25 offen offset:1024 sc1
    v_mfma_f32_16x16x32_bf16 a[16:19], a[148:151], a[116:119], a[16:19]
    buffer_load_dwordx4 a[104:107], v1, s[16:19], s25 offen offset:2048 sc1
    v_mfma_f32_16x16x32_bf16 a[20:23], a[132:135], a[120:123], a[20:23]
    buffer_load_dwordx4 a[108:111], v1, s[16:19], s25 offen offset:3072 sc1
    v_mfma_f32_16x16x32_bf16 a[24:27], a[136:139], a[120:123], a[24:27]
    buffer_load_dwordx4 a[112:115], v2, s[16:19], s25 offen offset:0 sc1
    v_mfma_f32_16x16x32_bf16 a[28:31], a[140:143], a[120:123], a[28:31]
    buffer_load_dwordx4 a[80:83], v1, s[16:19], s24 offen offset:0 sc1
    v_mfma_f32_16x16x32_bf16 a[32:35], a[144:147], a[120:123], a[32:35]
    buffer_load_dwordx4 a[84:87], v1, s[16:19], s24 offen offset:1024 sc1
    v_mfma_f32_16x16x32_bf16 a[36:39], a[148:151], a[120:123], a[36:39]
    buffer_load_dwordx4 a[88:91], v1, s[16:19], s24 offen offset:2048 sc1
    v_mfma_f32_16x16x32_bf16 a[40:43], a[132:135], a[124:127], a[40:43]
    buffer_load_dwordx4 a[92:95], v1, s[16:19], s24 offen offset:3072 sc1
    v_mfma_f32_16x16x32_bf16 a[44:47], a[136:139], a[124:127], a[44:47]
    v_mfma_f32_16x16x32_bf16 a[48:51], a[140:143], a[124:127], a[48:51]
    v_mfma_f32_16x16x32_bf16 a[52:55], a[144:147], a[124:127], a[52:55]
    v_mfma_f32_16x16x32_bf16 a[56:59], a[148:151], a[124:127], a[56:59]
    v_mfma_f32_16x16x32_bf16 a[60:63], a[132:135], a[128:131], a[60:63]
    v_mfma_f32_16x16x32_bf16 a[64:67], a[136:139], a[128:131], a[64:67]
    v_mfma_f32_16x16x32_bf16 a[68:71], a[140:143], a[128:131], a[68:71]
    v_mfma_f32_16x16x32_bf16 a[72:75], a[144:147], a[128:131], a[72:75]
    v_mfma_f32_16x16x32_bf16 a[76:79], a[148:151], a[128:131], a[76:79]
    s_waitcnt vmcnt(36)
    v_mfma_f32_16x16x32_bf16 a[0:3], v[44:47], v[28:31], a[0:3]
    s_add_u32 s24, s53, 270336
    v_mfma_f32_16x16x32_bf16 a[4:7], v[48:51], v[28:31], a[4:7]
    s_add_u32 s25, s57, 337920
    v_mfma_f32_16x16x32_bf16 a[8:11], v[52:55], v[28:31], a[8:11]
    buffer_load_dwordx4 a[132:135], v1, s[16:19], s25 offen offset:0 sc1
    v_mfma_f32_16x16x32_bf16 a[12:15], v[56:59], v[28:31], a[12:15]
    buffer_load_dwordx4 a[136:139], v1, s[16:19], s25 offen offset:1024 sc1
    v_mfma_f32_16x16x32_bf16 a[16:19], v[60:63], v[28:31], a[16:19]
    buffer_load_dwordx4 a[140:143], v1, s[16:19], s25 offen offset:2048 sc1
    v_mfma_f32_16x16x32_bf16 a[20:23], v[44:47], v[32:35], a[20:23]
    buffer_load_dwordx4 a[144:147], v1, s[16:19], s25 offen offset:3072 sc1
    v_mfma_f32_16x16x32_bf16 a[24:27], v[48:51], v[32:35], a[24:27]
    buffer_load_dwordx4 a[148:151], v2, s[16:19], s25 offen offset:0 sc1
    v_mfma_f32_16x16x32_bf16 a[28:31], v[52:55], v[32:35], a[28:31]
    buffer_load_dwordx4 a[116:119], v1, s[16:19], s24 offen offset:0 sc1
    v_mfma_f32_16x16x32_bf16 a[32:35], v[56:59], v[32:35], a[32:35]
    buffer_load_dwordx4 a[120:123], v1, s[16:19], s24 offen offset:1024 sc1
    v_mfma_f32_16x16x32_bf16 a[36:39], v[60:63], v[32:35], a[36:39]
    buffer_load_dwordx4 a[124:127], v1, s[16:19], s24 offen offset:2048 sc1
    v_mfma_f32_16x16x32_bf16 a[40:43], v[44:47], v[36:39], a[40:43]
    buffer_load_dwordx4 a[128:131], v1, s[16:19], s24 offen offset:3072 sc1
    v_mfma_f32_16x16x32_bf16 a[44:47], v[48:51], v[36:39], a[44:47]
    v_mfma_f32_16x16x32_bf16 a[48:51], v[52:55], v[36:39], a[48:51]
    v_mfma_f32_16x16x32_bf16 a[52:55], v[56:59], v[36:39], a[52:55]
    v_mfma_f32_16x16x32_bf16 a[56:59], v[60:63], v[36:39], a[56:59]
    v_mfma_f32_16x16x32_bf16 a[60:63], v[44:47], v[40:43], a[60:63]
    v_mfma_f32_16x16x32_bf16 a[64:67], v[48:51], v[40:43], a[64:67]
    v_mfma_f32_16x16x32_bf16 a[68:71], v[52:55], v[40:43], a[68:71]
    v_mfma_f32_16x16x32_bf16 a[72:75], v[56:59], v[40:43], a[72:75]
    v_mfma_f32_16x16x32_bf16 a[76:79], v[60:63], v[40:43], a[76:79]
    s_waitcnt vmcnt(36)
    v_mfma_f32_16x16x32_bf16 a[0:3], v[80:83], v[64:67], a[0:3]
    s_add_u32 s24, s53, 286720
    v_mfma_f32_16x16x32_bf16 a[4:7], v[84:87], v[64:67], a[4:7]
    s_add_u32 s25, s57, 358400
    v_mfma_f32_16x16x32_bf16 a[8:11], v[88:91], v[64:67], a[8:11]
    buffer_load_dwordx4 v[44:47], v1, s[16:19], s25 offen offset:0 sc1
    v_mfma_f32_16x16x32_bf16 a[12:15], v[92:95], v[64:67], a[12:15]
    buffer_load_dwordx4 v[48:51], v1, s[16:19], s25 offen offset:1024 sc1
    v_mfma_f32_16x16x32_bf16 a[16:19], v[96:99], v[64:67], a[16:19]
    buffer_load_dwordx4 v[52:55], v1, s[16:19], s25 offen offset:2048 sc1
    v_mfma_f32_16x16x32_bf16 a[20:23], v[80:83], v[68:71], a[20:23]
    buffer_load_dwordx4 v[56:59], v1, s[16:19], s25 offen offset:3072 sc1
    v_mfma_f32_16x16x32_bf16 a[24:27], v[84:87], v[68:71], a[24:27]
    buffer_load_dwordx4 v[60:63], v2, s[16:19], s25 offen offset:0 sc1
    v_mfma_f32_16x16x32_bf16 a[28:31], v[88:91], v[68:71], a[28:31]
    buffer_load_dwordx4 v[28:31], v1, s[16:19], s24 offen offset:0 sc1
    v_mfma_f32_16x16x32_bf16 a[32:35], v[92:95], v[68:71], a[32:35]
    buffer_load_dwordx4 v[32:35], v1, s[16:19], s24 offen offset:1024 sc1
    v_mfma_f32_16x16x32_bf16 a[36:39], v[96:99], v[68:71], a[36:39]
    buffer_load_dwordx4 v[36:39], v1, s[16:19], s24 offen offset:2048 sc1
    v_mfma_f32_16x16x32_bf16 a[40:43], v[80:83], v[72:75], a[40:43]
    buffer_load_dwordx4 v[40:43], v1, s[16:19], s24 offen offset:3072 sc1
    v_mfma_f32_16x16x32_bf16 a[44:47], v[84:87], v[72:75], a[44:47]
    v_mfma_f32_16x16x32_bf16 a[48:51], v[88:91], v[72:75], a[48:51]
    v_mfma_f32_16x16x32_bf16 a[52:55], v[92:95], v[72:75], a[52:55]
    v_mfma_f32_16x16x32_bf16 a[56:59], v[96:99], v[72:75], a[56:59]
    v_mfma_f32_16x16x32_bf16 a[60:63], v[80:83], v[76:79], a[60:63]
    v_mfma_f32_16x16x32_bf16 a[64:67], v[84:87], v[76:79], a[64:67]
    v_mfma_f32_16x16x32_bf16 a[68:71], v[88:91], v[76:79], a[68:71]
    v_mfma_f32_16x16x32_bf16 a[72:75], v[92:95], v[76:79], a[72:75]
    v_mfma_f32_16x16x32_bf16 a[76:79], v[96:99], v[76:79], a[76:79]
    s_waitcnt vmcnt(36)
    v_mfma_f32_16x16x32_bf16 a[0:3], v[116:119], v[100:103], a[0:3]
    s_lshl_b32 s38, s23, 8
    s_add_u32 s38, s38, 19922944
    s_mul_i32 s39, s27, 160
    s_mul_i32 s40, s23, 81920
    s_add_u32 s40, s40, s39
    v_mfma_f32_16x16x32_bf16 a[4:7], v[120:123], v[100:103], a[4:7]
    v_add_u32 v10, 0, v0
    v_mul_u32_u24 v11, 3277, v10
    v_lshrrev_b32 v11, 16, v11
    v_mul_u32_u24 v12, 20, v11
    v_sub_u32 v12, v10, v12
    v_mfma_f32_16x16x32_bf16 a[8:11], v[124:127], v[100:103], a[8:11]
    v_bfe_u32 v13, v11, 1, 2
    v_xor_b32 v13, v13, v10
    v_lshlrev_b32 v176, 4, v13
    v_lshlrev_b32 v12, 3, v12
    v_mul_u32_u24 v13, 1280, v11
    v_mfma_f32_16x16x32_bf16 a[12:15], v[128:131], v[100:103], a[12:15]
    v_add_u32 v181, v13, v12
    v_lshlrev_b32 v11, 2, v11
    buffer_load_dword v186, v11, s[16:19], s38 offen offset:0 sc1
    buffer_load_dwordx2 v[192:193], v12, s[12:15], s39 offen offset:0
    v_add_u32 v10, 256, v0
    v_mfma_f32_16x16x32_bf16 a[16:19], v[132:135], v[100:103], a[16:19]
    v_mul_u32_u24 v11, 3277, v10
    v_lshrrev_b32 v11, 16, v11
    v_mul_u32_u24 v12, 20, v11
    v_sub_u32 v12, v10, v12
    v_bfe_u32 v13, v11, 1, 2
    v_mfma_f32_16x16x32_bf16 a[20:23], v[116:119], v[104:107], a[20:23]
    v_xor_b32 v13, v13, v10
    v_lshlrev_b32 v177, 4, v13
    v_lshlrev_b32 v12, 3, v12
    v_mul_u32_u24 v13, 1280, v11
    v_add_u32 v182, v13, v12
    v_mfma_f32_16x16x32_bf16 a[24:27], v[120:123], v[104:107], a[24:27]
    v_lshlrev_b32 v11, 2, v11
    buffer_load_dword v187, v11, s[16:19], s38 offen offset:0 sc1
    buffer_load_dwordx2 v[194:195], v12, s[12:15], s39 offen offset:0
    v_add_u32 v10, 512, v0
    v_mul_u32_u24 v11, 3277, v10
    v_mfma_f32_16x16x32_bf16 a[28:31], v[124:127], v[104:107], a[28:31]
    v_lshrrev_b32 v11, 16, v11
    v_mul_u32_u24 v12, 20, v11
    v_sub_u32 v12, v10, v12
    v_bfe_u32 v13, v11, 1, 2
    v_xor_b32 v13, v13, v10
    v_mfma_f32_16x16x32_bf16 a[32:35], v[128:131], v[104:107], a[32:35]
    v_lshlrev_b32 v178, 4, v13
    v_lshlrev_b32 v12, 3, v12
    v_mul_u32_u24 v13, 1280, v11
    v_add_u32 v183, v13, v12
    v_lshlrev_b32 v11, 2, v11
    v_mfma_f32_16x16x32_bf16 a[36:39], v[132:135], v[104:107], a[36:39]
    buffer_load_dword v188, v11, s[16:19], s38 offen offset:0 sc1
    buffer_load_dwordx2 v[196:197], v12, s[12:15], s39 offen offset:0
    v_add_u32 v10, 768, v0
    v_mul_u32_u24 v11, 3277, v10
    v_lshrrev_b32 v11, 16, v11
    v_mfma_f32_16x16x32_bf16 a[40:43], v[116:119], v[108:111], a[40:43]
    v_mul_u32_u24 v12, 20, v11
    v_sub_u32 v12, v10, v12
    v_bfe_u32 v13, v11, 1, 2
    v_xor_b32 v13, v13, v10
    v_lshlrev_b32 v179, 4, v13
    v_mfma_f32_16x16x32_bf16 a[44:47], v[120:123], v[108:111], a[44:47]
    v_lshlrev_b32 v12, 3, v12
    v_mul_u32_u24 v13, 1280, v11
    v_add_u32 v184, v13, v12
    v_lshlrev_b32 v11, 2, v11
    buffer_load_dword v189, v11, s[16:19], s38 offen offset:0 sc1
    v_mfma_f32_16x16x32_bf16 a[48:51], v[124:127], v[108:111], a[48:51]
    buffer_load_dwordx2 v[198:199], v12, s[12:15], s39 offen offset:0
    v_add_u32 v10, 1024, v0
    v_mul_u32_u24 v11, 3277, v10
    v_lshrrev_b32 v11, 16, v11
    v_mul_u32_u24 v12, 20, v11
    v_mfma_f32_16x16x32_bf16 a[52:55], v[128:131], v[108:111], a[52:55]
    v_sub_u32 v12, v10, v12
    v_bfe_u32 v13, v11, 1, 2
    v_xor_b32 v13, v13, v10
    v_lshlrev_b32 v180, 4, v13
    v_lshlrev_b32 v12, 3, v12
    v_mfma_f32_16x16x32_bf16 a[56:59], v[132:135], v[108:111], a[56:59]
    v_mul_u32_u24 v13, 1280, v11
    v_add_u32 v185, v13, v12
    v_lshlrev_b32 v11, 2, v11
    buffer_load_dword v190, v11, s[16:19], s38 offen offset:0 sc1
    buffer_load_dwordx2 v[200:201], v12, s[12:15], s39 offen offset:0
    v_mfma_f32_16x16x32_bf16 a[60:63], v[116:119], v[112:115], a[60:63]
    v_and_b32 v10, 15, v3
    v_lshrrev_b32 v11, 4, v3
    v_bfe_u32 v12, v10, 1, 2
    v_xor_b32 v11, v11, v12
    v_mul_u32_u24 v10, 320, v10
    v_mfma_f32_16x16x32_bf16 a[64:67], v[120:123], v[112:115], a[64:67]
    v_lshl_add_u32 v10, v11, 4, v10
    s_mul_i32 s37, s20, 20480
    v_add_u32 v19, s37, v10
    v_mfma_f32_16x16x32_bf16 a[68:71], v[124:127], v[112:115], a[68:71]
    v_mfma_f32_16x16x32_bf16 a[72:75], v[128:131], v[112:115], a[72:75]
    v_mfma_f32_16x16x32_bf16 a[76:79], v[132:135], v[112:115], a[76:79]
    s_waitcnt vmcnt(37)
    v_mfma_f32_16x16x32_bf16 a[0:3], v[152:155], v[136:139], a[0:3]
    v_mfma_f32_16x16x32_bf16 a[4:7], v[156:159], v[136:139], a[4:7]
    v_mfma_f32_16x16x32_bf16 a[8:11], v[160:163], v[136:139], a[8:11]
    v_mfma_f32_16x16x32_bf16 a[12:15], v[164:167], v[136:139], a[12:15]
    v_mfma_f32_16x16x32_bf16 a[16:19], v[168:171], v[136:139], a[16:19]
    v_mfma_f32_16x16x32_bf16 a[20:23], v[152:155], v[140:143], a[20:23]
    v_mfma_f32_16x16x32_bf16 a[24:27], v[156:159], v[140:143], a[24:27]
    v_mfma_f32_16x16x32_bf16 a[28:31], v[160:163], v[140:143], a[28:31]
    v_mfma_f32_16x16x32_bf16 a[32:35], v[164:167], v[140:143], a[32:35]
    v_mfma_f32_16x16x32_bf16 a[36:39], v[168:171], v[140:143], a[36:39]
    v_mfma_f32_16x16x32_bf16 a[40:43], v[152:155], v[144:147], a[40:43]
    v_mfma_f32_16x16x32_bf16 a[44:47], v[156:159], v[144:147], a[44:47]
    v_mfma_f32_16x16x32_bf16 a[48:51], v[160:163], v[144:147], a[48:51]
    v_mfma_f32_16x16x32_bf16 a[52:55], v[164:167], v[144:147], a[52:55]
    v_mfma_f32_16x16x32_bf16 a[56:59], v[168:171], v[144:147], a[56:59]
    v_mfma_f32_16x16x32_bf16 a[60:63], v[152:155], v[148:151], a[60:63]
    v_mfma_f32_16x16x32_bf16 a[64:67], v[156:159], v[148:151], a[64:67]
    v_mfma_f32_16x16x32_bf16 a[68:71], v[160:163], v[148:151], a[68:71]
    v_mfma_f32_16x16x32_bf16 a[72:75], v[164:167], v[148:151], a[72:75]
    v_mfma_f32_16x16x32_bf16 a[76:79], v[168:171], v[148:151], a[76:79]
    s_waitcnt vmcnt(28)
    v_mfma_f32_16x16x32_bf16 a[0:3], a[96:99], a[80:83], a[0:3]
    v_mfma_f32_16x16x32_bf16 a[4:7], a[100:103], a[80:83], a[4:7]
    v_mfma_f32_16x16x32_bf16 a[8:11], a[104:107], a[80:83], a[8:11]
    v_mfma_f32_16x16x32_bf16 a[12:15], a[108:111], a[80:83], a[12:15]
    v_mfma_f32_16x16x32_bf16 a[16:19], a[112:115], a[80:83], a[16:19]
    v_mfma_f32_16x16x32_bf16 a[20:23], a[96:99], a[84:87], a[20:23]
    v_mfma_f32_16x16x32_bf16 a[24:27], a[100:103], a[84:87], a[24:27]
    v_mfma_f32_16x16x32_bf16 a[28:31], a[104:107], a[84:87], a[28:31]
    v_mfma_f32_16x16x32_bf16 a[32:35], a[108:111], a[84:87], a[32:35]
    v_mfma_f32_16x16x32_bf16 a[36:39], a[112:115], a[84:87], a[36:39]
    v_mfma_f32_16x16x32_bf16 a[40:43], a[96:99], a[88:91], a[40:43]
    v_mfma_f32_16x16x32_bf16 a[44:47], a[100:103], a[88:91], a[44:47]
    v_mfma_f32_16x16x32_bf16 a[48:51], a[104:107], a[88:91], a[48:51]
    v_mfma_f32_16x16x32_bf16 a[52:55], a[108:111], a[88:91], a[52:55]
    v_mfma_f32_16x16x32_bf16 a[56:59], a[112:115], a[88:91], a[56:59]
    v_mfma_f32_16x16x32_bf16 a[60:63], a[96:99], a[92:95], a[60:63]
    v_mfma_f32_16x16x32_bf16 a[64:67], a[100:103], a[92:95], a[64:67]
    v_mfma_f32_16x16x32_bf16 a[68:71], a[104:107], a[92:95], a[68:71]
    v_mfma_f32_16x16x32_bf16 a[72:75], a[108:111], a[92:95], a[72:75]
    v_mfma_f32_16x16x32_bf16 a[76:79], a[112:115], a[92:95], a[76:79]
    s_waitcnt vmcnt(19)
    v_mfma_f32_16x16x32_bf16 a[0:3], a[132:135], a[116:119], a[0:3]
    v_mfma_f32_16x16x32_bf16 a[4:7], a[136:139], a[116:119], a[4:7]
    v_mfma_f32_16x16x32_bf16 a[8:11], a[140:143], a[116:119], a[8:11]
    v_mfma_f32_16x16x32_bf16 a[12:15], a[144:147], a[116:119], a[12:15]
    v_mfma_f32_16x16x32_bf16 a[16:19], a[148:151], a[116:119], a[16:19]
    v_mfma_f32_16x16x32_bf16 a[20:23], a[132:135], a[120:123], a[20:23]
    v_mfma_f32_16x16x32_bf16 a[24:27], a[136:139], a[120:123], a[24:27]
    v_mfma_f32_16x16x32_bf16 a[28:31], a[140:143], a[120:123], a[28:31]
    v_mfma_f32_16x16x32_bf16 a[32:35], a[144:147], a[120:123], a[32:35]
    v_mfma_f32_16x16x32_bf16 a[36:39], a[148:151], a[120:123], a[36:39]
    v_mfma_f32_16x16x32_bf16 a[40:43], a[132:135], a[124:127], a[40:43]
    v_mfma_f32_16x16x32_bf16 a[44:47], a[136:139], a[124:127], a[44:47]
    v_mfma_f32_16x16x32_bf16 a[48:51], a[140:143], a[124:127], a[48:51]
    v_mfma_f32_16x16x32_bf16 a[52:55], a[144:147], a[124:127], a[52:55]
    v_mfma_f32_16x16x32_bf16 a[56:59], a[148:151], a[124:127], a[56:59]
    v_mfma_f32_16x16x32_bf16 a[60:63], a[132:135], a[128:131], a[60:63]
    v_mfma_f32_16x16x32_bf16 a[64:67], a[136:139], a[128:131], a[64:67]
    v_mfma_f32_16x16x32_bf16 a[68:71], a[140:143], a[128:131], a[68:71]
    v_mfma_f32_16x16x32_bf16 a[72:75], a[144:147], a[128:131], a[72:75]
    v_mfma_f32_16x16x32_bf16 a[76:79], a[148:151], a[128:131], a[76:79]
    s_waitcnt vmcnt(10)
    v_mfma_f32_16x16x32_bf16 a[0:3], v[44:47], v[28:31], a[0:3]
    v_mfma_f32_16x16x32_bf16 a[4:7], v[48:51], v[28:31], a[4:7]
    v_mfma_f32_16x16x32_bf16 a[8:11], v[52:55], v[28:31], a[8:11]
    v_mfma_f32_16x16x32_bf16 a[12:15], v[56:59], v[28:31], a[12:15]
    v_mfma_f32_16x16x32_bf16 a[16:19], v[60:63], v[28:31], a[16:19]
    v_mfma_f32_16x16x32_bf16 a[20:23], v[44:47], v[32:35], a[20:23]
    v_mfma_f32_16x16x32_bf16 a[24:27], v[48:51], v[32:35], a[24:27]
    v_mfma_f32_16x16x32_bf16 a[28:31], v[52:55], v[32:35], a[28:31]
    v_mfma_f32_16x16x32_bf16 a[32:35], v[56:59], v[32:35], a[32:35]
    ds_write_b128 v19, a[0:3] offset:0
    v_mfma_f32_16x16x32_bf16 a[36:39], v[60:63], v[32:35], a[36:39]
    ds_write_b128 v19, a[4:7] offset:64
    v_mfma_f32_16x16x32_bf16 a[40:43], v[44:47], v[36:39], a[40:43]
    ds_write_b128 v19, a[8:11] offset:128
    v_mfma_f32_16x16x32_bf16 a[44:47], v[48:51], v[36:39], a[44:47]
    ds_write_b128 v19, a[12:15] offset:192
    v_mfma_f32_16x16x32_bf16 a[48:51], v[52:55], v[36:39], a[48:51]
    ds_write_b128 v19, a[16:19] offset:256
    v_mfma_f32_16x16x32_bf16 a[52:55], v[56:59], v[36:39], a[52:55]
    ds_write_b128 v19, a[20:23] offset:5120
    v_mfma_f32_16x16x32_bf16 a[56:59], v[60:63], v[36:39], a[56:59]
    ds_write_b128 v19, a[24:27] offset:5184
    v_mfma_f32_16x16x32_bf16 a[60:63], v[44:47], v[40:43], a[60:63]
    ds_write_b128 v19, a[28:31] offset:5248
    v_mfma_f32_16x16x32_bf16 a[64:67], v[48:51], v[40:43], a[64:67]
    ds_write_b128 v19, a[32:35] offset:5312
    v_mfma_f32_16x16x32_bf16 a[68:71], v[52:55], v[40:43], a[68:71]
    ds_write_b128 v19, a[36:39] offset:5376
    v_mfma_f32_16x16x32_bf16 a[72:75], v[56:59], v[40:43], a[72:75]
    ds_write_b128 v19, a[40:43] offset:10240
    v_mfma_f32_16x16x32_bf16 a[76:79], v[60:63], v[40:43], a[76:79]
    ds_write_b128 v19, a[44:47] offset:10304
    ds_write_b128 v19, a[48:51] offset:10368
    ds_write_b128 v19, a[52:55] offset:10432
    ds_write_b128 v19, a[56:59] offset:10496
    ds_write_b128 v19, a[60:63] offset:15360
    ds_write_b128 v19, a[64:67] offset:15424
    ds_write_b128 v19, a[68:71] offset:15488
    ds_write_b128 v19, a[72:75] offset:15552
    s_nop 1
    ds_write_b128 v19, a[76:79] offset:15616
    s_waitcnt vmcnt(0)
    v_sub_f32 v186, 1.0, v186
    v_sub_f32 v187, 1.0, v187
    v_sub_f32 v188, 1.0, v188
    v_sub_f32 v189, 1.0, v189
    v_sub_f32 v190, 1.0, v190
    s_waitcnt lgkmcnt(0)
    s_barrier
    ds_read_b128 v[28:31], v176 offset:0
    ds_read_b128 v[32:35], v176 offset:20480
    ds_read_b128 v[36:39], v176 offset:40960
    ds_read_b128 v[40:43], v176 offset:61440
    ds_read_b128 v[44:47], v177 offset:0
    ds_read_b128 v[48:51], v177 offset:20480
    ds_read_b128 v[52:55], v177 offset:40960
    ds_read_b128 v[56:59], v177 offset:61440
    ds_read_b128 v[60:63], v178 offset:0
    ds_read_b128 v[64:67], v178 offset:20480
    ds_read_b128 v[68:71], v178 offset:40960
    ds_read_b128 v[72:75], v178 offset:61440
    v_lshlrev_b32 v10, 16, v192
    v_and_b32 v11, 0xffff0000, v192
    v_lshlrev_b32 v12, 16, v193
    v_and_b32 v13, 0xffff0000, v193
    s_waitcnt lgkmcnt(8)
    ds_read_b128 v[76:79], v179 offset:0
    ds_read_b128 v[80:83], v179 offset:20480
    ds_read_b128 v[84:87], v179 offset:40960
    ds_read_b128 v[88:91], v179 offset:61440
    v_pk_add_f32 v[28:29], v[28:29], v[32:33]
    v_pk_add_f32 v[30:31], v[30:31], v[34:35]
    v_pk_add_f32 v[36:37], v[36:37], v[40:41]
    v_pk_add_f32 v[38:39], v[38:39], v[42:43]
    v_pk_add_f32 v[28:29], v[28:29], v[36:37]
    v_pk_add_f32 v[30:31], v[30:31], v[38:39]
    v_fmac_f32 v28, v10, v186
    v_fmac_f32 v29, v11, v186
    v_fmac_f32 v30, v12, v186
    v_fmac_f32 v31, v13, v186
    v_cvt_pk_bf16_f32 v28, v28, v29
    v_cvt_pk_bf16_f32 v29, v30, v31
    buffer_store_dwordx2 v[28:29], v181, s[8:11], s40 offen
    v_lshlrev_b32 v10, 16, v194
    v_and_b32 v11, 0xffff0000, v194
    v_lshlrev_b32 v12, 16, v195
    v_and_b32 v13, 0xffff0000, v195
    s_waitcnt lgkmcnt(8)
    ds_read_b128 v[92:95], v180 offset:0
    ds_read_b128 v[96:99], v180 offset:20480
    ds_read_b128 v[100:103], v180 offset:40960
    ds_read_b128 v[104:107], v180 offset:61440
    v_pk_add_f32 v[44:45], v[44:45], v[48:49]
    v_pk_add_f32 v[46:47], v[46:47], v[50:51]
    v_pk_add_f32 v[52:53], v[52:53], v[56:57]
    v_pk_add_f32 v[54:55], v[54:55], v[58:59]
    v_pk_add_f32 v[44:45], v[44:45], v[52:53]
    v_pk_add_f32 v[46:47], v[46:47], v[54:55]
    v_fmac_f32 v44, v10, v187
    v_fmac_f32 v45, v11, v187
    v_fmac_f32 v46, v12, v187
    v_fmac_f32 v47, v13, v187
    v_cvt_pk_bf16_f32 v44, v44, v45
    v_cvt_pk_bf16_f32 v45, v46, v47
    buffer_store_dwordx2 v[44:45], v182, s[8:11], s40 offen
    v_lshlrev_b32 v10, 16, v196
    v_and_b32 v11, 0xffff0000, v196
    v_lshlrev_b32 v12, 16, v197
    v_and_b32 v13, 0xffff0000, v197
    s_waitcnt lgkmcnt(8)
    v_pk_add_f32 v[60:61], v[60:61], v[64:65]
    v_pk_add_f32 v[62:63], v[62:63], v[66:67]
    v_pk_add_f32 v[68:69], v[68:69], v[72:73]
    v_pk_add_f32 v[70:71], v[70:71], v[74:75]
    v_pk_add_f32 v[60:61], v[60:61], v[68:69]
    v_pk_add_f32 v[62:63], v[62:63], v[70:71]
    v_fmac_f32 v60, v10, v188
    v_fmac_f32 v61, v11, v188
    v_fmac_f32 v62, v12, v188
    v_fmac_f32 v63, v13, v188
    v_cvt_pk_bf16_f32 v60, v60, v61
    v_cvt_pk_bf16_f32 v61, v62, v63
    buffer_store_dwordx2 v[60:61], v183, s[8:11], s40 offen
    v_lshlrev_b32 v10, 16, v198
    v_and_b32 v11, 0xffff0000, v198
    v_lshlrev_b32 v12, 16, v199
    v_and_b32 v13, 0xffff0000, v199
    s_waitcnt lgkmcnt(4)
    v_pk_add_f32 v[76:77], v[76:77], v[80:81]
    v_pk_add_f32 v[78:79], v[78:79], v[82:83]
    v_pk_add_f32 v[84:85], v[84:85], v[88:89]
    v_pk_add_f32 v[86:87], v[86:87], v[90:91]
    v_pk_add_f32 v[76:77], v[76:77], v[84:85]
    v_pk_add_f32 v[78:79], v[78:79], v[86:87]
    v_fmac_f32 v76, v10, v189
    v_fmac_f32 v77, v11, v189
    v_fmac_f32 v78, v12, v189
    v_fmac_f32 v79, v13, v189
    v_cvt_pk_bf16_f32 v76, v76, v77
    v_cvt_pk_bf16_f32 v77, v78, v79
    buffer_store_dwordx2 v[76:77], v184, s[8:11], s40 offen
    v_lshlrev_b32 v10, 16, v200
    v_and_b32 v11, 0xffff0000, v200
    v_lshlrev_b32 v12, 16, v201
    v_and_b32 v13, 0xffff0000, v201
    s_waitcnt lgkmcnt(0)
    v_pk_add_f32 v[92:93], v[92:93], v[96:97]
    v_pk_add_f32 v[94:95], v[94:95], v[98:99]
    v_pk_add_f32 v[100:101], v[100:101], v[104:105]
    v_pk_add_f32 v[102:103], v[102:103], v[106:107]
    v_pk_add_f32 v[92:93], v[92:93], v[100:101]
    v_pk_add_f32 v[94:95], v[94:95], v[102:103]
    v_fmac_f32 v92, v10, v190
    v_fmac_f32 v93, v11, v190
    v_fmac_f32 v94, v12, v190
    v_fmac_f32 v95, v13, v190
    v_cvt_pk_bf16_f32 v92, v92, v93
    v_cvt_pk_bf16_f32 v93, v94, v95
    buffer_store_dwordx2 v[92:93], v185, s[8:11], s40 offen
    s_endpgm
.p2align 8
.fill 2048, 4, 0xbf800000
s_endpgm
.section .rodata,"a"
.p2align 6
.amdhsa_kernel gated_mix__linear_attn_block__mixer_channel_mlp__prompt_kernel
  .amdhsa_next_free_vgpr 512
  .amdhsa_next_free_sgpr 102
  .amdhsa_accum_offset 256
  .amdhsa_group_segment_fixed_size 0
  .amdhsa_kernarg_size 96
  .amdhsa_user_sgpr_count 2
  .amdhsa_user_sgpr_kernarg_segment_ptr 1
  .amdhsa_system_sgpr_workgroup_id_x 1
.end_amdhsa_kernel
```
